```python
import torch

def _softmax(x, axis=-1):
    return torch.softmax(x, dim=axis)
def _gelu(x):
    return torch.nn.functional.gelu(x, approximate="tanh")
def _silu(x):
    return torch.nn.functional.silu(x)
def _sigmoid(x):
    return torch.sigmoid(x)
def _layernorm(x, axis=-1, eps=1e-5):
    m = x.mean(dim=axis, keepdim=True)
    v = x.var(dim=axis, keepdim=True, unbiased=False)
    return (x - m) / torch.sqrt(v + eps)
def _scatter_add(tgt, idx, src, axis=0):
    return tgt.clone().index_add_(axis, idx, src)
def _segment_sum(src, seg, n):
    out = torch.zeros((n,) + src.shape[1:], dtype=src.dtype)
    return out.index_add_(0, seg, src)
def _pad(x, pw):
    flat = tuple(v for pair in reversed(pw) for v in pair)
    return torch.nn.functional.pad(x, flat)

kernel_name = 'sequential_preLN__grouped_kv_mqa__glu_gated_swiglu__prompt'

def setup_inputs():

    _w = (lambda a: (lambda t: t.to(torch.bfloat16) if t.is_floating_point() else t)(torch.as_tensor(a)))
    def _A_setup():
        B, S, D, H = 1, 2048, 640, 32
        Dh = D // H
        return {
            "x": _w((lambda *s: torch.randn(*s, dtype=torch.bfloat16) * 0.05)(B, S, D)),
            "wq": _w((lambda *s: torch.randn(*s, dtype=torch.bfloat16) * 0.05)(D, H * Dh)),
            "wk": _w((lambda *s: torch.randn(*s, dtype=torch.bfloat16) * 0.05)(D, Dh)),
            "wv": _w((lambda *s: torch.randn(*s, dtype=torch.bfloat16) * 0.05)(D, Dh)),
            "wo": _w((lambda *s: torch.randn(*s, dtype=torch.bfloat16) * 0.05)(H * Dh, D)),
        }
    _A_in = _A_setup()

    def _B_setup():
        B, S, D, F = 1, 2048, 640, 1728
        return {
            "x": _w((lambda *s: torch.randn(*s, dtype=torch.bfloat16) * 0.05)(B, S, D)),
            "w1": _w((lambda *s: torch.randn(*s, dtype=torch.bfloat16) * 0.4)(D, F) * (2.0 / D) ** 0.5),
            "w3": _w((lambda *s: torch.randn(*s, dtype=torch.bfloat16) * 0.4)(D, F) * (2.0 / D) ** 0.5),
            "w2": _w((lambda *s: torch.randn(*s, dtype=torch.bfloat16) * 0.4)(F, D) * (2.0 / F) ** 0.5),
        }
    _B_in = _B_setup()

    return {
        "A_x": _A_in["x"],
        "A_wq": _A_in["wq"],
        "A_wk": _A_in["wk"],
        "A_wv": _A_in["wv"],
        "A_wo": _A_in["wo"],
        "B_x": _B_in["x"],
        "B_w1": _B_in["w1"],
        "B_w3": _B_in["w3"],
        "B_w2": _B_in["w2"],
    }

def reference(A_x, A_wq, A_wk, A_wv, A_wo, B_x, B_w1, B_w3, B_w2):
    def _A_ref(x, wq, wk, wv, wo):
        B, S, D = x.shape
        H = 32
        Dh = D // H
        q = (lambda x, *d: x.permute(*d))((x @ wq).reshape(B, S, H, Dh), 0, 2, 1, 3)
        k = x @ wk
        v = x @ wv
        scores = torch.einsum("bhqd,bkd->bhqk", q, k) * (Dh ** -0.5)
        p = _softmax(scores, axis=-1)
        o = torch.einsum("bhqk,bkd->bhqd", p, v)
        return (lambda x, *d: x.permute(*d))(o, 0, 2, 1, 3).reshape(B, S, H * Dh) @ wo

    def _B_ref(x, w1, w3, w2):
        gate = torch.einsum("bsd,df->bsf", x, w1)
        up = torch.einsum("bsd,df->bsf", x, w3)
        h = _silu(gate) * up
        out = torch.einsum("bsf,fd->bsd", h, w2)
        return out

    x = A_x
    h = x + _A_ref(_layernorm(x, axis=-1), A_wq, A_wk, A_wv, A_wo)
    h2 = h + _B_ref(_layernorm(h, axis=-1), B_w1, B_w3, B_w2)
    return h2
```

```asm
; @launch grid=(256,1,1) block=(256,1,1) lds=163840
.amdgcn_target "amdgcn-amd-amdhsa--gfx950"
.text
.globl sequential_preLN__grouped_kv_mqa__glu_gated_swiglu__prompt_kernel
.p2align 12
.type sequential_preLN__grouped_kv_mqa__glu_gated_swiglu__prompt_kernel,@function
sequential_preLN__grouped_kv_mqa__glu_gated_swiglu__prompt_kernel:
    s_cmp_ge_u32 s2, 256
    s_cbranch_scc1 k2_main_kernel_end
    s_load_dwordx2 s[4:5], s[0:1], 88
    s_mov_b32 s6, 0x10000000
    s_mov_b32 s7, 0x00020000
    s_load_dwordx2 s[16:17], s[0:1], 0
    s_mov_b32 s18, 0x280000
    s_mov_b32 s19, 0x00020000
    s_load_dwordx2 s[32:33], s[0:1], 16
    s_load_dwordx2 s[34:35], s[0:1], 24
    s_load_dwordx2 s[24:25], s[0:1], 8
    s_mov_b32 s26, 0xc8000
    s_mov_b32 s27, 0x00020000
    s_load_dwordx2 s[44:45], s[0:1], 80
    s_mov_b32 s46, 0x100
    s_mov_b32 s47, 0x00020000
    v_lshrrev_b32 v1, 6, v0
    v_lshrrev_b32 v2, 4, v0
    v_and_b32 v0, 63, v0
    s_and_b32 s38, s2, 7
    s_lshr_b32 s39, s2, 3
    v_readfirstlane_b32 s3, v1
    s_and_b32 s40, s38, 7
    s_mul_i32 s20, s40, 4
    s_lshr_b32 s40, s39, 3
    s_add_u32 s20, s20, s40
    s_lshr_b32 s40, s38, 3
    s_lshl_b32 s40, s40, 3
    s_and_b32 s21, s39, 7
    s_add_u32 s21, s21, s40
    v_lshlrev_b32 v1, 4, v0
    v_and_b32 v10, 15, v0
    v_xor_b32 v13, v10, v2
    v_mul_u32_u24 v240, 1280, v2
    v_lshl_add_u32 v240, v13, 4, v240
    s_lshl_b32 s22, s20, 2
    s_lshr_b32 s37, s21, 1
    s_add_u32 s28, s22, s37
    s_mul_i32 s28, s28, 20480
    s_mul_i32 s30, s3, 6400
    s_add_u32 m0, s30, 122880
    s_lshl_b32 s29, s3, 10
    s_sub_u32 s70, s3, s37
    s_and_b32 s70, s70, 3
    s_cmp_lg_u32 s3, 3
    s_cbranch_scc1 k2_main_kernel_npf
    s_getpc_b64 s[72:73]
k2_main_kernel_pc:
    s_sub_u32 s72, s72, k2_main_kernel_pc - sequential_preLN__grouped_kv_mqa__glu_gated_swiglu__prompt_kernel
    s_subb_u32 s73, s73, 0
    s_mov_b32 s74, text_end - sequential_preLN__grouped_kv_mqa__glu_gated_swiglu__prompt_kernel
    s_mov_b32 s75, 0x00020000
    s_lshl_b32 s79, s21, 13
    v_lshlrev_b32 v252, 7, v0
    buffer_load_dword v253, v252, s[72:75], s79 offen
k2_main_kernel_npf:
    v_lshrrev_b32 v254, 2, v0
    v_lshlrev_b32 v254, 7, v254
    v_and_b32 v13, 3, v0
    v_lshl_add_u32 v254, v13, 4, v254
    s_mov_b32 s68, 28049408
    s_lshl_b32 s83, s2, 2
    s_add_u32 s83, s83, s3
    v_mov_b64 v[16:17], 0
    v_mov_b64 v[18:19], 0
    v_bfe_u32 v11, v0, 4, 1
    v_lshrrev_b32 v12, 5, v0
    v_lshlrev_b32 v15, 3, v10
    v_add_u32 v6, 5570560, v1
    s_add_u32 s22, s22, s3
    s_mov_b32 s50, s22
    s_mov_b32 s52, s21
    s_lshl_b32 s53, s3, 12
    s_bitcmp1_b32 s21, 0
    s_waitcnt lgkmcnt(0)
    s_cselect_b32 s32, s34, s32
    s_cselect_b32 s33, s35, s33
    s_mov_b32 s34, 25600
    s_mov_b32 s35, 0x00020000
    s_cmp_lg_u32 s83, 1
    s_cbranch_scc1 k2_main_kernel_nzk
    buffer_store_dwordx4 v[16:19], v254, s[4:7], s68 offen sc1
k2_main_kernel_nzk:
    buffer_load_dwordx4 v1, s[32:35], s30 offen offset:0 lds
    buffer_load_dwordx4 v1, s[32:35], s30 offen offset:1024 lds
    v_mov_b32 v7, 1
    v_bfe_u32 v10, v0, 2, 2
    v_lshrrev_b32 v13, 4, v0
    v_lshrrev_b32 v228, 3, v15
    v_xor_b32 v228, v228, v13
    v_lshlrev_b32 v228, 4, v228
    v_lshl_add_u32 v228, v15, 5, v228
    v_lshl_add_u32 v13, v13, 3, v10
    v_and_b32 v10, 1, v0
    v_bfe_u32 v14, v0, 1, 1
    v_mul_u32_u24 v241, 40, v13
    v_lshl_add_u32 v241, v10, 3, v241
    buffer_load_dwordx4 v1, s[32:35], s30 offen offset:2048 lds
    v_lshl_add_u32 v241, v14, 5, v241
    s_mul_i32 s78, s3, 1280
    s_add_u32 s78, s78, 122880
    s_mul_i32 s36, s70, 20480
    s_lshl_b32 s40, s3, 6
    v_add_u32 v241, s78, v241
    s_and_b32 s78, s40, 128
    v_xor_b32 v228, s78, v228
    s_and_b32 s40, s40, 64
    v_xor_b32 v224, 0, v228
    v_add_u32 v224, s36, v224
    v_xor_b32 v225, 64, v228
    v_add_u32 v225, s36, v225
    buffer_load_dwordx4 v1, s[32:35], s30 offen offset:3072 lds
    v_xor_b32 v226, 128, v228
    v_add_u32 v226, s36, v226
    v_xor_b32 v227, 192, v228
    v_add_u32 v227, s36, v227
    v_xor_b32 v228, s40, v228
    s_mul_i32 s40, s21, 10
    v_lshl_add_u32 v149, v15, 5, s36
    v_lshl_add_u32 v149, v11, 3, v149
    v_add_u32 v150, s40, v12
    v_and_b32 v151, 15, v0
    s_movk_i32 s40, 3840
    v_xor_b32 v152, v150, v151
    s_add_u32 m0, m0, 4096
    s_add_u32 s30, s30, 4096
    buffer_load_dwordx4 v1, s[32:35], s30 offen offset:0 lds
    v_lshl_add_u32 v144, v152, 4, v149
    v_lshrrev_b32 v152, 4, v150
    v_mad_u32_u24 v144, v152, s40, v144
    v_add_u32 v150, 2, v150
    v_xor_b32 v152, v150, v151
    v_lshl_add_u32 v145, v152, 4, v149
    v_lshrrev_b32 v152, 4, v150
    v_mad_u32_u24 v145, v152, s40, v145
    v_add_u32 v150, 2, v150
    v_xor_b32 v152, v150, v151
    v_lshl_add_u32 v146, v152, 4, v149
    v_lshrrev_b32 v152, 4, v150
    buffer_load_dwordx4 v1, s[32:35], s30 offen offset:1024 lds
    v_mad_u32_u24 v146, v152, s40, v146
    v_add_u32 v150, 2, v150
    v_xor_b32 v152, v150, v151
    v_lshl_add_u32 v147, v152, 4, v149
    v_lshrrev_b32 v152, 4, v150
    v_mad_u32_u24 v147, v152, s40, v147
    v_add_u32 v150, 2, v150
    v_xor_b32 v152, v150, v151
    v_lshl_add_u32 v148, v152, 4, v149
    v_lshrrev_b32 v152, 4, v150
    v_mad_u32_u24 v148, v152, s40, v148
    v_add_u32 v150, 2, v150
    buffer_load_dwordx4 v1, s[32:35], s30 offen offset:2048 lds
    s_xor_b32 s40, s3, 1
    s_sub_u32 s40, s40, s37
    s_and_b32 s40, s40, 3
    s_sub_u32 s40, s40, s70
    s_mul_i32 s40, s40, 20480
    v_add_u32 v153, s40, v224
    v_add_u32 v154, s40, v225
    v_add_u32 v155, s40, v226
    v_add_u32 v156, s40, v227
    v_mov_b32 v108, 0x3f803f80
    v_mov_b32 v109, 0x3f803f80
    v_mov_b32 v110, 0x3f803f80
    s_add_u32 m0, s29, 0
    s_nop 0
    buffer_load_dwordx4 v240, s[16:19], s28 offen offset:0 lds
    v_mov_b32 v111, 0x3f803f80
    v_lshl_add_u32 v13, v11, 2, v13
    s_and_b32 s36, s3, 1
    s_mul_i32 s36, s36, 40
    s_add_u32 s36, s36, 81920
    v_mul_u32_u24 v10, 80, v10
    v_add_u32 v10, s36, v10
    v_mul_u32_u24 v249, 160, v13
    v_add_u32 v249, v249, v10
    v_lshl_add_u32 v247, v14, 3, v249
    v_xor_b32 v13, 4, v13
    v_mul_u32_u24 v250, 160, v13
    s_add_u32 m0, s29, 3840
    s_nop 0
    buffer_load_dwordx4 v240, s[16:19], s28 offen offset:256 lds
    v_add_u32 v250, v250, v10
    v_lshl_add_u32 v248, v14, 3, v250
    v_add_u32 v13, 0, v0
    v_mul_u32_u24 v14, 205, v13
    v_lshrrev_b32 v14, 11, v14
    v_lshrrev_b32 v10, 1, v14
    v_and_b32 v10, 4, v10
    v_xor_b32 v10, v10, v14
    v_mul_u32_u24 v10, 1280, v10
    v_mul_u32_u24 v14, 160, v14
    v_lshl_add_u32 v10, v13, 4, v10
    v_sub_u32 v242, v10, v14
    s_add_u32 m0, s29, 7680
    s_nop 0
    buffer_load_dwordx4 v240, s[16:19], s28 offen offset:512 lds
    v_add_u32 v13, 64, v0
    v_mul_u32_u24 v14, 205, v13
    v_lshrrev_b32 v14, 11, v14
    v_lshrrev_b32 v10, 1, v14
    v_and_b32 v10, 4, v10
    v_xor_b32 v10, v10, v14
    v_mul_u32_u24 v10, 1280, v10
    v_mul_u32_u24 v14, 160, v14
    v_lshl_add_u32 v10, v13, 4, v10
    v_sub_u32 v243, v10, v14
    v_add_u32 v13, 128, v0
    v_mul_u32_u24 v14, 205, v13
    s_add_u32 m0, s29, 11520
    s_nop 0
    buffer_load_dwordx4 v240, s[16:19], s28 offen offset:768 lds
    v_lshrrev_b32 v14, 11, v14
    v_lshrrev_b32 v10, 1, v14
    v_and_b32 v10, 4, v10
    v_xor_b32 v10, v10, v14
    v_mul_u32_u24 v10, 1280, v10
    v_mul_u32_u24 v14, 160, v14
    v_lshl_add_u32 v10, v13, 4, v10
    v_sub_u32 v244, v10, v14
    v_add_u32 v13, 192, v0
    v_mul_u32_u24 v14, 205, v13
    v_lshrrev_b32 v14, 11, v14
    v_lshrrev_b32 v10, 1, v14
    s_add_u32 m0, s29, 15360
    s_nop 0
    buffer_load_dwordx4 v240, s[16:19], s28 offen offset:1024 lds
    s_cmp_lg_u32 s70, 0
    s_cbranch_scc1 k2_main_kernel_nzf
    s_lshl_b32 s81, s2, 11
    s_add_u32 s81, s81, 27262976
    v_lshlrev_b32 v230, 7, v0
    v_mov_b32 v231, 0
    s_mov_b64 exec, 0xffff
    buffer_store_dword v231, v230, s[4:7], s81 offen sc1
    s_mov_b64 exec, -1
k2_main_kernel_nzf:
    v_and_b32 v10, 4, v10
    v_xor_b32 v10, v10, v14
    v_mul_u32_u24 v10, 1280, v10
    v_mul_u32_u24 v14, 160, v14
    v_lshl_add_u32 v10, v13, 4, v10
    v_sub_u32 v245, v10, v14
    v_add_u32 v13, 256, v0
    v_mul_u32_u24 v14, 205, v13
    v_lshrrev_b32 v14, 11, v14
    v_lshrrev_b32 v10, 1, v14
    v_and_b32 v10, 4, v10
    v_xor_b32 v10, v10, v14
    s_add_u32 m0, s29, 20480
    s_add_u32 s51, s37, 1
    s_and_b32 s51, s51, 3
    s_lshl2_add_u32 s51, s20, s51
    s_mul_i32 s51, s51, 20480
    buffer_load_dwordx4 v240, s[16:19], s51 offen offset:0 lds
    v_bfe_u32 v80, v0, 1, 2
    v_bfe_u32 v81, v0, 3, 1
    v_and_b32 v84, 1, v0
    v_lshlrev_b32 v84, 4, v84
    v_mov_b32 v236, v1
    v_mov_b32 v237, 0
    s_lshl_b32 s65, s2, 2
    s_add_u32 s65, s65, s3
    s_lshl_b32 s65, s65, 7
    s_add_u32 s65, s65, 27787264
    s_add_u32 m0, s29, 40960
    s_add_u32 s62, s37, 2
    s_and_b32 s62, s62, 3
    s_lshl2_add_u32 s62, s20, s62
    s_mul_i32 s62, s62, 20480
    buffer_load_dwordx4 v240, s[16:19], s62 offen offset:0 lds
    s_cmp_lt_u32 s2, 112
    s_cbranch_scc1 k2_main_kernel_t13
    s_cmp_lt_u32 s2, 168
    s_cbranch_scc1 k2_main_kernel_t2
    s_load_dwordx2 s[8:9], s[0:1], 32
    s_mov_b32 s10, 0xc8000
    s_mov_b32 s11, 0x00020000
    s_load_dwordx2 s[12:13], s[0:1], 32
    s_mov_b32 s14, 0xc8000
    s_mov_b32 s15, 0x00020000
    s_sub_u32 s71, s2, 168
    s_mul_i32 s59, s71, 5120
    s_add_u32 s59, s59, s29
    s_add_u32 s59, s59, 18874368
    s_mov_b32 s64, 409600
    s_add_u32 m0, s29, 61440
    s_add_u32 s82, s37, 3
    s_and_b32 s82, s82, 3
    s_lshl2_add_u32 s82, s20, s82
    s_mul_i32 s82, s82, 20480
    buffer_load_dwordx4 v240, s[16:19], s82 offen offset:0 lds
    s_mul_i32 s72, s71, 40
    s_and_b32 s73, s71, 1
    s_mul_i32 s73, s73, 20
    s_sub_u32 s72, s72, s73
    s_mov_b32 s73, 40
    s_mov_b32 s74, 4
    s_mov_b32 s75, 8
    s_cmp_lt_u32 s71, 16
    s_cbranch_scc1 k2_main_kernel_tcommon
    s_mul_i32 s72, s71, 160
    s_sub_u32 s72, s72, 2544
    s_mov_b32 s73, 20
    s_mov_b32 s74, 80
    s_mov_b32 s75, 40
    s_branch k2_main_kernel_tcommon
k2_main_kernel_t2:
    s_load_dwordx2 s[8:9], s[0:1], 64
    s_mov_b32 s10, 0x21c000
    s_mov_b32 s11, 0x00020000
    s_load_dwordx2 s[12:13], s[0:1], 64
    s_mov_b32 s14, 0x21c000
    s_mov_b32 s15, 0x00020000
    s_sub_u32 s71, s2, 112
    s_mul_i32 s59, s71, 5120
    s_add_u32 s59, s59, s29
    s_add_u32 s59, s59, 24641536
    s_mov_b32 s64, 1146880
    s_mul_i32 s76, s71, 147
    s_lshr_b32 s76, s76, 11
    s_mul_i32 s77, s76, 14
    s_sub_u32 s77, s71, s77
    s_add_u32 m0, s29, 61440
    s_add_u32 s82, s37, 3
    s_and_b32 s82, s82, 3
    s_lshl2_add_u32 s82, s20, s82
    s_mul_i32 s82, s82, 20480
    buffer_load_dwordx4 v240, s[16:19], s82 offen offset:0 lds
    s_lshr_b32 s72, s77, 1
    s_mul_i32 s72, s72, 112
    s_and_b32 s78, s77, 1
    s_lshl_b32 s78, s78, 5
    s_add_u32 s72, s72, s78
    s_mul_i32 s78, s77, 112
    s_sub_u32 s78, s78, 832
    s_cmp_ge_u32 s77, 8
    s_cselect_b32 s72, s78, s72
    s_mul_i32 s78, s77, 224
    s_sub_u32 s78, s78, 2592
    s_cmp_ge_u32 s77, 12
    s_cselect_b32 s72, s78, s72
    s_cselect_b32 s74, 112, 16
    s_mul_i32 s76, s76, 448
    s_add_u32 s72, s72, s76
    s_mov_b32 s73, 4
    s_mov_b32 s75, 8
k2_main_kernel_tcommon:
    s_add_u32 m0, s29, 24320
    s_nop 0
    buffer_load_dwordx4 v240, s[16:19], s51 offen offset:256 lds
    v_mad_u32_u24 v80, v11, s74, v80
    v_mad_u32_u24 v80, v12, s75, v80
    v_mul_u32_u24 v232, 1280, v80
    v_add_u32 v232, v232, v84
    v_mul_u32_u24 v81, 640, v81
    v_add_u32 v232, v232, v81
    v_mov_b32 v233, v232
    s_mul_i32 s73, s73, 1280
    s_mul_i32 s54, s72, 1280
    s_mul_i32 s76, s3, 32
    s_add_u32 s54, s54, s76
    s_lshr_b32 s63, s64, 2
    s_sub_u32 s63, s63, 1024
    s_movk_i32 s76, 4096
    s_add_u32 m0, s29, 44800
    s_nop 0
    buffer_load_dwordx4 v240, s[16:19], s62 offen offset:256 lds
    s_cmp_lt_u32 s2, 188
    s_cbranch_scc1 k2_main_kernel_treal
    s_mov_b32 s54, 0x10000000
    s_mov_b32 s59, s65
    s_mov_b32 s63, 0
    s_mov_b32 s64, 0
    s_mov_b32 s76, 0
    v_mov_b32 v236, 0
k2_main_kernel_treal:
    s_add_u32 s55, s54, 128
    s_add_u32 s56, s54, 256
    s_add_u32 s57, s54, 384
    s_add_u32 s58, s54, 512
    s_lshl_b32 s75, 0x42, s3
    s_branch k2_main_kernel_tdone
k2_main_kernel_t13:
    s_load_dwordx2 s[8:9], s[0:1], 48
    s_mov_b32 s10, 0x21c000
    s_mov_b32 s11, 0x00020000
    s_load_dwordx2 s[12:13], s[0:1], 56
    s_mov_b32 s14, 0x21c000
    s_mov_b32 s15, 0x00020000
    v_mul_u32_u24 v81, 80, v81
    v_add_u32 v80, v80, v81
    v_lshl_add_u32 v85, v11, 2, v80
    v_lshl_add_u32 v85, v12, 4, v85
    v_lshl_add_u32 v86, v11, 3, v80
    v_lshl_add_u32 v86, v12, 2, v86
    s_movk_i32 s76, 3456
    s_add_u32 m0, s29, 61440
    s_add_u32 s82, s37, 3
    s_and_b32 s82, s82, 3
    s_lshl2_add_u32 s82, s20, s82
    s_mul_i32 s82, s82, 20480
    buffer_load_dwordx4 v240, s[16:19], s82 offen offset:0 lds
    v_mad_u32_u24 v232, v85, s76, v84
    v_mad_u32_u24 v233, v86, s76, v84
    v_mov_b32 v237, v1
    s_and_b32 s77, s2, 0xfc
    s_add_u32 s77, s77, s3
    s_and_b32 s78, s2, 3
    s_lshl_b32 s78, s78, 1
    s_mul_i32 s54, s78, 276480
    s_lshl_b32 s76, s77, 5
    s_add_u32 s54, s54, s76
    s_cmp_ge_u32 s77, 108
    s_cselect_b32 s54, 0x10000000, s54
    s_add_u32 m0, s29, 24320
    s_nop 0
    buffer_load_dwordx4 v240, s[16:19], s51 offen offset:256 lds
    s_add_u32 s55, s54, 27648
    s_add_u32 s56, s54, 110592
    s_add_u32 s57, s54, 138240
    s_add_u32 s58, s54, 221184
    s_mul_i32 s71, s77, 293
    s_lshr_b32 s71, s71, 11
    s_mul_i32 s72, s71, 7
    s_sub_u32 s72, s77, s72
    s_cmp_ge_u32 s72, 3
    s_cselect_b32 s73, 1, 3
    s_cselect_b32 s74, 40, 2
    s_mul_i32 s74, s74, s72
    s_add_u32 m0, s29, 44800
    s_nop 0
    buffer_load_dwordx4 v240, s[16:19], s62 offen offset:256 lds
    s_mul_i32 s59, s78, 5
    s_mul_i32 s59, s59, s73
    s_add_u32 s59, s59, s74
    s_mul_i32 s75, s71, 280
    s_add_u32 s59, s59, s75
    s_lshl_b32 s59, s59, 10
    s_add_u32 s59, s59, 19922944
    s_movk_i32 s63, 1024
    s_lshl_b32 s64, s73, 12
    s_add_u32 s64, s64, s63
    s_lshl_b32 s76, s73, 11
    s_sub_u32 s76, s76, s63
    s_movk_i32 s75, 0x154
    s_lshl_b32 s65, s77, 10
    s_lshl1_add_u32 s65, s78, s65
    s_add_u32 s65, s65, 5767168
    s_mov_b32 s73, 0
k2_main_kernel_tdone:
    s_add_u32 m0, s29, 65280
    s_nop 0
    buffer_load_dwordx4 v240, s[16:19], s82 offen offset:256 lds
    v_add_u32 v234, s73, v232
    v_add_u32 v235, s73, v233
    s_add_u32 s64, s64, s59
    s_mul_i32 s66, s3, 10240
    s_add_u32 s66, s66, 122880
    v_lshl_add_u32 v238, v11, 10, v15
    v_lshl_add_u32 v238, v12, 8, v238
    v_add_u32 v238, s66, v238
    v_lshlrev_b32 v239, 7, v0
    s_lshl_b32 s67, s2, 7
    s_add_u32 s67, s67, 27656192
    s_lshl_b32 s100, s3, 13
    s_add_u32 s100, s100, 27656192
    s_mul_i32 s71, s21, 286720
    s_mul_i32 s36, s3, 71680
    s_add_u32 s71, s71, s36
    s_add_u32 s71, s71, 24641536
    s_add_u32 m0, s29, 28160
    s_nop 0
    buffer_load_dwordx4 v240, s[16:19], s51 offen offset:512 lds
    v_mul_u32_u24 v10, 1280, v10
    v_mul_u32_u24 v14, 160, v14
    v_lshl_add_u32 v10, v13, 4, v10
    v_sub_u32 v246, v10, v14
    s_mul_i32 s80, s3, 5120
    s_mul_i32 s69, s3, 40960
    s_mul_i32 s79, s21, 160
    s_add_u32 s69, s69, s79
    s_mul_i32 s31, s3, 5120
    s_mul_i32 s23, s21, 102400
    s_add_u32 s23, s23, 18874368
    v_add_u32 v9, s23, v1
    s_add_u32 m0, s29, 48640
    s_nop 0
    buffer_load_dwordx4 v240, s[16:19], s62 offen offset:512 lds
    v_mov_b32 v5, 0xdddddddd
    s_getreg_b32 s36, hwreg(HW_REG_XCC_ID, 0, 4)
    s_lshl_b32 s101, s38, 7
    s_add_u32 s101, s101, 27656192
    v_add_u32 v8, s36, v7
    v_and_b32 v10, 31, v0
    v_mul_u32_u24 v4, 320, v12
    v_lshl_add_u32 v4, v10, 4, v4
    v_add_u32 v4, 2560, v4
    v_mov_b32 v2, v1
    v_lshlrev_b32 v3, 3, v0
    v_add_u32 v3, 2048, v3
    s_add_u32 m0, s29, 69120
    s_nop 0
    buffer_load_dwordx4 v240, s[16:19], s82 offen offset:512 lds
    s_mov_b32 s42, 0x000fffff
    s_mov_b32 s43, 0x000fffff
    s_mov_b32 s41, 0
    s_mov_b32 vcc_lo, 0x11000000
    s_mov_b32 vcc_hi, 0x11000000
    v_mov_b32 v160, 0x3f803f80
    v_cndmask_b32 v160, 0, v160, vcc
    v_mov_b32 v161, v160
    v_mov_b64 v[162:163], v[160:161]
    v_mov_b64 v[164:165], v[160:161]
    v_mov_b64 v[166:167], v[160:161]
    v_mov_b64 v[168:169], v[160:161]
    s_add_u32 m0, s29, 32000
    s_nop 0
    buffer_load_dwordx4 v240, s[16:19], s51 offen offset:768 lds
    v_mov_b64 v[170:171], v[160:161]
    v_mov_b64 v[172:173], v[160:161]
    v_mov_b64 v[174:175], v[160:161]
    v_mov_b64 v[176:177], v[160:161]
    v_mov_b64 v[178:179], v[160:161]
    v_mov_b64 v[180:181], v[160:161]
    v_mov_b64 v[182:183], v[160:161]
    v_mov_b64 v[184:185], v[160:161]
    v_mov_b64 v[186:187], v[160:161]
    v_mov_b64 v[188:189], v[160:161]
    v_mov_b64 v[190:191], v[160:161]
    v_mov_b64 v[112:113], 0
    s_add_u32 m0, s29, 52480
    s_nop 0
    buffer_load_dwordx4 v240, s[16:19], s62 offen offset:768 lds
    v_mov_b64 v[114:115], 0
    v_mov_b64 v[116:117], 0
    v_mov_b64 v[118:119], 0
    v_mov_b64 v[120:121], 0
    v_mov_b64 v[122:123], 0
    v_mov_b64 v[124:125], 0
    v_mov_b64 v[126:127], 0
    v_mov_b64 v[128:129], 0
    v_mov_b64 v[130:131], 0
    v_mov_b64 v[132:133], 0
    v_mov_b64 v[134:135], 0
    v_mov_b64 v[136:137], 0
    s_add_u32 m0, s29, 72960
    s_nop 0
    buffer_load_dwordx4 v240, s[16:19], s82 offen offset:768 lds
    v_mov_b64 v[138:139], 0
    v_mov_b64 v[140:141], 0
    v_mov_b64 v[142:143], 0
    s_mov_b32 s60, 0x100001
    s_mov_b32 s61, 0x10000100
    s_mov_b32 s48, 0x200002
    s_mov_b32 s49, 0x20000200
    s_mov_b32 s32, 0x400004
    s_mov_b32 s33, 0x40000400
    s_mov_b32 s34, 0x800008
    s_mov_b32 s35, 0x80000800
    s_add_u32 m0, s29, 35840
    s_nop 0
    buffer_load_dwordx4 v240, s[16:19], s51 offen offset:1024 lds
    s_add_u32 m0, s29, 56320
    s_nop 0
    buffer_load_dwordx4 v240, s[16:19], s62 offen offset:1024 lds
    s_add_u32 m0, s29, 76800
    s_nop 0
    buffer_load_dwordx4 v240, s[16:19], s82 offen offset:1024 lds
    s_cmp_lg_u32 s83, 1
    s_cbranch_scc1 k2_main_kernel_ndb
    s_waitcnt vmcnt(27)
    buffer_store_dword v7, off, s[44:47], 0 sc1
k2_main_kernel_ndb:
    s_waitcnt lgkmcnt(0)
    s_waitcnt vmcnt(15)
    s_barrier
    ds_read_b128 v[56:59], v228 offset:0
    ds_read_b64_tr_b16 v[16:17], v241 offset:0
    ds_read_b64_tr_b16 v[18:19], v241 offset:160
    ds_read_b64_tr_b16 v[20:21], v241 offset:16
    ds_read_b64_tr_b16 v[22:23], v241 offset:176
    ds_read_b128 v[60:63], v228 offset:4096
    ds_read_b64_tr_b16 v[24:25], v241 offset:5120
    ds_read_b64_tr_b16 v[26:27], v241 offset:5280
    ds_read_b64_tr_b16 v[28:29], v241 offset:5136
    ds_read_b64_tr_b16 v[30:31], v241 offset:5296
    ds_read_b128 v[64:67], v228 offset:8192
    ds_read_b64_tr_b16 v[32:33], v241 offset:10240
    ds_read_b64_tr_b16 v[34:35], v241 offset:10400
    ds_read_b64_tr_b16 v[36:37], v241 offset:10256
    ds_read_b64_tr_b16 v[38:39], v241 offset:10416
    s_add_u32 m0, s80, 81920
    s_add_u32 s79, s69, 0
    buffer_load_dwordx4 v242, s[24:27], s79 offen lds
    s_waitcnt lgkmcnt(10)
    v_mfma_f32_16x16x32_bf16 v[208:211], v[108:111], v[56:59], 0
    ds_read_b128 v[68:71], v228 offset:12288
    v_mfma_f32_16x16x32_bf16 v[212:215], v[56:59], v[56:59], 0
    ds_read_b64_tr_b16 v[40:41], v241 offset:15360
    v_mfma_f32_16x16x32_bf16 v[192:195], v[16:19], v[56:59], 0
    ds_read_b64_tr_b16 v[42:43], v241 offset:15520
    s_add_u32 m0, s80, 82944
    s_nop 0
    buffer_load_dwordx4 v243, s[24:27], s79 offen lds
    v_mfma_f32_16x16x32_bf16 v[200:203], v[16:19], v[108:111], 0
    ds_read_b64_tr_b16 v[44:45], v241 offset:15376
    v_mfma_f32_16x16x32_bf16 v[196:199], v[20:23], v[56:59], 0
    ds_read_b64_tr_b16 v[46:47], v241 offset:15536
    v_mfma_f32_16x16x32_bf16 v[204:207], v[20:23], v[108:111], 0
    s_add_u32 m0, s80, 83968
    s_nop 0
    buffer_load_dwordx4 v244, s[24:27], s79 offen lds
    s_waitcnt lgkmcnt(10)
    v_mfma_f32_16x16x32_bf16 v[208:211], v[108:111], v[60:63], v[208:211]
    ds_read_b128 v[72:75], v228 offset:16384
    v_mfma_f32_16x16x32_bf16 v[212:215], v[60:63], v[60:63], v[212:215]
    ds_read_b64_tr_b16 v[48:49], v241 offset:20480
    v_mfma_f32_16x16x32_bf16 v[192:195], v[24:27], v[60:63], v[192:195]
    ds_read_b64_tr_b16 v[50:51], v241 offset:20640
    s_add_u32 m0, s80, 84992
    s_nop 0
    buffer_load_dwordx4 v245, s[24:27], s79 offen lds
    v_mfma_f32_16x16x32_bf16 v[200:203], v[24:27], v[108:111], v[200:203]
    ds_read_b64_tr_b16 v[52:53], v241 offset:20496
    v_mfma_f32_16x16x32_bf16 v[196:199], v[28:31], v[60:63], v[196:199]
    ds_read_b64_tr_b16 v[54:55], v241 offset:20656
    v_mfma_f32_16x16x32_bf16 v[204:207], v[28:31], v[108:111], v[204:207]
    s_add_u32 m0, s80, 86016
    s_nop 0
    buffer_load_dwordx4 v246, s[24:27], s79 offen lds
    s_waitcnt lgkmcnt(10)
    v_mfma_f32_16x16x32_bf16 v[208:211], v[108:111], v[64:67], v[208:211]
    v_mfma_f32_16x16x32_bf16 v[212:215], v[64:67], v[64:67], v[212:215]
    v_mfma_f32_16x16x32_bf16 v[192:195], v[32:35], v[64:67], v[192:195]
    v_mfma_f32_16x16x32_bf16 v[200:203], v[32:35], v[108:111], v[200:203]
    v_mfma_f32_16x16x32_bf16 v[196:199], v[36:39], v[64:67], v[196:199]
    v_mfma_f32_16x16x32_bf16 v[204:207], v[36:39], v[108:111], v[204:207]
    s_add_u32 m0, s80, 102400
    s_add_u32 s79, s69, 163840
    buffer_load_dwordx4 v242, s[24:27], s79 offen lds
    s_waitcnt lgkmcnt(5)
    v_mfma_f32_16x16x32_bf16 v[208:211], v[108:111], v[68:71], v[208:211]
    v_mfma_f32_16x16x32_bf16 v[212:215], v[68:71], v[68:71], v[212:215]
    v_mfma_f32_16x16x32_bf16 v[192:195], v[40:43], v[68:71], v[192:195]
    v_mfma_f32_16x16x32_bf16 v[200:203], v[40:43], v[108:111], v[200:203]
    v_mfma_f32_16x16x32_bf16 v[196:199], v[44:47], v[68:71], v[196:199]
    v_mfma_f32_16x16x32_bf16 v[204:207], v[44:47], v[108:111], v[204:207]
    s_add_u32 m0, s80, 103424
    s_nop 0
    buffer_load_dwordx4 v243, s[24:27], s79 offen lds
    s_waitcnt lgkmcnt(0)
    v_mfma_f32_16x16x32_bf16 v[208:211], v[108:111], v[72:75], v[208:211]
    v_mfma_f32_16x16x32_bf16 v[212:215], v[72:75], v[72:75], v[212:215]
    v_mfma_f32_16x16x32_bf16 v[192:195], v[48:51], v[72:75], v[192:195]
    v_mfma_f32_16x16x32_bf16 v[200:203], v[48:51], v[108:111], v[200:203]
    v_mfma_f32_16x16x32_bf16 v[196:199], v[52:55], v[72:75], v[196:199]
    v_mfma_f32_16x16x32_bf16 v[204:207], v[52:55], v[108:111], v[204:207]
    s_add_u32 m0, s80, 104448
    s_nop 0
    buffer_load_dwordx4 v244, s[24:27], s79 offen lds
    s_mul_i32 s36, s70, 4608
    s_add_u32 s36, s36, 144896
    v_add_u32 v10, s36, v1
    v_lshl_add_u32 v14, v0, 3, s36
    v_cndmask_b32 v212, 0, v212, s[60:61]
    v_cndmask_b32 v212, v212, v213, s[48:49]
    v_cndmask_b32 v212, v212, v214, s[32:33]
    v_cndmask_b32 v212, v212, v215, s[34:35]
    v_mov_b32 v209, v212
    s_cmp_eq_u32 s70, 0
    s_cbranch_scc1 k2_main_kernel_nwr
    ds_write_b64 v14, v[208:209] offset:4096
    ds_write_b128 v10, v[192:195] offset:0
    ds_write_b128 v10, v[196:199] offset:1024
    ds_write_b128 v10, v[200:203] offset:2048
    ds_write_b128 v10, v[204:207] offset:3072
    s_branch k2_main_kernel_nwx
k2_main_kernel_nwr:
    ds_read_b128 a[32:35], v224 offset:0
    ds_read_b128 a[36:39], v225 offset:0
    ds_read_b128 a[40:43], v226 offset:0
    ds_read_b128 a[44:47], v227 offset:0
    ds_read_b128 a[48:51], v224 offset:4096
    ds_read_b128 a[52:55], v225 offset:4096
    ds_read_b128 a[56:59], v226 offset:4096
    ds_read_b128 a[60:63], v227 offset:4096
    ds_read_b128 a[64:67], v224 offset:8192
    ds_read_b128 a[68:71], v225 offset:8192
    ds_read_b128 a[72:75], v226 offset:8192
    ds_read_b128 a[76:79], v227 offset:8192
    ds_read_b128 a[80:83], v224 offset:12288
    ds_read_b128 a[84:87], v225 offset:12288
    ds_read_b128 a[88:91], v226 offset:12288
    ds_read_b128 a[92:95], v227 offset:12288
    ds_read_b128 a[96:99], v224 offset:16384
    ds_read_b128 a[100:103], v225 offset:16384
    ds_read_b128 a[104:107], v226 offset:16384
    ds_read_b128 a[108:111], v227 offset:16384
k2_main_kernel_nwx:
    s_waitcnt vmcnt(8)
    s_waitcnt lgkmcnt(0)
    s_barrier
    s_cmp_lg_u32 s70, 0
    s_cbranch_scc1 k2_main_kernel_nkv
    ds_read_b64 v[66:67], v14 offset:8704
    ds_read_b64 v[68:69], v14 offset:13312
    ds_read_b64 v[70:71], v14 offset:17920
    ds_read_b128 v[16:19], v10 offset:4608
    ds_read_b128 v[20:23], v10 offset:5632
    ds_read_b128 v[24:27], v10 offset:6656
    ds_read_b128 v[28:31], v10 offset:7680
    ds_read_b128 v[32:35], v10 offset:9216
    ds_read_b128 v[36:39], v10 offset:10240
    ds_read_b128 v[40:43], v10 offset:11264
    ds_read_b128 v[44:47], v10 offset:12288
    ds_read_b128 v[48:51], v10 offset:13824
    ds_read_b128 v[52:55], v10 offset:14848
    ds_read_b128 v[56:59], v10 offset:15872
    ds_read_b128 v[60:63], v10 offset:16896
    s_mul_i32 s36, s20, 5120
    s_add_u32 s36, s36, 5570560
    s_waitcnt lgkmcnt(12)
    v_add_f32 v208, v208, v66
    v_add_f32 v209, v209, v67
    v_add_f32 v208, v208, v68
    v_add_f32 v209, v209, v69
    v_add_f32 v208, v208, v70
    v_add_f32 v209, v209, v71
    v_mov_b32 v210, v209
    v_mul_f32 v216, 0.0015625, v208
    s_nop 0
    v_permlane32_swap_b32 v209, v210
    v_add_f32 v209, v209, v210
    v_mov_b32 v210, v209
    v_mul_f32 v218, v216, v216
    v_mov_b32 v219, 0.0015625
    v_permlane16_swap_b32 v209, v210
    v_add_f32 v209, v209, v210
    v_fma_f32 v218, v209, v219, -v218
    v_add_f32 v218, 1e-05, v218
    v_rsq_f32 v217, v218
    s_waitcnt lgkmcnt(8)
    v_pk_add_f32 v[192:193], v[192:193], v[16:17]
    v_pk_add_f32 v[194:195], v[194:195], v[18:19]
    v_pk_add_f32 v[196:197], v[196:197], v[20:21]
    v_pk_add_f32 v[198:199], v[198:199], v[22:23]
    v_pk_add_f32 v[200:201], v[200:201], v[24:25]
    v_pk_add_f32 v[202:203], v[202:203], v[26:27]
    v_pk_add_f32 v[204:205], v[204:205], v[28:29]
    v_pk_add_f32 v[206:207], v[206:207], v[30:31]
    s_waitcnt lgkmcnt(4)
    v_pk_add_f32 v[192:193], v[192:193], v[32:33]
    v_pk_add_f32 v[194:195], v[194:195], v[34:35]
    v_pk_add_f32 v[196:197], v[196:197], v[36:37]
    v_pk_add_f32 v[198:199], v[198:199], v[38:39]
    v_pk_add_f32 v[200:201], v[200:201], v[40:41]
    v_pk_add_f32 v[202:203], v[202:203], v[42:43]
    v_pk_add_f32 v[204:205], v[204:205], v[44:45]
    v_pk_add_f32 v[206:207], v[206:207], v[46:47]
    s_waitcnt lgkmcnt(0)
    v_pk_add_f32 v[192:193], v[192:193], v[48:49]
    v_pk_add_f32 v[194:195], v[194:195], v[50:51]
    v_pk_add_f32 v[196:197], v[196:197], v[52:53]
    v_pk_add_f32 v[198:199], v[198:199], v[54:55]
    v_pk_add_f32 v[200:201], v[200:201], v[56:57]
    v_pk_add_f32 v[202:203], v[202:203], v[58:59]
    v_pk_add_f32 v[204:205], v[204:205], v[60:61]
    v_pk_add_f32 v[206:207], v[206:207], v[62:63]
    v_fma_f32 v192, -v216, v200, v192
    v_fma_f32 v193, -v216, v201, v193
    v_fma_f32 v194, -v216, v202, v194
    v_fma_f32 v195, -v216, v203, v195
    v_fma_f32 v196, -v216, v204, v196
    v_fma_f32 v197, -v216, v205, v197
    v_fma_f32 v198, -v216, v206, v198
    v_fma_f32 v199, -v216, v207, v199
    v_mul_f32 v192, v192, v217
    v_mul_f32 v193, v193, v217
    v_mul_f32 v194, v194, v217
    v_mul_f32 v195, v195, v217
    v_mul_f32 v196, v196, v217
    v_mul_f32 v197, v197, v217
    v_mul_f32 v198, v198, v217
    v_mul_f32 v199, v199, v217
    v_cvt_pk_bf16_f32 v200, v192, v193
    v_cvt_pk_bf16_f32 v201, v194, v195
    v_cvt_pk_bf16_f32 v202, v196, v197
    v_cvt_pk_bf16_f32 v203, v198, v199
    s_bitcmp1_b32 s21, 0
    s_cbranch_scc1 k2_main_kernel_kvv
    s_lshr_b32 s40, s37, 1
    s_lshl_b32 s40, s40, 10
    s_and_b32 s78, s37, 1
    s_lshl_b32 s78, s78, 8
    s_add_u32 s40, s40, s78
    s_add_u32 s40, s40, s36
    v_lshlrev_b32 v219, 1, v15
    v_lshl_add_u32 v219, v11, 9, v219
    s_lshl_b32 s37, s37, 7
    s_add_u32 s37, s37, s36
    s_mov_b32 exec_hi, 0
    buffer_store_dwordx4 v[200:203], v219, s[4:7], s40 offen sc1
    s_mov_b32 exec_hi, 0xffff
    s_mov_b32 exec_lo, 0
    buffer_store_dwordx2 v[200:201], v15, s[4:7], s37 offen offset:2048 sc1
    s_branch k2_main_kernel_kvd
k2_main_kernel_kvv:
    v_mov_b32 v218, 149504
    v_lshl_add_u32 v218, v12, 5, v218
    v_lshl_add_u32 v219, v15, 3, v218
    v_lshl_add_u32 v219, v11, 3, v219
    ds_write_b64 v219, v[200:201]
    ds_write_b64 v219, v[202:203] offset:16
    v_bfe_u32 v219, v0, 2, 2
    v_lshl_add_u32 v219, v11, 3, v219
    v_lshl_add_u32 v219, v219, 6, v218
    v_and_b32 v220, 3, v0
    v_lshl_add_u32 v219, v220, 3, v219
    s_waitcnt lgkmcnt(0)
    ds_read_b64_tr_b16 v[200:201], v219
    ds_read_b64_tr_b16 v[202:203], v219 offset:256
    v_mul_u32_u24 v219, 320, v11
    v_lshl_add_u32 v219, v12, 8, v219
    v_lshl_add_u32 v219, v15, 1, v219
    s_mul_i32 s37, s37, 640
    s_add_u32 s37, s37, s36
    s_mov_b32 exec_hi, 0x000f000f
    s_waitcnt lgkmcnt(0)
    buffer_store_dwordx4 v[200:203], v219, s[4:7], s37 offen offset:2560 sc1
k2_main_kernel_kvd:
    s_mov_b64 exec, -1
    buffer_load_dword v13, off, s[44:47], 0 sc1
    ds_read_b128 a[112:115], v153 offset:0
    ds_read_b128 a[116:119], v154 offset:0
    s_add_u32 m0, s80, 105472
    s_nop 0
    buffer_load_dwordx4 v245, s[24:27], s79 offen lds
    ds_read_b128 a[120:123], v155 offset:0
    ds_read_b128 a[124:127], v156 offset:0
    s_add_u32 m0, s80, 106496
    s_nop 0
    buffer_load_dwordx4 v246, s[24:27], s79 offen lds
    ds_read_b128 a[128:131], v153 offset:4096
    ds_read_b128 a[132:135], v154 offset:4096
    s_add_u32 m0, s80, 122880
    s_add_u32 s79, s69, 327680
    buffer_load_dwordx4 v242, s[24:27], s79 offen lds
    ds_read_b128 a[136:139], v155 offset:4096
    ds_read_b128 a[140:143], v156 offset:4096
    s_add_u32 m0, s80, 123904
    s_nop 0
    buffer_load_dwordx4 v243, s[24:27], s79 offen lds
    ds_read_b128 a[144:147], v153 offset:8192
    ds_read_b128 a[148:151], v154 offset:8192
    s_add_u32 m0, s80, 124928
    s_nop 0
    buffer_load_dwordx4 v244, s[24:27], s79 offen lds
    s_add_u32 m0, s80, 125952
    s_nop 0
    buffer_load_dwordx4 v245, s[24:27], s79 offen lds
    s_branch k2_main_kernel_kvj
k2_main_kernel_nkv:
    ds_read_b128 a[32:35], v224 offset:0
    ds_read_b128 a[36:39], v225 offset:0
    ds_read_b128 a[40:43], v226 offset:0
    ds_read_b128 a[44:47], v227 offset:0
    ds_read_b128 a[48:51], v224 offset:4096
    ds_read_b128 a[52:55], v225 offset:4096
    ds_read_b128 a[56:59], v226 offset:4096
    ds_read_b128 a[60:63], v227 offset:4096
    ds_read_b128 a[64:67], v224 offset:8192
    ds_read_b128 a[68:71], v225 offset:8192
    ds_read_b128 a[72:75], v226 offset:8192
    ds_read_b128 a[76:79], v227 offset:8192
    ds_read_b128 a[80:83], v224 offset:12288
    ds_read_b128 a[84:87], v225 offset:12288
    s_waitcnt lgkmcnt(13)
    v_mfma_f32_16x16x32_bf16 v[104:107], v[108:111], a[32:35], 0
    v_mfma_f32_16x16x32_bf16 v[192:195], a[32:35], a[32:35], 0
    ds_read_b128 a[88:91], v226 offset:12288
    s_add_u32 m0, s80, 105472
    s_nop 0
    buffer_load_dwordx4 v245, s[24:27], s79 offen lds
    s_waitcnt lgkmcnt(13)
    v_mfma_f32_16x16x32_bf16 v[104:107], v[108:111], a[36:39], v[104:107]
    v_mfma_f32_16x16x32_bf16 v[192:195], a[36:39], a[36:39], v[192:195]
    ds_read_b128 a[92:95], v227 offset:12288
    s_waitcnt lgkmcnt(13)
    v_mfma_f32_16x16x32_bf16 v[104:107], v[108:111], a[40:43], v[104:107]
    v_mfma_f32_16x16x32_bf16 v[192:195], a[40:43], a[40:43], v[192:195]
    ds_read_b128 a[96:99], v224 offset:16384
    s_waitcnt lgkmcnt(13)
    v_mfma_f32_16x16x32_bf16 v[104:107], v[108:111], a[44:47], v[104:107]
    v_mfma_f32_16x16x32_bf16 v[192:195], a[44:47], a[44:47], v[192:195]
    ds_read_b128 a[100:103], v225 offset:16384
    s_add_u32 m0, s80, 106496
    s_nop 0
    buffer_load_dwordx4 v246, s[24:27], s79 offen lds
    s_waitcnt lgkmcnt(13)
    v_mfma_f32_16x16x32_bf16 v[104:107], v[108:111], a[48:51], v[104:107]
    v_mfma_f32_16x16x32_bf16 v[192:195], a[48:51], a[48:51], v[192:195]
    ds_read_b128 a[104:107], v226 offset:16384
    s_waitcnt lgkmcnt(13)
    v_mfma_f32_16x16x32_bf16 v[104:107], v[108:111], a[52:55], v[104:107]
    v_mfma_f32_16x16x32_bf16 v[192:195], a[52:55], a[52:55], v[192:195]
    ds_read_b128 a[108:111], v227 offset:16384
    s_waitcnt lgkmcnt(13)
    v_mfma_f32_16x16x32_bf16 v[104:107], v[108:111], a[56:59], v[104:107]
    v_mfma_f32_16x16x32_bf16 v[192:195], a[56:59], a[56:59], v[192:195]
    ds_read_b128 a[112:115], v153 offset:0
    s_add_u32 m0, s80, 122880
    s_add_u32 s79, s69, 327680
    buffer_load_dwordx4 v242, s[24:27], s79 offen lds
    s_waitcnt lgkmcnt(13)
    v_mfma_f32_16x16x32_bf16 v[104:107], v[108:111], a[60:63], v[104:107]
    v_mfma_f32_16x16x32_bf16 v[192:195], a[60:63], a[60:63], v[192:195]
    ds_read_b128 a[116:119], v154 offset:0
    s_waitcnt lgkmcnt(13)
    v_mfma_f32_16x16x32_bf16 v[104:107], v[108:111], a[64:67], v[104:107]
    v_mfma_f32_16x16x32_bf16 v[192:195], a[64:67], a[64:67], v[192:195]
    ds_read_b128 a[120:123], v155 offset:0
    s_waitcnt lgkmcnt(13)
    v_mfma_f32_16x16x32_bf16 v[104:107], v[108:111], a[68:71], v[104:107]
    v_mfma_f32_16x16x32_bf16 v[192:195], a[68:71], a[68:71], v[192:195]
    ds_read_b128 a[124:127], v156 offset:0
    s_add_u32 m0, s80, 123904
    s_nop 0
    buffer_load_dwordx4 v243, s[24:27], s79 offen lds
    s_waitcnt lgkmcnt(13)
    v_mfma_f32_16x16x32_bf16 v[104:107], v[108:111], a[72:75], v[104:107]
    v_mfma_f32_16x16x32_bf16 v[192:195], a[72:75], a[72:75], v[192:195]
    ds_read_b128 a[128:131], v153 offset:4096
    s_waitcnt lgkmcnt(13)
    v_mfma_f32_16x16x32_bf16 v[104:107], v[108:111], a[76:79], v[104:107]
    v_mfma_f32_16x16x32_bf16 v[192:195], a[76:79], a[76:79], v[192:195]
    ds_read_b128 a[132:135], v154 offset:4096
    s_waitcnt lgkmcnt(13)
    v_mfma_f32_16x16x32_bf16 v[104:107], v[108:111], a[80:83], v[104:107]
    v_mfma_f32_16x16x32_bf16 v[192:195], a[80:83], a[80:83], v[192:195]
    ds_read_b128 a[136:139], v155 offset:4096
    s_add_u32 m0, s80, 124928
    s_nop 0
    buffer_load_dwordx4 v244, s[24:27], s79 offen lds
    s_waitcnt lgkmcnt(13)
    v_mfma_f32_16x16x32_bf16 v[104:107], v[108:111], a[84:87], v[104:107]
    v_mfma_f32_16x16x32_bf16 v[192:195], a[84:87], a[84:87], v[192:195]
    ds_read_b128 a[140:143], v156 offset:4096
    s_waitcnt lgkmcnt(13)
    v_mfma_f32_16x16x32_bf16 v[104:107], v[108:111], a[88:91], v[104:107]
    v_mfma_f32_16x16x32_bf16 v[192:195], a[88:91], a[88:91], v[192:195]
    ds_read_b128 a[144:147], v153 offset:8192
    s_waitcnt lgkmcnt(13)
    v_mfma_f32_16x16x32_bf16 v[104:107], v[108:111], a[92:95], v[104:107]
    v_mfma_f32_16x16x32_bf16 v[192:195], a[92:95], a[92:95], v[192:195]
    ds_read_b128 a[148:151], v154 offset:8192
    s_add_u32 m0, s80, 125952
    s_nop 0
    buffer_load_dwordx4 v245, s[24:27], s79 offen lds
    s_waitcnt lgkmcnt(13)
    v_mfma_f32_16x16x32_bf16 v[104:107], v[108:111], a[96:99], v[104:107]
    v_mfma_f32_16x16x32_bf16 v[192:195], a[96:99], a[96:99], v[192:195]
    s_waitcnt lgkmcnt(12)
    v_mfma_f32_16x16x32_bf16 v[104:107], v[108:111], a[100:103], v[104:107]
    v_mfma_f32_16x16x32_bf16 v[192:195], a[100:103], a[100:103], v[192:195]
    s_waitcnt lgkmcnt(11)
    v_mfma_f32_16x16x32_bf16 v[104:107], v[108:111], a[104:107], v[104:107]
    v_mfma_f32_16x16x32_bf16 v[192:195], a[104:107], a[104:107], v[192:195]
    s_waitcnt lgkmcnt(10)
    v_mfma_f32_16x16x32_bf16 v[104:107], v[108:111], a[108:111], v[104:107]
    v_mfma_f32_16x16x32_bf16 v[192:195], a[108:111], a[108:111], v[192:195]
    s_nop 7
    v_cndmask_b32 v192, 0, v192, s[60:61]
    v_cndmask_b32 v192, v192, v193, s[48:49]
    v_cndmask_b32 v192, v192, v194, s[32:33]
    v_cndmask_b32 v192, v192, v195, s[34:35]
    v_mov_b32 v193, v192
    v_mul_f32 v216, 0.0015625, v104
    s_nop 0
    v_permlane32_swap_b32 v192, v193
    v_add_f32 v192, v192, v193
    v_mov_b32 v193, v192
    v_mul_f32 v218, v216, v216
    v_mov_b32 v219, 0.0015625
    v_permlane16_swap_b32 v192, v193
    v_add_f32 v192, v192, v193
    v_fma_f32 v218, v192, v219, -v218
    v_add_f32 v218, 1e-05, v218
    v_rsq_f32 v217, v218
k2_main_kernel_kvj:
    s_lshl3_add_u32 s83, s20, s21
    s_lshl2_add_u32 s83, s83, s3
    s_mul_i32 s83, s83, 2560
    s_add_u32 s83, s83, 6029312
    s_lshl_b32 s36, s3, 9
    v_add_u32 v10, s36, v3
    v_mul_f32 v217, 0.32259641822295604, v217
    v_xor_b32 v14, 512, v10
    s_and_b32 s40, s3, 2
    s_mul_i32 s40, s40, 5120
    s_sub_u32 s36, 10240, s40
    v_add_u32 v100, s36, v247
    v_add_u32 v101, s36, v248
    v_add_u32 v102, s36, v249
    v_add_u32 v103, s36, v250
    v_add_u32 v247, s40, v247
    v_add_u32 v248, s40, v248
    v_add_u32 v249, s40, v249
    v_add_u32 v250, s40, v250
    v_lshrrev_b32 v254, 4, v0
    v_lshlrev_b32 v254, 7, v254
    v_and_b32 v220, 15, v0
    v_lshl_add_u32 v254, v220, 2, v254
    s_lshl_b32 s36, s3, 9
    v_add_u32 v254, s36, v254
    s_cmp_lg_u32 s70, 0
    s_cbranch_scc1 k2_main_kernel_nfl
    s_mov_b64 exec, 0
    s_branch k2_main_kernel_pad_P3
k2_main_kernel_tr_k0:
    s_mov_b64 exec, -1
    s_waitcnt vmcnt(6)
    v_cmp_eq_u32 vcc, 0, v13
    s_lshr_b32 s36, s2, 4
    s_lshl_b32 s36, s36, 7
    s_and_b32 s40, s2, 15
    s_lshl2_add_u32 s36, s40, s36
    s_add_u32 s36, s36, s68
    s_cbranch_vccnz k2_main_kernel_dp
k2_main_kernel_dpx:
    buffer_store_dword v7, off, s[4:7], s36 sc1
k2_main_kernel_nfl:
    s_load_dwordx2 s[44:45], s[0:1], 72
    s_mov_b32 s46, 0x280000
    s_mov_b32 s47, 0x00020000
    s_mov_b64 exec, 0
    s_cmp_eq_u32 s70, 0
    s_cbranch_scc1 k2_main_kernel_tr_gp0
    s_cmp_eq_u32 s70, 1
    s_cbranch_scc1 k2_main_kernel_pad_P4
    s_cmp_eq_u32 s70, 2
    s_cbranch_scc1 k2_main_kernel_pad_P5
    s_branch k2_main_kernel_pad_P6
k2_main_kernel_tr_gp0:
    s_mov_b64 exec, -1
    s_waitcnt vmcnt(9)
    s_barrier
    ds_read_b64_tr_b16 v[16:17], v247 offset:0
    ds_read_b64_tr_b16 v[18:19], v248 offset:0
    ds_read_b64_tr_b16 v[20:21], v247 offset:16
    ds_read_b64_tr_b16 v[22:23], v248 offset:16
    s_add_u32 m0, s80, 126976
    ds_read_b64_tr_b16 v[24:25], v249 offset:32
    ds_read_b64_tr_b16 v[26:27], v250 offset:32
    ds_read_b64_tr_b16 v[28:29], v247 offset:5120
    ds_read_b64_tr_b16 v[30:31], v248 offset:5120
    s_waitcnt lgkmcnt(6)
    v_mfma_f32_16x16x32_bf16 v[88:91], v[16:19], v[108:111], 0
    buffer_load_dwordx4 v246, s[24:27], s79 offen lds
    v_mfma_f32_16x16x32_bf16 v[64:67], v[16:19], a[32:35], 0
    s_add_u32 m0, s80, 143360
    ds_read_b128 a[152:155], v155 offset:8192
    ds_read_b64_tr_b16 v[32:33], v247 offset:5136
    v_mfma_f32_16x16x32_bf16 v[76:79], v[16:19], a[112:115], 0
    s_waitcnt lgkmcnt(6)
    ds_read_b64_tr_b16 v[34:35], v248 offset:5136
    ds_read_b128 a[156:159], v156 offset:8192
    v_mfma_f32_16x16x32_bf16 v[92:95], v[20:23], v[108:111], 0
    s_add_u32 s79, s69, 491520
    ds_read_b128 a[160:163], v153 offset:12288
    ds_read_b64_tr_b16 v[36:37], v249 offset:5152
    v_mfma_f32_16x16x32_bf16 v[68:71], v[20:23], a[32:35], 0
    buffer_load_dwordx4 v242, s[24:27], s79 offen lds
    v_mfma_f32_16x16x32_bf16 v[80:83], v[20:23], a[112:115], 0
    s_waitcnt lgkmcnt(8)
    ds_read_b64_tr_b16 v[38:39], v250 offset:5152
    ds_read_b128 a[164:167], v154 offset:12288
    v_mfma_f32_16x16x32_bf16 v[96:99], v[24:27], v[108:111], 0
    s_add_u32 m0, s80, 144384
    ds_read_b128 a[168:171], v155 offset:12288
    ds_read_b64_tr_b16 v[40:41], v100 offset:0
    v_mfma_f32_16x16x32_bf16 v[72:75], v[24:27], a[32:35], 0
    ds_read_b64_tr_b16 v[42:43], v101 offset:0
    ds_read_b128 a[172:175], v156 offset:12288
    v_mfma_f32_16x16x32_bf16 v[84:87], v[24:27], a[112:115], 0
    s_waitcnt lgkmcnt(12)
    buffer_load_dwordx4 v243, s[24:27], s79 offen lds
    v_mfma_f32_16x16x32_bf16 v[88:91], v[28:31], v[108:111], v[88:91]
    s_add_u32 m0, s80, 145408
    ds_read_b128 a[176:179], v153 offset:16384
    ds_read_b64_tr_b16 v[44:45], v100 offset:16
    v_mfma_f32_16x16x32_bf16 v[64:67], v[28:31], a[36:39], v[64:67]
    ds_read_b64_tr_b16 v[46:47], v101 offset:16
    ds_read_b128 a[180:183], v154 offset:16384
    v_mfma_f32_16x16x32_bf16 v[76:79], v[28:31], a[116:119], v[76:79]
    s_waitcnt lgkmcnt(10)
    ds_read_b64_tr_b16 v[48:49], v102 offset:32
    ds_read_b64_tr_b16 v[50:51], v103 offset:32
    v_mfma_f32_16x16x32_bf16 v[92:95], v[32:35], v[108:111], v[92:95]
    buffer_load_dwordx4 v244, s[24:27], s79 offen lds
    v_mfma_f32_16x16x32_bf16 v[68:71], v[32:35], a[36:39], v[68:71]
    s_add_u32 m0, s80, 146432
    ds_read_b128 a[184:187], v155 offset:16384
    ds_read_b128 a[188:191], v156 offset:16384
    v_mfma_f32_16x16x32_bf16 v[80:83], v[32:35], a[116:119], v[80:83]
    s_waitcnt lgkmcnt(10)
    ds_read_b64_tr_b16 v[52:53], v100 offset:5120
    ds_read_b64_tr_b16 v[54:55], v101 offset:5120
    v_mfma_f32_16x16x32_bf16 v[96:99], v[36:39], v[108:111], v[96:99]
    ds_read_b64_tr_b16 v[56:57], v100 offset:5136
    ds_read_b64_tr_b16 v[58:59], v101 offset:5136
    v_mfma_f32_16x16x32_bf16 v[72:75], v[36:39], a[36:39], v[72:75]
    buffer_load_dwordx4 v245, s[24:27], s79 offen lds
    v_mfma_f32_16x16x32_bf16 v[84:87], v[36:39], a[116:119], v[84:87]
    s_waitcnt lgkmcnt(10)
    ds_read_b64 a[22:23], v144
    ds_read_b64 a[24:25], v145
    v_mfma_f32_16x16x32_bf16 v[64:67], v[40:43], a[40:43], v[64:67]
    s_add_u32 m0, s80, 147456
    ds_read_b64_tr_b16 v[60:61], v102 offset:5152
    ds_read_b64_tr_b16 v[62:63], v103 offset:5152
    v_mfma_f32_16x16x32_bf16 v[76:79], v[40:43], a[120:123], v[76:79]
    s_waitcnt lgkmcnt(10)
    ds_read_b64 a[26:27], v146
    ds_read_b64 a[28:29], v147
    v_mfma_f32_16x16x32_bf16 v[68:71], v[44:47], a[40:43], v[68:71]
    s_waitcnt vmcnt(9)
    s_barrier
    ds_read_b64_tr_b16 v[16:17], v247 offset:20480
    v_mfma_f32_16x16x32_bf16 v[80:83], v[44:47], a[120:123], v[80:83]
    ds_read_b64_tr_b16 v[18:19], v248 offset:20480
    ds_read_b64 a[30:31], v148
    v_mfma_f32_16x16x32_bf16 v[72:75], v[48:51], a[40:43], v[72:75]
    buffer_load_dwordx4 v246, s[24:27], s79 offen lds
    v_mfma_f32_16x16x32_bf16 v[84:87], v[48:51], a[120:123], v[84:87]
    s_waitcnt lgkmcnt(9)
    ds_read_b64_tr_b16 v[20:21], v247 offset:20496
    ds_read_b64_tr_b16 v[22:23], v248 offset:20496
    v_mfma_f32_16x16x32_bf16 v[64:67], v[52:55], a[44:47], v[64:67]
    ds_read_b64_tr_b16 v[24:25], v249 offset:20512
    ds_read_b64_tr_b16 v[26:27], v250 offset:20512
    v_mfma_f32_16x16x32_bf16 v[76:79], v[52:55], a[124:127], v[76:79]
    ds_read_b64_tr_b16 v[28:29], v247 offset:25600
    ds_read_b64_tr_b16 v[30:31], v248 offset:25600
    v_mfma_f32_16x16x32_bf16 v[68:71], v[56:59], a[44:47], v[68:71]
    ds_read_b64_tr_b16 v[32:33], v247 offset:25616
    ds_read_b64_tr_b16 v[34:35], v248 offset:25616
    v_mfma_f32_16x16x32_bf16 v[80:83], v[56:59], a[124:127], v[80:83]
    s_waitcnt lgkmcnt(11)
    ds_read_b64_tr_b16 v[36:37], v249 offset:25632
    ds_read_b64_tr_b16 v[38:39], v250 offset:25632
    v_mfma_f32_16x16x32_bf16 v[72:75], v[60:63], a[44:47], v[72:75]
    ds_read_b64_tr_b16 v[40:41], v100 offset:20480
    v_mfma_f32_16x16x32_bf16 v[84:87], v[60:63], a[124:127], v[84:87]
    s_waitcnt lgkmcnt(11)
    ds_read_b64_tr_b16 v[42:43], v101 offset:20480
    v_mfma_f32_16x16x32_bf16 v[88:91], v[16:19], v[108:111], v[88:91]
    ds_read_b64_tr_b16 v[44:45], v100 offset:20496
    v_mfma_f32_16x16x32_bf16 v[64:67], v[16:19], a[48:51], v[64:67]
    ds_read_b64_tr_b16 v[46:47], v101 offset:20496
    v_mfma_f32_16x16x32_bf16 v[76:79], v[16:19], a[128:131], v[76:79]
    s_waitcnt lgkmcnt(10)
    ds_read_b64_tr_b16 v[48:49], v102 offset:20512
    v_mfma_f32_16x16x32_bf16 v[92:95], v[20:23], v[108:111], v[92:95]
    ds_read_b64_tr_b16 v[50:51], v103 offset:20512
    v_mfma_f32_16x16x32_bf16 v[68:71], v[20:23], a[48:51], v[68:71]
    ds_read_b64_tr_b16 v[52:53], v100 offset:25600
    v_mfma_f32_16x16x32_bf16 v[80:83], v[20:23], a[128:131], v[80:83]
    ds_read_b64_tr_b16 v[54:55], v101 offset:25600
    v_mfma_f32_16x16x32_bf16 v[96:99], v[24:27], v[108:111], v[96:99]
    ds_read_b64_tr_b16 v[56:57], v100 offset:25616
    v_mfma_f32_16x16x32_bf16 v[72:75], v[24:27], a[48:51], v[72:75]
    ds_read_b64_tr_b16 v[58:59], v101 offset:25616
    v_mfma_f32_16x16x32_bf16 v[84:87], v[24:27], a[128:131], v[84:87]
    s_waitcnt lgkmcnt(7)
    ds_read_b64_tr_b16 v[60:61], v102 offset:25632
    v_mfma_f32_16x16x32_bf16 v[88:91], v[28:31], v[108:111], v[88:91]
    ds_read_b64_tr_b16 v[62:63], v103 offset:25632
    v_mfma_f32_16x16x32_bf16 v[64:67], v[28:31], a[52:55], v[64:67]
    s_waitcnt vmcnt(5)
    s_barrier
    ds_write_b64 v10, v[216:217] offset:40960
    v_mfma_f32_16x16x32_bf16 v[76:79], v[28:31], a[132:135], v[76:79]
    s_add_u32 m0, s80, 81920
    v_add_u32 v247, 40960, v247
    v_mfma_f32_16x16x32_bf16 v[92:95], v[32:35], v[108:111], v[92:95]
    s_add_u32 s79, s69, 655360
    v_add_u32 v248, 40960, v248
    v_add_u32 v249, 40960, v249
    v_mfma_f32_16x16x32_bf16 v[68:71], v[32:35], a[52:55], v[68:71]
    buffer_load_dwordx4 v242, s[24:27], s79 offen lds
    v_mfma_f32_16x16x32_bf16 v[80:83], v[32:35], a[132:135], v[80:83]
    s_add_u32 m0, s80, 82944
    v_add_u32 v250, 40960, v250
    ds_read_b64_tr_b16 v[16:17], v247 offset:0
    v_mfma_f32_16x16x32_bf16 v[96:99], v[36:39], v[108:111], v[96:99]
    ds_read_b64_tr_b16 v[18:19], v248 offset:0
    ds_read_b64_tr_b16 v[20:21], v247 offset:16
    v_mfma_f32_16x16x32_bf16 v[72:75], v[36:39], a[52:55], v[72:75]
    ds_read_b64_tr_b16 v[22:23], v248 offset:16
    v_mfma_f32_16x16x32_bf16 v[84:87], v[36:39], a[132:135], v[84:87]
    buffer_load_dwordx4 v243, s[24:27], s79 offen lds
    v_mfma_f32_16x16x32_bf16 v[64:67], v[40:43], a[56:59], v[64:67]
    s_add_u32 m0, s80, 83968
    buffer_load_dword v220, v254, s[4:7], s68 offen sc1
    v_mfma_f32_16x16x32_bf16 v[76:79], v[40:43], a[136:139], v[76:79]
    s_waitcnt lgkmcnt(4)
    ds_read_b64_tr_b16 v[24:25], v249 offset:32
    ds_read_b64_tr_b16 v[26:27], v250 offset:32
    v_mfma_f32_16x16x32_bf16 v[68:71], v[44:47], a[56:59], v[68:71]
    ds_read_b64_tr_b16 v[28:29], v247 offset:5120
    v_mfma_f32_16x16x32_bf16 v[80:83], v[44:47], a[136:139], v[80:83]
    buffer_load_dwordx4 v244, s[24:27], s79 offen lds
    v_mfma_f32_16x16x32_bf16 v[72:75], v[48:51], a[56:59], v[72:75]
    s_add_u32 m0, s80, 84992
    ds_read_b64_tr_b16 v[30:31], v248 offset:5120
    v_mfma_f32_16x16x32_bf16 v[84:87], v[48:51], a[136:139], v[84:87]
    ds_read_b64_tr_b16 v[32:33], v247 offset:5136
    v_mfma_f32_16x16x32_bf16 v[64:67], v[52:55], a[60:63], v[64:67]
    ds_read_b64_tr_b16 v[34:35], v248 offset:5136
    v_mfma_f32_16x16x32_bf16 v[76:79], v[52:55], a[140:143], v[76:79]
    buffer_load_dwordx4 v245, s[24:27], s79 offen lds
    v_mfma_f32_16x16x32_bf16 v[68:71], v[56:59], a[60:63], v[68:71]
    s_add_u32 m0, s80, 86016
    ds_read_b64_tr_b16 v[36:37], v249 offset:5152
    v_mfma_f32_16x16x32_bf16 v[80:83], v[56:59], a[140:143], v[80:83]
    ds_read_b64_tr_b16 v[38:39], v250 offset:5152
    v_mfma_f32_16x16x32_bf16 v[72:75], v[60:63], a[60:63], v[72:75]
    v_add_u32 v100, 40960, v100
    v_mfma_f32_16x16x32_bf16 v[84:87], v[60:63], a[140:143], v[84:87]
    s_waitcnt lgkmcnt(5)
    buffer_load_dwordx4 v246, s[24:27], s79 offen lds
    v_mfma_f32_16x16x32_bf16 v[88:91], v[16:19], v[108:111], v[88:91]
    v_add_u32 v101, 40960, v101
    v_add_u32 v102, 40960, v102
    v_mfma_f32_16x16x32_bf16 v[64:67], v[16:19], a[64:67], v[64:67]
    v_add_u32 v103, 40960, v103
    ds_read_b64_tr_b16 v[40:41], v100 offset:0
    v_mfma_f32_16x16x32_bf16 v[76:79], v[16:19], a[144:147], v[76:79]
    ds_read_b64_tr_b16 v[42:43], v101 offset:0
    ds_read_b64_tr_b16 v[44:45], v100 offset:16
    v_mfma_f32_16x16x32_bf16 v[92:95], v[20:23], v[108:111], v[92:95]
    ds_read_b64_tr_b16 v[46:47], v101 offset:16
    v_mfma_f32_16x16x32_bf16 v[68:71], v[20:23], a[64:67], v[68:71]
    ds_read_b64_tr_b16 v[48:49], v102 offset:32
    ds_read_b64_tr_b16 v[50:51], v103 offset:32
    v_mfma_f32_16x16x32_bf16 v[80:83], v[20:23], a[144:147], v[80:83]
    ds_read_b64_tr_b16 v[52:53], v100 offset:5120
    v_mfma_f32_16x16x32_bf16 v[96:99], v[24:27], v[108:111], v[96:99]
    ds_read_b64_tr_b16 v[54:55], v101 offset:5120
    v_mfma_f32_16x16x32_bf16 v[72:75], v[24:27], a[64:67], v[72:75]
    ds_read_b64_tr_b16 v[56:57], v100 offset:5136
    v_mfma_f32_16x16x32_bf16 v[84:87], v[24:27], a[144:147], v[84:87]
    s_waitcnt lgkmcnt(9)
    ds_read_b64_tr_b16 v[58:59], v101 offset:5136
    v_mfma_f32_16x16x32_bf16 v[88:91], v[28:31], v[108:111], v[88:91]
    ds_read_b64_tr_b16 v[60:61], v102 offset:5152
    v_mfma_f32_16x16x32_bf16 v[64:67], v[28:31], a[68:71], v[64:67]
    ds_read_b64_tr_b16 v[62:63], v103 offset:5152
    v_mfma_f32_16x16x32_bf16 v[76:79], v[28:31], a[148:151], v[76:79]
    s_waitcnt vmcnt(6)
    s_barrier
    ds_read_b64 v[218:219], v14 offset:40960
    v_mfma_f32_16x16x32_bf16 v[92:95], v[32:35], v[108:111], v[92:95]
    ds_read_b64_tr_b16 v[16:17], v247 offset:20480
    ds_read_b64_tr_b16 v[18:19], v248 offset:20480
    v_mfma_f32_16x16x32_bf16 v[68:71], v[32:35], a[68:71], v[68:71]
    ds_read_b64_tr_b16 v[20:21], v247 offset:20496
    v_mfma_f32_16x16x32_bf16 v[80:83], v[32:35], a[148:151], v[80:83]
    ds_read_b64_tr_b16 v[22:23], v248 offset:20496
    v_mfma_f32_16x16x32_bf16 v[96:99], v[36:39], v[108:111], v[96:99]
    ds_read_b64_tr_b16 v[24:25], v249 offset:20512
    v_mfma_f32_16x16x32_bf16 v[72:75], v[36:39], a[68:71], v[72:75]
    ds_read_b64_tr_b16 v[26:27], v250 offset:20512
    v_mfma_f32_16x16x32_bf16 v[84:87], v[36:39], a[148:151], v[84:87]
    s_waitcnt lgkmcnt(8)
    ds_read_b64_tr_b16 v[28:29], v247 offset:25600
    v_mfma_f32_16x16x32_bf16 v[64:67], v[40:43], a[72:75], v[64:67]
    ds_read_b64_tr_b16 v[30:31], v248 offset:25600
    v_mfma_f32_16x16x32_bf16 v[76:79], v[40:43], a[152:155], v[76:79]
    ds_read_b64_tr_b16 v[32:33], v247 offset:25616
    v_mfma_f32_16x16x32_bf16 v[68:71], v[44:47], a[72:75], v[68:71]
k2_main_kernel_pad_P2:
    s_cbranch_execz k2_main_kernel_tr_k0
    ds_read_b64_tr_b16 v[34:35], v248 offset:25616
    v_mfma_f32_16x16x32_bf16 v[80:83], v[44:47], a[152:155], v[80:83]
    ds_read_b64_tr_b16 v[36:37], v249 offset:25632
    v_mfma_f32_16x16x32_bf16 v[72:75], v[48:51], a[72:75], v[72:75]
    ds_read_b64_tr_b16 v[38:39], v250 offset:25632
    v_mfma_f32_16x16x32_bf16 v[84:87], v[48:51], a[152:155], v[84:87]
    ds_read_b64_tr_b16 v[40:41], v100 offset:20480
    v_mfma_f32_16x16x32_bf16 v[64:67], v[52:55], a[76:79], v[64:67]
    ds_read_b64_tr_b16 v[42:43], v101 offset:20480
    v_mfma_f32_16x16x32_bf16 v[76:79], v[52:55], a[156:159], v[76:79]
    ds_read_b64_tr_b16 v[44:45], v100 offset:20496
    v_mfma_f32_16x16x32_bf16 v[68:71], v[56:59], a[76:79], v[68:71]
    ds_read_b64_tr_b16 v[46:47], v101 offset:20496
    v_mfma_f32_16x16x32_bf16 v[80:83], v[56:59], a[156:159], v[80:83]
    s_waitcnt lgkmcnt(7)
    ds_read_b64_tr_b16 v[48:49], v102 offset:20512
    v_mfma_f32_16x16x32_bf16 v[72:75], v[60:63], a[76:79], v[72:75]
    ds_read_b64_tr_b16 v[50:51], v103 offset:20512
    v_mfma_f32_16x16x32_bf16 v[84:87], v[60:63], a[156:159], v[84:87]
    ds_read_b64_tr_b16 v[52:53], v100 offset:25600
    s_waitcnt vmcnt(3)
    v_cmp_eq_u32 vcc, 0, v220
    s_cbranch_vccnz k2_main_kernel_kp
k2_main_kernel_kpx:
    s_barrier
    v_mfma_f32_16x16x32_bf16 v[88:91], v[16:19], v[108:111], v[88:91]
    s_add_u32 m0, s53, 0
    ds_read_b64_tr_b16 v[54:55], v101 offset:25600
    v_mfma_f32_16x16x32_bf16 v[64:67], v[16:19], a[80:83], v[64:67]
    buffer_load_dwordx4 v6, s[4:7], m0 offen offset:0 sc1 lds
    v_mfma_f32_16x16x32_bf16 v[76:79], v[16:19], a[160:163], v[76:79]
    ds_read_b64_tr_b16 v[56:57], v100 offset:25616
    v_mfma_f32_16x16x32_bf16 v[92:95], v[20:23], v[108:111], v[92:95]
    buffer_load_dwordx4 v6, s[4:7], m0 offen offset:1024 sc1 lds
    v_mfma_f32_16x16x32_bf16 v[68:71], v[20:23], a[80:83], v[68:71]
    ds_read_b64_tr_b16 v[58:59], v101 offset:25616
    v_mfma_f32_16x16x32_bf16 v[80:83], v[20:23], a[160:163], v[80:83]
    buffer_load_dwordx4 v6, s[4:7], m0 offen offset:2048 sc1 lds
    v_mfma_f32_16x16x32_bf16 v[96:99], v[24:27], v[108:111], v[96:99]
    ds_read_b64_tr_b16 v[60:61], v102 offset:25632
    v_mfma_f32_16x16x32_bf16 v[72:75], v[24:27], a[80:83], v[72:75]
    buffer_load_dwordx4 v6, s[4:7], m0 offen offset:3072 sc1 lds
    v_mfma_f32_16x16x32_bf16 v[84:87], v[24:27], a[160:163], v[84:87]
    s_add_u32 m0, s53, 16384
    ds_read_b64_tr_b16 v[62:63], v103 offset:25632
    v_mfma_f32_16x16x32_bf16 v[88:91], v[28:31], v[108:111], v[88:91]
    buffer_load_dwordx4 v6, s[4:7], m0 offen offset:0 sc1 lds
    v_mfma_f32_16x16x32_bf16 v[64:67], v[28:31], a[84:87], v[64:67]
    s_waitcnt vmcnt(5)
    s_barrier
    v_mfma_f32_16x16x32_bf16 v[76:79], v[28:31], a[164:167], v[76:79]
    s_waitcnt lgkmcnt(3)
    buffer_load_dwordx4 v6, s[4:7], m0 offen offset:1024 sc1 lds
    v_mfma_f32_16x16x32_bf16 v[92:95], v[32:35], v[108:111], v[92:95]
    v_add_u32 v247, 4294926336, v247
    v_add_u32 v248, 4294926336, v248
    v_mfma_f32_16x16x32_bf16 v[68:71], v[32:35], a[84:87], v[68:71]
    buffer_load_dwordx4 v6, s[4:7], m0 offen offset:2048 sc1 lds
    v_mfma_f32_16x16x32_bf16 v[80:83], v[32:35], a[164:167], v[80:83]
    v_add_u32 v249, 4294926336, v249
    v_add_u32 v250, 4294926336, v250
    v_mfma_f32_16x16x32_bf16 v[96:99], v[36:39], v[108:111], v[96:99]
    buffer_load_dwordx4 v6, s[4:7], m0 offen offset:3072 sc1 lds
    v_mfma_f32_16x16x32_bf16 v[72:75], v[36:39], a[84:87], v[72:75]
    ds_read_b64_tr_b16 v[16:17], v247 offset:0
    ds_read_b64_tr_b16 v[18:19], v248 offset:0
    v_mfma_f32_16x16x32_bf16 v[84:87], v[36:39], a[164:167], v[84:87]
    ds_read_b64_tr_b16 v[20:21], v247 offset:16
    ds_read_b64_tr_b16 v[22:23], v248 offset:16
    v_mfma_f32_16x16x32_bf16 v[64:67], v[40:43], a[88:91], v[64:67]
    ds_read_b64_tr_b16 v[24:25], v249 offset:32
    ds_read_b64_tr_b16 v[26:27], v250 offset:32
    v_mfma_f32_16x16x32_bf16 v[76:79], v[40:43], a[168:171], v[76:79]
    ds_read_b64_tr_b16 v[28:29], v247 offset:5120
    v_mfma_f32_16x16x32_bf16 v[68:71], v[44:47], a[88:91], v[68:71]
    ds_read_b64_tr_b16 v[30:31], v248 offset:5120
    v_mfma_f32_16x16x32_bf16 v[80:83], v[44:47], a[168:171], v[80:83]
    ds_read_b64_tr_b16 v[32:33], v247 offset:5136
    v_mfma_f32_16x16x32_bf16 v[72:75], v[48:51], a[88:91], v[72:75]
    ds_read_b64_tr_b16 v[34:35], v248 offset:5136
    v_mfma_f32_16x16x32_bf16 v[84:87], v[48:51], a[168:171], v[84:87]
    ds_read_b64_tr_b16 v[36:37], v249 offset:5152
    v_mfma_f32_16x16x32_bf16 v[64:67], v[52:55], a[92:95], v[64:67]
    ds_read_b64_tr_b16 v[38:39], v250 offset:5152
    v_mfma_f32_16x16x32_bf16 v[76:79], v[52:55], a[172:175], v[76:79]
    s_waitcnt lgkmcnt(8)
    v_add_u32 v100, 4294926336, v100
    v_mfma_f32_16x16x32_bf16 v[68:71], v[56:59], a[92:95], v[68:71]
    v_add_u32 v101, 4294926336, v101
    v_mfma_f32_16x16x32_bf16 v[80:83], v[56:59], a[172:175], v[80:83]
    v_add_u32 v102, 4294926336, v102
    v_mfma_f32_16x16x32_bf16 v[72:75], v[60:63], a[92:95], v[72:75]
    v_add_u32 v103, 4294926336, v103
    v_mfma_f32_16x16x32_bf16 v[84:87], v[60:63], a[172:175], v[84:87]
    ds_read_b64_tr_b16 v[40:41], v100 offset:0
    v_mfma_f32_16x16x32_bf16 v[88:91], v[16:19], v[108:111], v[88:91]
    ds_read_b64_tr_b16 v[42:43], v101 offset:0
    v_mfma_f32_16x16x32_bf16 v[64:67], v[16:19], a[96:99], v[64:67]
    ds_read_b64_tr_b16 v[44:45], v100 offset:16
    v_mfma_f32_16x16x32_bf16 v[76:79], v[16:19], a[176:179], v[76:79]
    ds_read_b64_tr_b16 v[46:47], v101 offset:16
    v_mfma_f32_16x16x32_bf16 v[92:95], v[20:23], v[108:111], v[92:95]
    ds_read_b64_tr_b16 v[48:49], v102 offset:32
    v_mfma_f32_16x16x32_bf16 v[68:71], v[20:23], a[96:99], v[68:71]
    ds_read_b64_tr_b16 v[50:51], v103 offset:32
    v_mfma_f32_16x16x32_bf16 v[80:83], v[20:23], a[176:179], v[80:83]
    s_waitcnt lgkmcnt(6)
    ds_read_b64_tr_b16 v[52:53], v100 offset:5120
    v_mfma_f32_16x16x32_bf16 v[96:99], v[24:27], v[108:111], v[96:99]
    ds_read_b64_tr_b16 v[54:55], v101 offset:5120
    v_mfma_f32_16x16x32_bf16 v[72:75], v[24:27], a[96:99], v[72:75]
    ds_read_b64_tr_b16 v[56:57], v100 offset:5136
    v_mfma_f32_16x16x32_bf16 v[84:87], v[24:27], a[176:179], v[84:87]
    ds_read_b64_tr_b16 v[58:59], v101 offset:5136
    v_mfma_f32_16x16x32_bf16 v[88:91], v[28:31], v[108:111], v[88:91]
    ds_read_b64_tr_b16 v[60:61], v102 offset:5152
    v_mfma_f32_16x16x32_bf16 v[64:67], v[28:31], a[100:103], v[64:67]
    ds_read_b64_tr_b16 v[62:63], v103 offset:5152
    v_mfma_f32_16x16x32_bf16 v[76:79], v[28:31], a[180:183], v[76:79]
    v_mfma_f32_16x16x32_bf16 v[92:95], v[32:35], v[108:111], v[92:95]
    s_mul_i32 s36, s3, 3072
    s_add_u32 s36, s36, 102400
    v_mfma_f32_16x16x32_bf16 v[68:71], v[32:35], a[100:103], v[68:71]
    v_add_u32 v204, s36, v1
    s_xor_b32 s40, s3, 2
    v_mfma_f32_16x16x32_bf16 v[80:83], v[32:35], a[180:183], v[80:83]
    s_mul_i32 s36, s40, 3072
    s_add_u32 s36, s36, 102400
    v_mfma_f32_16x16x32_bf16 v[96:99], v[36:39], v[108:111], v[96:99]
    v_add_u32 v205, s36, v1
    v_mfma_f32_16x16x32_bf16 v[72:75], v[36:39], a[100:103], v[72:75]
    ds_write_b128 v204, v[88:91] offset:0
    v_mfma_f32_16x16x32_bf16 v[84:87], v[36:39], a[180:183], v[84:87]
    s_waitcnt lgkmcnt(2)
    v_mfma_f32_16x16x32_bf16 v[64:67], v[40:43], a[104:107], v[64:67]
    ds_write_b128 v204, v[92:95] offset:1024
    v_mfma_f32_16x16x32_bf16 v[76:79], v[40:43], a[184:187], v[76:79]
    v_mfma_f32_16x16x32_bf16 v[68:71], v[44:47], a[104:107], v[68:71]
    ds_write_b128 v204, v[96:99] offset:2048
    v_mfma_f32_16x16x32_bf16 v[80:83], v[44:47], a[184:187], v[80:83]
    v_mfma_f32_16x16x32_bf16 v[72:75], v[48:51], a[104:107], v[72:75]
    s_waitcnt lgkmcnt(0)
    s_waitcnt vmcnt(4)
    s_barrier
    v_mfma_f32_16x16x32_bf16 v[84:87], v[48:51], a[184:187], v[84:87]
    ds_read_b128 v[192:195], v205 offset:0
    ds_read_b128 v[196:199], v205 offset:1024
    v_mfma_f32_16x16x32_bf16 v[64:67], v[52:55], a[108:111], v[64:67]
    ds_read_b128 v[200:203], v205 offset:2048
    ds_read_b128 a[0:3], v2 offset:0
    v_mfma_f32_16x16x32_bf16 v[76:79], v[52:55], a[188:191], v[76:79]
    ds_read_b128 a[4:7], v2 offset:1024
    ds_read_b64 a[8:9], v3 offset:0
    v_mfma_f32_16x16x32_bf16 v[68:71], v[56:59], a[108:111], v[68:71]
    ds_read_b128 a[12:15], v2 offset:5120
    ds_read_b128 a[16:19], v2 offset:6144
    v_mfma_f32_16x16x32_bf16 v[80:83], v[56:59], a[188:191], v[80:83]
    ds_read_b64 a[20:21], v3 offset:5120
    s_mov_b64 exec, s[42:43]
    ds_read_b128 v[160:163], v4 offset:0
    ds_read_b128 v[164:167], v4 offset:640
    ds_read_b128 v[168:171], v4 offset:1280
    ds_read_b128 v[172:175], v4 offset:1920
    s_mov_b64 exec, -1
    v_mfma_f32_16x16x32_bf16 v[72:75], v[60:63], a[108:111], v[72:75]
    v_mfma_f32_16x16x32_bf16 v[84:87], v[60:63], a[188:191], v[84:87]
    s_waitcnt lgkmcnt(10)
    v_pk_add_f32 v[88:89], v[88:89], v[192:193]
    v_pk_add_f32 v[90:91], v[90:91], v[194:195]
    v_pk_add_f32 v[92:93], v[92:93], v[196:197]
    v_pk_add_f32 v[94:95], v[94:95], v[198:199]
    v_pk_add_f32 v[96:97], v[96:97], v[200:201]
    v_pk_add_f32 v[98:99], v[98:99], v[202:203]
    s_mov_b32 vcc_lo, 0
    s_mov_b32 vcc_hi, -1
    s_nop 0
    v_pk_fma_f32 v[64:65], v[88:89], v[216:217], v[64:65] op_sel_hi:[1,0,1] neg_lo:[0,1,0] neg_hi:[0,1,0]
    v_pk_fma_f32 v[66:67], v[90:91], v[216:217], v[66:67] op_sel_hi:[1,0,1] neg_lo:[0,1,0] neg_hi:[0,1,0]
    v_pk_fma_f32 v[68:69], v[92:93], v[216:217], v[68:69] op_sel_hi:[1,0,1] neg_lo:[0,1,0] neg_hi:[0,1,0]
    v_pk_fma_f32 v[70:71], v[94:95], v[216:217], v[70:71] op_sel_hi:[1,0,1] neg_lo:[0,1,0] neg_hi:[0,1,0]
    v_pk_fma_f32 v[72:73], v[96:97], v[216:217], v[72:73] op_sel_hi:[1,0,1] neg_lo:[0,1,0] neg_hi:[0,1,0]
    v_pk_fma_f32 v[74:75], v[98:99], v[216:217], v[74:75] op_sel_hi:[1,0,1] neg_lo:[0,1,0] neg_hi:[0,1,0]
    v_pk_mul_f32 v[64:65], v[64:65], v[216:217] op_sel:[0,1]
    v_pk_mul_f32 v[66:67], v[66:67], v[216:217] op_sel:[0,1]
    v_pk_mul_f32 v[68:69], v[68:69], v[216:217] op_sel:[0,1]
    v_pk_mul_f32 v[70:71], v[70:71], v[216:217] op_sel:[0,1]
    v_pk_mul_f32 v[72:73], v[72:73], v[216:217] op_sel:[0,1]
    v_pk_mul_f32 v[74:75], v[74:75], v[216:217] op_sel:[0,1]
    v_cvt_pk_bf16_f32 v144, v64, v65
    v_cvt_pk_bf16_f32 v145, v66, v67
    v_cvt_pk_bf16_f32 v146, v68, v69
    v_cvt_pk_bf16_f32 v147, v70, v71
    v_cvt_pk_bf16_f32 v148, v72, v73
    v_cvt_pk_bf16_f32 v149, v74, v75
    v_cndmask_b32 v150, v148, 0, vcc
    v_cndmask_b32 v151, v149, 0, vcc
    s_waitcnt lgkmcnt(7)
    v_mfma_f32_32x32x16_bf16 v[16:31], a[0:3], v[144:147], 0
    v_pk_fma_f32 v[76:77], v[88:89], v[218:219], v[76:77] op_sel_hi:[1,0,1] neg_lo:[0,1,0] neg_hi:[0,1,0]
    v_pk_fma_f32 v[78:79], v[90:91], v[218:219], v[78:79] op_sel_hi:[1,0,1] neg_lo:[0,1,0] neg_hi:[0,1,0]
    v_pk_fma_f32 v[80:81], v[92:93], v[218:219], v[80:81] op_sel_hi:[1,0,1] neg_lo:[0,1,0] neg_hi:[0,1,0]
    v_pk_fma_f32 v[82:83], v[94:95], v[218:219], v[82:83] op_sel_hi:[1,0,1] neg_lo:[0,1,0] neg_hi:[0,1,0]
    v_pk_fma_f32 v[84:85], v[96:97], v[218:219], v[84:85] op_sel_hi:[1,0,1] neg_lo:[0,1,0] neg_hi:[0,1,0]
    v_pk_fma_f32 v[86:87], v[98:99], v[218:219], v[86:87] op_sel_hi:[1,0,1] neg_lo:[0,1,0] neg_hi:[0,1,0]
    v_pk_mul_f32 v[76:77], v[76:77], v[218:219] op_sel:[0,1]
    v_pk_mul_f32 v[78:79], v[78:79], v[218:219] op_sel:[0,1]
    v_pk_mul_f32 v[80:81], v[80:81], v[218:219] op_sel:[0,1]
    v_pk_mul_f32 v[82:83], v[82:83], v[218:219] op_sel:[0,1]
    v_mfma_f32_32x32x8_bf16 v[16:31], a[8:9], v[150:151], v[16:31]
    v_pk_mul_f32 v[84:85], v[84:85], v[218:219] op_sel:[0,1]
    v_pk_mul_f32 v[86:87], v[86:87], v[218:219] op_sel:[0,1]
    v_cvt_pk_bf16_f32 v152, v76, v77
    v_cvt_pk_bf16_f32 v153, v78, v79
    v_cvt_pk_bf16_f32 v154, v80, v81
    v_cvt_pk_bf16_f32 v155, v82, v83
    v_cvt_pk_bf16_f32 v156, v84, v85
    v_cvt_pk_bf16_f32 v157, v86, v87
    v_cndmask_b32 v158, v156, 0, vcc
    v_cndmask_b32 v159, v157, 0, vcc
    v_mfma_f32_32x32x16_bf16 v[48:63], a[0:3], v[152:155], 0
    s_nop 0
    v_max3_f32 v10, v16, v17, v18
    v_max3_f32 v11, v16, v17, v18
    s_nop 1
    v_permlane32_swap_b32 v10, v11
    v_min_f32 v80, -v10, -v11
    v_min_f32 v81, -v10, -v11
    v_mov_b64 v[82:83], v[80:81]
    v_mov_b64 v[84:85], v[80:81]
    v_mov_b64 v[86:87], v[80:81]
    v_mov_b64 v[88:89], v[80:81]
    v_mov_b64 v[90:91], v[80:81]
    v_mov_b64 v[92:93], v[80:81]
    v_mov_b64 v[94:95], v[80:81]
    v_mfma_f32_32x32x8_bf16 v[48:63], a[8:9], v[158:159], v[48:63]
    s_nop 0
    v_mfma_f32_32x32x16_bf16 v[16:31], a[0:3], v[144:147], v[80:95]
    v_mfma_f32_32x32x16_bf16 v[32:47], a[4:7], v[144:147], v[80:95]
    s_nop 9
    v_mfma_f32_32x32x4_2b_bf16 v[16:47], a[8:9], v[148:149], v[16:47]
    v_max3_f32 v12, v48, v49, v50
    v_max3_f32 v13, v48, v49, v50
    s_nop 1
    v_permlane32_swap_b32 v12, v13
    v_min_f32 v96, -v12, -v13
    v_min_f32 v97, -v12, -v13
    v_mov_b64 v[98:99], v[96:97]
    v_mov_b64 v[100:101], v[96:97]
    v_mov_b64 v[102:103], v[96:97]
    v_mov_b64 v[104:105], v[96:97]
    v_mov_b64 v[106:107], v[96:97]
    v_mov_b64 v[108:109], v[96:97]
    v_mov_b64 v[110:111], v[96:97]
    s_nop 4
    v_mfma_f32_32x32x16_bf16 v[48:63], a[0:3], v[152:155], v[96:111]
    s_add_u32 m0, s53, 32768
    v_exp_f32 v16, v16
    v_exp_f32 v17, v17
    v_exp_f32 v18, v18
    s_waitcnt lgkmcnt(0)
    v_exp_f32 v19, v19
    v_exp_f32 v20, v20
    v_exp_f32 v21, v21
    v_mfma_f32_32x32x16_bf16 v[64:79], a[4:7], v[152:155], v[96:111]
    buffer_load_dwordx4 v6, s[4:7], m0 offen offset:0 sc1 lds
    v_exp_f32 v22, v22
    v_exp_f32 v23, v23
    v_exp_f32 v24, v24
    v_exp_f32 v25, v25
    v_smfmac_f32_32x32x32_bf16 v[112:127], v[160:163], v[16:23], v5
    v_exp_f32 v26, v26
    v_exp_f32 v27, v27
    v_exp_f32 v28, v28
    v_exp_f32 v29, v29
    v_exp_f32 v30, v30
    v_mfma_f32_32x32x4_2b_bf16 v[48:79], a[8:9], v[156:157], v[48:79]
    buffer_load_dwordx4 v6, s[4:7], m0 offen offset:1024 sc1 lds
    v_exp_f32 v31, v31
    v_exp_f32 v32, v32
    v_exp_f32 v33, v33
    v_exp_f32 v34, v34
    v_exp_f32 v35, v35
    v_exp_f32 v36, v36
    v_exp_f32 v37, v37
    v_exp_f32 v38, v38
    v_smfmac_f32_32x32x32_bf16 v[112:127], v[164:167], v[24:31], v5
    v_exp_f32 v39, v39
    v_exp_f32 v40, v40
    v_exp_f32 v41, v41
    v_exp_f32 v42, v42
    v_smfmac_f32_32x32x32_bf16 v[112:127], v[168:171], v[32:39], v5
    s_nop 0
    buffer_load_dwordx4 v6, s[4:7], m0 offen offset:2048 sc1 lds
    v_exp_f32 v43, v43
    v_exp_f32 v44, v44
    v_exp_f32 v45, v45
    v_exp_f32 v46, v46
    v_exp_f32 v47, v47
    v_mfma_f32_32x32x16_bf16 v[16:31], a[12:15], v[144:147], v[80:95]
    ds_read_b128 a[0:3], v2 offset:10240
    v_exp_f32 v48, v48
    v_exp_f32 v49, v49
    v_exp_f32 v50, v50
    v_smfmac_f32_32x32x32_bf16 v[112:127], v[172:175], v[40:47], v5
    s_mov_b64 exec, s[42:43]
    ds_read_b128 v[176:179], v4 offset:5120
    ds_read_b128 v[180:183], v4 offset:5760
    ds_read_b128 v[184:187], v4 offset:6400
    ds_read_b128 v[188:191], v4 offset:7040
    s_mov_b64 exec, -1
    v_exp_f32 v51, v51
    v_exp_f32 v52, v52
    v_exp_f32 v53, v53
    v_mfma_f32_32x32x16_bf16 v[32:47], a[16:19], v[144:147], v[80:95]
    buffer_load_dwordx4 v6, s[4:7], m0 offen offset:3072 sc1 lds
    v_exp_f32 v54, v54
    v_exp_f32 v55, v55
    v_exp_f32 v56, v56
    v_exp_f32 v57, v57
    v_smfmac_f32_32x32x32_bf16 v[128:143], v[160:163], v[48:55], v5
    s_add_u32 m0, s66, 0
    ds_read_b128 a[4:7], v2 offset:11264
    ds_read_b64 a[8:9], v3 offset:10240
    v_exp_f32 v58, v58
    v_exp_f32 v59, v59
    v_exp_f32 v60, v60
    v_exp_f32 v61, v61
    v_exp_f32 v62, v62
    v_mfma_f32_32x32x4_2b_bf16 v[16:47], a[20:21], v[148:149], v[16:47]
    buffer_load_dwordx4 v232, s[8:11], s54 offen lds
    v_exp_f32 v63, v63
    v_exp_f32 v64, v64
    v_exp_f32 v65, v65
    v_exp_f32 v66, v66
    v_exp_f32 v67, v67
    v_exp_f32 v68, v68
    v_exp_f32 v69, v69
    v_exp_f32 v70, v70
    v_smfmac_f32_32x32x32_bf16 v[128:143], v[164:167], v[56:63], v5
    s_add_u32 m0, s66, 1024
    v_exp_f32 v71, v71
    v_exp_f32 v72, v72
    v_exp_f32 v73, v73
    v_exp_f32 v74, v74
    v_smfmac_f32_32x32x32_bf16 v[128:143], v[168:171], v[64:71], v5
    s_nop 0
    buffer_load_dwordx4 v234, s[12:15], s54 offen lds
    v_exp_f32 v75, v75
    v_exp_f32 v76, v76
    v_exp_f32 v77, v77
    v_exp_f32 v78, v78
    v_exp_f32 v79, v79
    v_mfma_f32_32x32x16_bf16 v[48:63], a[12:15], v[152:155], v[96:111]
    s_waitcnt vmcnt(6)
    s_barrier
    s_add_u32 m0, s66, 2048
    v_exp_f32 v16, v16
    v_exp_f32 v17, v17
    v_exp_f32 v18, v18
    v_smfmac_f32_32x32x32_bf16 v[128:143], v[172:175], v[72:79], v5
    s_waitcnt lgkmcnt(0)
    v_exp_f32 v19, v19
    v_exp_f32 v20, v20
    v_exp_f32 v21, v21
    v_mfma_f32_32x32x16_bf16 v[64:79], a[16:19], v[152:155], v[96:111]
    buffer_load_dwordx4 v232, s[8:11], s55 offen lds
    v_exp_f32 v22, v22
    v_exp_f32 v23, v23
    v_exp_f32 v24, v24
    v_exp_f32 v25, v25
    v_smfmac_f32_32x32x32_bf16 v[112:127], v[176:179], v[16:23], v5
    s_add_u32 m0, s66, 3072
    v_exp_f32 v26, v26
    v_exp_f32 v27, v27
    v_exp_f32 v28, v28
    v_exp_f32 v29, v29
    v_exp_f32 v30, v30
    v_mfma_f32_32x32x4_2b_bf16 v[48:79], a[20:21], v[156:157], v[48:79]
    buffer_load_dwordx4 v234, s[12:15], s55 offen lds
    v_exp_f32 v31, v31
    v_exp_f32 v32, v32
    v_exp_f32 v33, v33
    v_exp_f32 v34, v34
    v_exp_f32 v35, v35
    v_exp_f32 v36, v36
    v_exp_f32 v37, v37
    v_exp_f32 v38, v38
    v_smfmac_f32_32x32x32_bf16 v[112:127], v[180:183], v[24:31], v5
    s_add_u32 m0, s66, 4096
    v_exp_f32 v39, v39
    v_exp_f32 v40, v40
    v_exp_f32 v41, v41
    v_exp_f32 v42, v42
    v_smfmac_f32_32x32x32_bf16 v[112:127], v[184:187], v[32:39], v5
    s_nop 0
    buffer_load_dwordx4 v232, s[8:11], s56 offen lds
    v_exp_f32 v43, v43
    v_exp_f32 v44, v44
    v_exp_f32 v45, v45
    v_exp_f32 v46, v46
    v_exp_f32 v47, v47
    v_mfma_f32_32x32x16_bf16 v[16:31], a[0:3], v[144:147], v[80:95]
    s_add_u32 m0, s66, 5120
    ds_read_b128 a[12:15], v2 offset:15360
    v_exp_f32 v48, v48
    v_exp_f32 v49, v49
    v_exp_f32 v50, v50
    v_smfmac_f32_32x32x32_bf16 v[112:127], v[188:191], v[40:47], v5
    s_mov_b64 exec, s[42:43]
    ds_read_b128 v[160:163], v4 offset:10240
    ds_read_b128 v[164:167], v4 offset:10880
    ds_read_b128 v[168:171], v4 offset:11520
    ds_read_b128 v[172:175], v4 offset:12160
    s_mov_b64 exec, -1
    v_exp_f32 v51, v51
    v_exp_f32 v52, v52
    v_exp_f32 v53, v53
    v_mfma_f32_32x32x16_bf16 v[32:47], a[4:7], v[144:147], v[80:95]
    buffer_load_dwordx4 v234, s[12:15], s56 offen lds
    v_exp_f32 v54, v54
    v_exp_f32 v55, v55
    v_exp_f32 v56, v56
    v_exp_f32 v57, v57
    v_smfmac_f32_32x32x32_bf16 v[128:143], v[176:179], v[48:55], v5
    s_add_u32 m0, s66, 6144
    ds_read_b128 a[16:19], v2 offset:16384
    ds_read_b64 a[20:21], v3 offset:15360
    v_exp_f32 v58, v58
    v_exp_f32 v59, v59
    v_exp_f32 v60, v60
    v_exp_f32 v61, v61
    v_exp_f32 v62, v62
    v_mfma_f32_32x32x4_2b_bf16 v[16:47], a[8:9], v[148:149], v[16:47]
    buffer_load_dwordx4 v232, s[8:11], s57 offen lds
    v_exp_f32 v63, v63
    v_exp_f32 v64, v64
    v_exp_f32 v65, v65
    v_exp_f32 v66, v66
    v_exp_f32 v67, v67
    v_exp_f32 v68, v68
    v_exp_f32 v69, v69
    v_exp_f32 v70, v70
    v_smfmac_f32_32x32x32_bf16 v[128:143], v[180:183], v[56:63], v5
    s_add_u32 m0, s66, 7168
    v_exp_f32 v71, v71
    v_exp_f32 v72, v72
    v_exp_f32 v73, v73
    v_exp_f32 v74, v74
    v_smfmac_f32_32x32x32_bf16 v[128:143], v[184:187], v[64:71], v5
    s_nop 0
    buffer_load_dwordx4 v234, s[12:15], s57 offen lds
    v_exp_f32 v75, v75
    v_exp_f32 v76, v76
    v_exp_f32 v77, v77
    v_exp_f32 v78, v78
    v_exp_f32 v79, v79
    v_mfma_f32_32x32x16_bf16 v[48:63], a[0:3], v[152:155], v[96:111]
    s_add_u32 m0, s66, 8192
    v_exp_f32 v16, v16
    v_exp_f32 v17, v17
    v_exp_f32 v18, v18
    v_smfmac_f32_32x32x32_bf16 v[128:143], v[188:191], v[72:79], v5
    s_waitcnt lgkmcnt(0)
    v_exp_f32 v19, v19
    v_exp_f32 v20, v20
    v_exp_f32 v21, v21
    v_mfma_f32_32x32x16_bf16 v[64:79], a[4:7], v[152:155], v[96:111]
    buffer_load_dwordx4 v233, s[8:11], s58 offen lds
    v_exp_f32 v22, v22
    v_exp_f32 v23, v23
    v_exp_f32 v24, v24
    v_exp_f32 v25, v25
    v_smfmac_f32_32x32x32_bf16 v[112:127], v[160:163], v[16:23], v5
    s_add_u32 m0, s66, 9216
    v_exp_f32 v26, v26
    v_exp_f32 v27, v27
    v_exp_f32 v28, v28
    v_exp_f32 v29, v29
    v_exp_f32 v30, v30
    v_mfma_f32_32x32x4_2b_bf16 v[48:79], a[8:9], v[156:157], v[48:79]
    buffer_load_dwordx4 v235, s[12:15], s58 offen lds
    v_exp_f32 v31, v31
    v_exp_f32 v32, v32
    v_exp_f32 v33, v33
    v_exp_f32 v34, v34
    v_exp_f32 v35, v35
    v_exp_f32 v36, v36
    v_exp_f32 v37, v37
    v_exp_f32 v38, v38
    v_smfmac_f32_32x32x32_bf16 v[112:127], v[164:167], v[24:31], v5
    v_exp_f32 v39, v39
    v_exp_f32 v40, v40
    v_exp_f32 v41, v41
    v_exp_f32 v42, v42
    v_smfmac_f32_32x32x32_bf16 v[112:127], v[168:171], v[32:39], v5
    v_exp_f32 v43, v43
    v_exp_f32 v44, v44
    v_exp_f32 v45, v45
    v_exp_f32 v46, v46
    v_exp_f32 v47, v47
    v_mfma_f32_32x32x16_bf16 v[16:31], a[12:15], v[144:147], v[80:95]
    ds_read_b128 a[0:3], v2 offset:20480
    v_exp_f32 v48, v48
    v_exp_f32 v49, v49
    v_exp_f32 v50, v50
    v_smfmac_f32_32x32x32_bf16 v[112:127], v[172:175], v[40:47], v5
    s_mov_b64 exec, s[42:43]
    ds_read_b128 v[176:179], v4 offset:15360
    ds_read_b128 v[180:183], v4 offset:16000
    ds_read_b128 v[184:187], v4 offset:16640
    ds_read_b128 v[188:191], v4 offset:17280
    s_mov_b64 exec, -1
    v_exp_f32 v51, v51
    v_exp_f32 v52, v52
    v_exp_f32 v53, v53
    v_mfma_f32_32x32x16_bf16 v[32:47], a[16:19], v[144:147], v[80:95]
    v_exp_f32 v54, v54
    v_exp_f32 v55, v55
    v_exp_f32 v56, v56
    v_exp_f32 v57, v57
    v_smfmac_f32_32x32x32_bf16 v[128:143], v[160:163], v[48:55], v5
    s_nop 0
    ds_read_b128 a[4:7], v2 offset:21504
    ds_read_b64 a[8:9], v3 offset:20480
    v_exp_f32 v58, v58
    v_exp_f32 v59, v59
    v_exp_f32 v60, v60
    v_exp_f32 v61, v61
    v_exp_f32 v62, v62
    v_mfma_f32_32x32x4_2b_bf16 v[16:47], a[20:21], v[148:149], v[16:47]
    v_exp_f32 v63, v63
    v_exp_f32 v64, v64
    v_exp_f32 v65, v65
    v_exp_f32 v66, v66
    v_exp_f32 v67, v67
    v_exp_f32 v68, v68
    v_exp_f32 v69, v69
    v_exp_f32 v70, v70
    v_smfmac_f32_32x32x32_bf16 v[128:143], v[164:167], v[56:63], v5
    v_exp_f32 v71, v71
    v_exp_f32 v72, v72
    v_exp_f32 v73, v73
    v_exp_f32 v74, v74
    v_smfmac_f32_32x32x32_bf16 v[128:143], v[168:171], v[64:71], v5
    v_exp_f32 v75, v75
    v_exp_f32 v76, v76
    v_exp_f32 v77, v77
    v_exp_f32 v78, v78
    v_exp_f32 v79, v79
    v_mfma_f32_32x32x16_bf16 v[48:63], a[12:15], v[152:155], v[96:111]
    v_exp_f32 v16, v16
    v_exp_f32 v17, v17
    v_exp_f32 v18, v18
    v_smfmac_f32_32x32x32_bf16 v[128:143], v[172:175], v[72:79], v5
    s_waitcnt lgkmcnt(0)
    v_exp_f32 v19, v19
    v_exp_f32 v20, v20
    v_exp_f32 v21, v21
    v_mfma_f32_32x32x16_bf16 v[64:79], a[16:19], v[152:155], v[96:111]
    v_exp_f32 v22, v22
    v_exp_f32 v23, v23
    v_exp_f32 v24, v24
    v_exp_f32 v25, v25
    v_smfmac_f32_32x32x32_bf16 v[112:127], v[176:179], v[16:23], v5
    v_exp_f32 v26, v26
    v_exp_f32 v27, v27
    v_exp_f32 v28, v28
    v_exp_f32 v29, v29
    v_exp_f32 v30, v30
    v_mfma_f32_32x32x4_2b_bf16 v[48:79], a[20:21], v[156:157], v[48:79]
    v_exp_f32 v31, v31
    v_exp_f32 v32, v32
    v_exp_f32 v33, v33
    v_exp_f32 v34, v34
    v_exp_f32 v35, v35
    v_exp_f32 v36, v36
    v_exp_f32 v37, v37
    v_exp_f32 v38, v38
    v_smfmac_f32_32x32x32_bf16 v[112:127], v[180:183], v[24:31], v5
    v_exp_f32 v39, v39
    v_exp_f32 v40, v40
    v_exp_f32 v41, v41
    v_exp_f32 v42, v42
    v_smfmac_f32_32x32x32_bf16 v[112:127], v[184:187], v[32:39], v5
    v_exp_f32 v43, v43
    v_exp_f32 v44, v44
    v_exp_f32 v45, v45
    v_exp_f32 v46, v46
    v_exp_f32 v47, v47
    v_mfma_f32_32x32x16_bf16 v[16:31], a[0:3], v[144:147], v[80:95]
    ds_read_b128 a[12:15], v2 offset:25600
    v_exp_f32 v48, v48
    v_exp_f32 v49, v49
    v_exp_f32 v50, v50
    v_smfmac_f32_32x32x32_bf16 v[112:127], v[188:191], v[40:47], v5
    s_mov_b64 exec, s[42:43]
    ds_read_b128 v[160:163], v4 offset:20480
    ds_read_b128 v[164:167], v4 offset:21120
    ds_read_b128 v[168:171], v4 offset:21760
    ds_read_b128 v[172:175], v4 offset:22400
    s_mov_b64 exec, -1
    v_exp_f32 v51, v51
    v_exp_f32 v52, v52
    v_exp_f32 v53, v53
    v_mfma_f32_32x32x16_bf16 v[32:47], a[4:7], v[144:147], v[80:95]
    v_exp_f32 v54, v54
    v_exp_f32 v55, v55
    v_exp_f32 v56, v56
    v_exp_f32 v57, v57
    v_smfmac_f32_32x32x32_bf16 v[128:143], v[176:179], v[48:55], v5
    s_nop 0
    ds_read_b128 a[16:19], v2 offset:26624
    ds_read_b64 a[20:21], v3 offset:25600
    v_exp_f32 v58, v58
    v_exp_f32 v59, v59
    v_exp_f32 v60, v60
    v_exp_f32 v61, v61
    v_exp_f32 v62, v62
    v_mfma_f32_32x32x4_2b_bf16 v[16:47], a[8:9], v[148:149], v[16:47]
    v_exp_f32 v63, v63
    v_exp_f32 v64, v64
    v_exp_f32 v65, v65
    v_exp_f32 v66, v66
    v_exp_f32 v67, v67
    v_exp_f32 v68, v68
    v_exp_f32 v69, v69
    v_exp_f32 v70, v70
    v_smfmac_f32_32x32x32_bf16 v[128:143], v[180:183], v[56:63], v5
    v_exp_f32 v71, v71
    v_exp_f32 v72, v72
    v_exp_f32 v73, v73
    v_exp_f32 v74, v74
    v_smfmac_f32_32x32x32_bf16 v[128:143], v[184:187], v[64:71], v5
    v_exp_f32 v75, v75
    v_exp_f32 v76, v76
    v_exp_f32 v77, v77
    v_exp_f32 v78, v78
    v_exp_f32 v79, v79
    v_mfma_f32_32x32x16_bf16 v[48:63], a[0:3], v[152:155], v[96:111]
    s_waitcnt vmcnt(10)
    s_barrier
    v_exp_f32 v16, v16
    v_exp_f32 v17, v17
    v_exp_f32 v18, v18
    v_smfmac_f32_32x32x32_bf16 v[128:143], v[188:191], v[72:79], v5
    s_waitcnt lgkmcnt(0)
    v_exp_f32 v19, v19
    v_exp_f32 v20, v20
    v_exp_f32 v21, v21
    v_mfma_f32_32x32x16_bf16 v[64:79], a[4:7], v[152:155], v[96:111]
    v_exp_f32 v22, v22
    v_exp_f32 v23, v23
    v_exp_f32 v24, v24
    v_exp_f32 v25, v25
    v_smfmac_f32_32x32x32_bf16 v[112:127], v[160:163], v[16:23], v5
    v_exp_f32 v26, v26
    v_exp_f32 v27, v27
    v_exp_f32 v28, v28
    v_exp_f32 v29, v29
    v_exp_f32 v30, v30
    v_mfma_f32_32x32x4_2b_bf16 v[48:79], a[8:9], v[156:157], v[48:79]
    v_exp_f32 v31, v31
    v_exp_f32 v32, v32
    v_exp_f32 v33, v33
    v_exp_f32 v34, v34
    v_exp_f32 v35, v35
    v_exp_f32 v36, v36
    v_exp_f32 v37, v37
    v_exp_f32 v38, v38
    v_smfmac_f32_32x32x32_bf16 v[112:127], v[164:167], v[24:31], v5
    v_exp_f32 v39, v39
    v_exp_f32 v40, v40
    v_exp_f32 v41, v41
    v_exp_f32 v42, v42
    v_smfmac_f32_32x32x32_bf16 v[112:127], v[168:171], v[32:39], v5
    v_exp_f32 v43, v43
    v_exp_f32 v44, v44
    v_exp_f32 v45, v45
    v_exp_f32 v46, v46
    v_exp_f32 v47, v47
    v_mfma_f32_32x32x16_bf16 v[16:31], a[12:15], v[144:147], v[80:95]
    ds_read_b128 a[0:3], v2 offset:30720
    v_exp_f32 v48, v48
    v_exp_f32 v49, v49
    v_exp_f32 v50, v50
    v_smfmac_f32_32x32x32_bf16 v[112:127], v[172:175], v[40:47], v5
    s_mov_b64 exec, s[42:43]
    ds_read_b128 v[176:179], v4 offset:25600
    ds_read_b128 v[180:183], v4 offset:26240
    ds_read_b128 v[184:187], v4 offset:26880
    ds_read_b128 v[188:191], v4 offset:27520
    s_mov_b64 exec, -1
    v_exp_f32 v51, v51
    v_exp_f32 v52, v52
    v_exp_f32 v53, v53
    v_mfma_f32_32x32x16_bf16 v[32:47], a[16:19], v[144:147], v[80:95]
k2_main_kernel_pad_P3:
    s_cbranch_execz k2_main_kernel_pad_P2
    v_exp_f32 v54, v54
    v_exp_f32 v55, v55
    v_exp_f32 v56, v56
    v_exp_f32 v57, v57
    v_smfmac_f32_32x32x32_bf16 v[128:143], v[160:163], v[48:55], v5
    s_nop 0
    ds_read_b128 a[4:7], v2 offset:31744
    ds_read_b64 a[8:9], v3 offset:30720
    v_exp_f32 v58, v58
    v_exp_f32 v59, v59
    v_exp_f32 v60, v60
    v_exp_f32 v61, v61
    v_exp_f32 v62, v62
    v_mfma_f32_32x32x4_2b_bf16 v[16:47], a[20:21], v[148:149], v[16:47]
    v_exp_f32 v63, v63
    v_exp_f32 v64, v64
    v_exp_f32 v65, v65
    v_exp_f32 v66, v66
    v_exp_f32 v67, v67
    v_exp_f32 v68, v68
    v_exp_f32 v69, v69
    v_exp_f32 v70, v70
    v_smfmac_f32_32x32x32_bf16 v[128:143], v[164:167], v[56:63], v5
    v_exp_f32 v71, v71
    v_exp_f32 v72, v72
    v_exp_f32 v73, v73
    v_exp_f32 v74, v74
    v_smfmac_f32_32x32x32_bf16 v[128:143], v[168:171], v[64:71], v5
    v_exp_f32 v75, v75
    v_exp_f32 v76, v76
    v_exp_f32 v77, v77
    v_exp_f32 v78, v78
    v_exp_f32 v79, v79
    v_mfma_f32_32x32x16_bf16 v[48:63], a[12:15], v[152:155], v[96:111]
    s_add_u32 m0, s53, 49152
    v_exp_f32 v16, v16
    v_exp_f32 v17, v17
    v_exp_f32 v18, v18
    v_smfmac_f32_32x32x32_bf16 v[128:143], v[172:175], v[72:79], v5
    s_waitcnt lgkmcnt(0)
    v_exp_f32 v19, v19
    v_exp_f32 v20, v20
    v_exp_f32 v21, v21
    v_mfma_f32_32x32x16_bf16 v[64:79], a[16:19], v[152:155], v[96:111]
    buffer_load_dwordx4 v6, s[4:7], m0 offen offset:0 sc1 lds
    v_exp_f32 v22, v22
    v_exp_f32 v23, v23
    v_exp_f32 v24, v24
    v_exp_f32 v25, v25
    v_smfmac_f32_32x32x32_bf16 v[112:127], v[176:179], v[16:23], v5
    v_exp_f32 v26, v26
    v_exp_f32 v27, v27
    v_exp_f32 v28, v28
    v_exp_f32 v29, v29
    v_exp_f32 v30, v30
    v_mfma_f32_32x32x4_2b_bf16 v[48:79], a[20:21], v[156:157], v[48:79]
    buffer_load_dwordx4 v6, s[4:7], m0 offen offset:1024 sc1 lds
    v_exp_f32 v31, v31
    v_exp_f32 v32, v32
    v_exp_f32 v33, v33
    v_exp_f32 v34, v34
    v_exp_f32 v35, v35
    v_exp_f32 v36, v36
    v_exp_f32 v37, v37
    v_exp_f32 v38, v38
    v_smfmac_f32_32x32x32_bf16 v[112:127], v[180:183], v[24:31], v5
    v_exp_f32 v39, v39
    v_exp_f32 v40, v40
    v_exp_f32 v41, v41
    v_exp_f32 v42, v42
    v_smfmac_f32_32x32x32_bf16 v[112:127], v[184:187], v[32:39], v5
    s_nop 0
    buffer_load_dwordx4 v6, s[4:7], m0 offen offset:2048 sc1 lds
    v_exp_f32 v43, v43
    v_exp_f32 v44, v44
    v_exp_f32 v45, v45
    v_exp_f32 v46, v46
    v_exp_f32 v47, v47
    v_mfma_f32_32x32x16_bf16 v[16:31], a[0:3], v[144:147], v[80:95]
    ds_read_b128 a[12:15], v2 offset:35840
    v_exp_f32 v48, v48
    v_exp_f32 v49, v49
    v_exp_f32 v50, v50
    v_smfmac_f32_32x32x32_bf16 v[112:127], v[188:191], v[40:47], v5
    s_mov_b64 exec, s[42:43]
    ds_read_b128 v[160:163], v4 offset:30720
    ds_read_b128 v[164:167], v4 offset:31360
    ds_read_b128 v[168:171], v4 offset:32000
    ds_read_b128 v[172:175], v4 offset:32640
    s_mov_b64 exec, -1
    v_exp_f32 v51, v51
    v_exp_f32 v52, v52
    v_exp_f32 v53, v53
    v_mfma_f32_32x32x16_bf16 v[32:47], a[4:7], v[144:147], v[80:95]
    buffer_load_dwordx4 v6, s[4:7], m0 offen offset:3072 sc1 lds
    v_exp_f32 v54, v54
    v_exp_f32 v55, v55
    v_exp_f32 v56, v56
    v_exp_f32 v57, v57
    v_smfmac_f32_32x32x32_bf16 v[128:143], v[176:179], v[48:55], v5
    s_add_u32 m0, s53, 65536
    ds_read_b128 a[16:19], v2 offset:36864
    ds_read_b64 a[20:21], v3 offset:35840
    v_exp_f32 v58, v58
    v_exp_f32 v59, v59
    v_exp_f32 v60, v60
    v_exp_f32 v61, v61
    v_exp_f32 v62, v62
    v_mfma_f32_32x32x4_2b_bf16 v[16:47], a[8:9], v[148:149], v[16:47]
    buffer_load_dwordx4 v6, s[4:7], m0 offen offset:0 sc1 lds
    v_exp_f32 v63, v63
    v_exp_f32 v64, v64
    v_exp_f32 v65, v65
    v_exp_f32 v66, v66
    v_exp_f32 v67, v67
    v_exp_f32 v68, v68
    v_exp_f32 v69, v69
    v_exp_f32 v70, v70
    v_smfmac_f32_32x32x32_bf16 v[128:143], v[180:183], v[56:63], v5
    v_exp_f32 v71, v71
    v_exp_f32 v72, v72
    v_exp_f32 v73, v73
    v_exp_f32 v74, v74
    v_smfmac_f32_32x32x32_bf16 v[128:143], v[184:187], v[64:71], v5
    s_nop 0
    buffer_load_dwordx4 v6, s[4:7], m0 offen offset:1024 sc1 lds
    v_exp_f32 v75, v75
    v_exp_f32 v76, v76
    v_exp_f32 v77, v77
    v_exp_f32 v78, v78
    v_exp_f32 v79, v79
    v_mfma_f32_32x32x16_bf16 v[48:63], a[0:3], v[152:155], v[96:111]
    s_mov_b32 vcc_lo, 0xf0f00f0f
    v_exp_f32 v16, v16
    v_exp_f32 v17, v17
    v_exp_f32 v18, v18
    v_smfmac_f32_32x32x32_bf16 v[128:143], v[188:191], v[72:79], v5
    s_waitcnt lgkmcnt(0)
    v_exp_f32 v19, v19
    v_exp_f32 v20, v20
    v_exp_f32 v21, v21
    v_mfma_f32_32x32x16_bf16 v[64:79], a[4:7], v[152:155], v[96:111]
    buffer_load_dwordx4 v6, s[4:7], m0 offen offset:2048 sc1 lds
    v_exp_f32 v22, v22
    v_exp_f32 v23, v23
    v_exp_f32 v24, v24
    v_exp_f32 v25, v25
    v_smfmac_f32_32x32x32_bf16 v[112:127], v[160:163], v[16:23], v5
    s_mov_b32 vcc_hi, 0xf0f00f0f
    v_exp_f32 v26, v26
    v_exp_f32 v27, v27
    v_exp_f32 v28, v28
    v_exp_f32 v29, v29
    v_exp_f32 v30, v30
    v_mfma_f32_32x32x4_2b_bf16 v[48:79], a[8:9], v[156:157], v[48:79]
    buffer_load_dwordx4 v6, s[4:7], m0 offen offset:3072 sc1 lds
    v_exp_f32 v31, v31
    v_exp_f32 v32, v32
    v_exp_f32 v33, v33
    v_exp_f32 v34, v34
    v_exp_f32 v35, v35
    v_mov_b32 v10, 0x3f803f80
    v_exp_f32 v36, v36
    v_cndmask_b32 v10, 0, v10, vcc
    v_exp_f32 v37, v37
    v_exp_f32 v38, v38
    v_smfmac_f32_32x32x32_bf16 v[112:127], v[164:167], v[24:31], v5
    s_add_u32 m0, s53, 81920
    v_exp_f32 v39, v39
    v_mov_b32 v11, v10
    v_exp_f32 v40, v40
    v_mov_b64 v[12:13], v[10:11]
    v_exp_f32 v41, v41
    v_exp_f32 v42, v42
    v_smfmac_f32_32x32x32_bf16 v[112:127], v[168:171], v[32:39], v5
    s_nop 0
    buffer_load_dwordx4 v6, s[4:7], m0 offen offset:0 sc1 lds
    v_exp_f32 v43, v43
    v_exp_f32 v44, v44
    v_exp_f32 v45, v45
    v_exp_f32 v46, v46
    v_exp_f32 v47, v47
    v_mfma_f32_32x32x16_bf16 v[16:31], a[12:15], v[144:147], v[80:95]
    ds_read_b128 a[0:3], v2 offset:40960
    v_exp_f32 v48, v48
    v_exp_f32 v49, v49
    v_exp_f32 v50, v50
    v_smfmac_f32_32x32x32_bf16 v[112:127], v[172:175], v[40:47], v5
    s_mov_b64 exec, s[42:43]
    ds_read_b128 v[176:179], v4 offset:35840
    ds_read_b128 v[180:183], v4 offset:36480
    ds_read_b128 v[184:187], v4 offset:37120
    ds_read_b128 v[188:191], v4 offset:37760
    s_mov_b64 exec, -1
    v_exp_f32 v51, v51
    v_exp_f32 v52, v52
    v_exp_f32 v53, v53
    v_mfma_f32_32x32x16_bf16 v[32:47], a[16:19], v[144:147], v[80:95]
    buffer_load_dwordx4 v6, s[4:7], m0 offen offset:1024 sc1 lds
    v_exp_f32 v54, v54
    v_exp_f32 v55, v55
    v_exp_f32 v56, v56
    v_exp_f32 v57, v57
    v_smfmac_f32_32x32x32_bf16 v[128:143], v[160:163], v[48:55], v5
    s_nop 0
    ds_read_b128 a[4:7], v2 offset:41984
    ds_read_b64 a[8:9], v3 offset:40960
    v_exp_f32 v58, v58
    v_exp_f32 v59, v59
    v_exp_f32 v60, v60
    v_exp_f32 v61, v61
    v_exp_f32 v62, v62
    v_mfma_f32_32x32x4_2b_bf16 v[16:47], a[20:21], v[148:149], v[16:47]
    buffer_load_dwordx4 v6, s[4:7], m0 offen offset:2048 sc1 lds
    v_exp_f32 v63, v63
    v_exp_f32 v64, v64
    v_exp_f32 v65, v65
    v_exp_f32 v66, v66
    v_exp_f32 v67, v67
    v_exp_f32 v68, v68
    v_exp_f32 v69, v69
    v_exp_f32 v70, v70
    v_smfmac_f32_32x32x32_bf16 v[128:143], v[164:167], v[56:63], v5
    v_exp_f32 v71, v71
    v_exp_f32 v72, v72
    v_exp_f32 v73, v73
    v_exp_f32 v74, v74
    v_smfmac_f32_32x32x32_bf16 v[128:143], v[168:171], v[64:71], v5
    s_nop 0
    buffer_load_dwordx4 v6, s[4:7], m0 offen offset:3072 sc1 lds
    v_exp_f32 v75, v75
    v_exp_f32 v76, v76
    v_exp_f32 v77, v77
    v_exp_f32 v78, v78
    v_exp_f32 v79, v79
    v_mfma_f32_32x32x16_bf16 v[48:63], a[12:15], v[152:155], v[96:111]
    s_waitcnt vmcnt(12)
    s_add_u32 m0, s53, 98304
    v_exp_f32 v16, v16
    v_exp_f32 v17, v17
    v_exp_f32 v18, v18
    v_smfmac_f32_32x32x32_bf16 v[128:143], v[172:175], v[72:79], v5
    s_waitcnt lgkmcnt(0)
    ds_read_b64_tr_b16 v[192:193], v238 offset:0
    ds_read_b64_tr_b16 v[194:195], v238 offset:512
    v_exp_f32 v19, v19
    v_exp_f32 v20, v20
    v_exp_f32 v21, v21
    v_mfma_f32_32x32x16_bf16 v[64:79], a[16:19], v[152:155], v[96:111]
    buffer_load_dwordx4 v6, s[4:7], m0 offen offset:0 sc1 lds
    v_exp_f32 v22, v22
    v_exp_f32 v23, v23
    v_exp_f32 v24, v24
    v_exp_f32 v25, v25
    v_smfmac_f32_32x32x32_bf16 v[112:127], v[176:179], v[16:23], v5
    s_nop 0
    ds_read_b64_tr_b16 v[196:197], v238 offset:2048
    ds_read_b64_tr_b16 v[198:199], v238 offset:2560
    v_exp_f32 v26, v26
    v_exp_f32 v27, v27
    v_exp_f32 v28, v28
    v_exp_f32 v29, v29
    v_exp_f32 v30, v30
    v_mfma_f32_32x32x4_2b_bf16 v[48:79], a[20:21], v[156:157], v[48:79]
    buffer_load_dwordx4 v6, s[4:7], m0 offen offset:1024 sc1 lds
    v_exp_f32 v31, v31
    v_exp_f32 v32, v32
    v_exp_f32 v33, v33
    v_exp_f32 v34, v34
    v_exp_f32 v35, v35
    v_exp_f32 v36, v36
    v_exp_f32 v37, v37
    v_exp_f32 v38, v38
    v_smfmac_f32_32x32x32_bf16 v[112:127], v[180:183], v[24:31], v5
    s_nop 0
    ds_read_b64_tr_b16 v[200:201], v238 offset:4096
    v_exp_f32 v39, v39
    v_exp_f32 v40, v40
    v_exp_f32 v41, v41
    v_exp_f32 v42, v42
    v_smfmac_f32_32x32x32_bf16 v[112:127], v[184:187], v[32:39], v5
    s_nop 0
    buffer_load_dwordx4 v6, s[4:7], m0 offen offset:2048 sc1 lds
    v_exp_f32 v43, v43
    v_exp_f32 v44, v44
    v_exp_f32 v45, v45
    v_exp_f32 v46, v46
    v_exp_f32 v47, v47
    v_mfma_f32_32x32x16_bf16 v[16:31], a[0:3], v[144:147], v[80:95]
    ds_read_b128 a[12:15], v2 offset:46080
    ds_read_b64_tr_b16 v[202:203], v238 offset:4608
    v_exp_f32 v48, v48
    v_exp_f32 v49, v49
    v_exp_f32 v50, v50
    v_smfmac_f32_32x32x32_bf16 v[112:127], v[188:191], v[40:47], v5
    s_mov_b64 exec, s[42:43]
    ds_read_b128 v[160:163], v4 offset:40960
    ds_read_b128 v[164:167], v4 offset:41600
    ds_read_b128 v[168:171], v4 offset:42240
    ds_read_b128 v[172:175], v4 offset:42880
    s_mov_b64 exec, -1
    v_exp_f32 v51, v51
    v_exp_f32 v52, v52
    v_exp_f32 v53, v53
    v_mfma_f32_32x32x16_bf16 v[32:47], a[4:7], v[144:147], v[80:95]
    ds_read_b64_tr_b16 v[204:205], v238 offset:6144
    buffer_load_dwordx4 v6, s[4:7], m0 offen offset:3072 sc1 lds
    v_exp_f32 v54, v54
    v_exp_f32 v55, v55
    v_exp_f32 v56, v56
    v_exp_f32 v57, v57
    v_smfmac_f32_32x32x32_bf16 v[128:143], v[176:179], v[48:55], v5
    s_lshl_b32 m0, s3, 11
    s_add_u32 m0, m0, 114688
    ds_read_b128 a[16:19], v2 offset:47104
    ds_read_b64 a[20:21], v3 offset:46080
    v_exp_f32 v58, v58
    v_exp_f32 v59, v59
    v_exp_f32 v60, v60
    v_exp_f32 v61, v61
    v_exp_f32 v62, v62
    v_mfma_f32_32x32x4_2b_bf16 v[16:47], a[8:9], v[148:149], v[16:47]
    buffer_load_dwordx4 v6, s[4:7], m0 offen offset:0 sc1 lds
    v_exp_f32 v63, v63
    v_exp_f32 v64, v64
    v_exp_f32 v65, v65
    v_exp_f32 v66, v66
    v_exp_f32 v67, v67
    v_exp_f32 v68, v68
    v_exp_f32 v69, v69
    v_exp_f32 v70, v70
    v_smfmac_f32_32x32x32_bf16 v[128:143], v[180:183], v[56:63], v5
    s_nop 0
    ds_read_b64_tr_b16 v[206:207], v238 offset:6656
    ds_read_b64_tr_b16 v[208:209], v238 offset:8192
    v_exp_f32 v71, v71
    v_exp_f32 v72, v72
    v_exp_f32 v73, v73
    v_exp_f32 v74, v74
    v_smfmac_f32_32x32x32_bf16 v[128:143], v[184:187], v[64:71], v5
    s_nop 0
    ds_read_b64_tr_b16 v[210:211], v238 offset:8704
    buffer_load_dwordx4 v6, s[4:7], m0 offen offset:1024 sc1 lds
    v_exp_f32 v75, v75
    v_exp_f32 v76, v76
    v_exp_f32 v77, v77
    v_exp_f32 v78, v78
    v_exp_f32 v79, v79
    v_mfma_f32_32x32x16_bf16 v[48:63], a[0:3], v[152:155], v[96:111]
    s_waitcnt vmcnt(10)
    s_barrier
    v_exp_f32 v16, v16
    v_exp_f32 v17, v17
    v_exp_f32 v18, v18
    v_smfmac_f32_32x32x32_bf16 v[128:143], v[188:191], v[72:79], v5
    s_waitcnt lgkmcnt(0)
    ds_read_b64_tr_b16 v[212:213], v238 offset:128
    ds_read_b64_tr_b16 v[214:215], v238 offset:640
    v_exp_f32 v19, v19
    v_exp_f32 v20, v20
    v_exp_f32 v21, v21
    v_mfma_f32_32x32x16_bf16 v[64:79], a[4:7], v[152:155], v[96:111]
    v_exp_f32 v22, v22
    v_exp_f32 v23, v23
    v_exp_f32 v24, v24
    v_exp_f32 v25, v25
    v_smfmac_f32_32x32x32_bf16 v[112:127], v[160:163], v[16:23], v5
    s_nop 0
    ds_read_b64_tr_b16 v[216:217], v238 offset:2176
    ds_read_b64_tr_b16 v[218:219], v238 offset:2688
    v_exp_f32 v26, v26
    v_exp_f32 v27, v27
    v_exp_f32 v28, v28
    v_exp_f32 v29, v29
    v_exp_f32 v30, v30
    v_mfma_f32_32x32x4_2b_bf16 v[48:79], a[8:9], v[156:157], v[48:79]
    v_exp_f32 v31, v31
    v_exp_f32 v32, v32
    v_exp_f32 v33, v33
    v_exp_f32 v34, v34
    v_exp_f32 v35, v35
    v_exp_f32 v36, v36
    v_exp_f32 v37, v37
    v_exp_f32 v38, v38
    v_smfmac_f32_32x32x32_bf16 v[112:127], v[164:167], v[24:31], v5
    s_nop 0
    ds_read_b64_tr_b16 v[220:221], v238 offset:4224
    v_exp_f32 v39, v39
    v_exp_f32 v40, v40
    v_exp_f32 v41, v41
    v_exp_f32 v42, v42
    v_smfmac_f32_32x32x32_bf16 v[112:127], v[168:171], v[32:39], v5
    v_exp_f32 v43, v43
    v_exp_f32 v44, v44
    v_exp_f32 v45, v45
    v_exp_f32 v46, v46
    v_exp_f32 v47, v47
    v_mfma_f32_32x32x16_bf16 v[16:31], a[12:15], v[144:147], v[80:95]
    ds_read_b128 a[0:3], v2 offset:51200
    ds_read_b64_tr_b16 v[222:223], v238 offset:4736
    v_exp_f32 v48, v48
    v_exp_f32 v49, v49
    v_exp_f32 v50, v50
    v_smfmac_f32_32x32x32_bf16 v[112:127], v[172:175], v[40:47], v5
    s_mov_b64 exec, s[42:43]
    ds_read_b128 v[176:179], v4 offset:46080
    ds_read_b128 v[180:183], v4 offset:46720
    ds_read_b128 v[184:187], v4 offset:47360
    ds_read_b128 v[188:191], v4 offset:48000
    s_mov_b64 exec, -1
    v_exp_f32 v51, v51
    v_exp_f32 v52, v52
    v_exp_f32 v53, v53
    v_mfma_f32_32x32x16_bf16 v[32:47], a[16:19], v[144:147], v[80:95]
    ds_read_b64_tr_b16 v[224:225], v238 offset:6272
    buffer_store_dwordx4 v[192:195], v236, s[4:7], s59 offen sc1
    v_exp_f32 v54, v54
    v_exp_f32 v55, v55
    v_exp_f32 v56, v56
    v_exp_f32 v57, v57
    v_smfmac_f32_32x32x32_bf16 v[128:143], v[160:163], v[48:55], v5
    s_bitcmp1_b32 s75, 1
    s_cselect_b32 s77, s76, s63
    s_add_u32 s59, s59, s77
    ds_read_b128 a[4:7], v2 offset:52224
    ds_read_b64 a[8:9], v3 offset:51200
    v_exp_f32 v58, v58
    v_exp_f32 v59, v59
    v_exp_f32 v60, v60
    v_exp_f32 v61, v61
    v_mfma_f32_16x16x32_bf16 v[232:235], v[10:13], v[192:195], 0
    v_exp_f32 v62, v62
    v_mfma_f32_32x32x4_2b_bf16 v[16:47], a[20:21], v[148:149], v[16:47]
    buffer_store_dwordx4 v[196:199], v236, s[4:7], s59 offen sc1
    v_exp_f32 v63, v63
    v_exp_f32 v64, v64
    v_exp_f32 v65, v65
    v_exp_f32 v66, v66
    v_exp_f32 v67, v67
    v_exp_f32 v68, v68
    v_exp_f32 v69, v69
    v_exp_f32 v70, v70
    v_smfmac_f32_32x32x32_bf16 v[128:143], v[164:167], v[56:63], v5
    s_bitcmp1_b32 s75, 2
    s_cselect_b32 s77, s76, s63
    s_add_u32 s59, s59, s77
    ds_read_b64_tr_b16 v[226:227], v238 offset:6784
    ds_read_b64_tr_b16 v[228:229], v238 offset:8320
    v_exp_f32 v71, v71
    v_exp_f32 v72, v72
    v_exp_f32 v73, v73
    v_exp_f32 v74, v74
    v_smfmac_f32_32x32x32_bf16 v[128:143], v[168:171], v[64:71], v5
    s_nop 0
    ds_read_b64_tr_b16 v[230:231], v238 offset:8832
    buffer_store_dwordx4 v[200:203], v236, s[4:7], s59 offen sc1
    v_exp_f32 v75, v75
    v_exp_f32 v76, v76
    v_exp_f32 v77, v77
    v_exp_f32 v78, v78
    v_mfma_f32_16x16x32_bf16 v[232:235], v[10:13], v[196:199], v[232:235]
    v_exp_f32 v79, v79
    v_mfma_f32_16x16x32_bf16 v[232:235], v[10:13], v[200:203], v[232:235]
    v_mfma_f32_32x32x16_bf16 v[48:63], a[12:15], v[152:155], v[96:111]
    s_bitcmp1_b32 s75, 3
    s_cselect_b32 s77, s76, s63
    s_add_u32 s59, s59, s77
    v_exp_f32 v16, v16
    v_exp_f32 v17, v17
    v_exp_f32 v18, v18
    v_smfmac_f32_32x32x32_bf16 v[128:143], v[172:175], v[72:79], v5
    s_waitcnt lgkmcnt(0)
    v_exp_f32 v19, v19
    v_exp_f32 v20, v20
    v_exp_f32 v21, v21
    v_mfma_f32_32x32x16_bf16 v[64:79], a[16:19], v[152:155], v[96:111]
    buffer_store_dwordx4 v[204:207], v236, s[4:7], s59 offen sc1
    v_exp_f32 v22, v22
    v_exp_f32 v23, v23
    v_exp_f32 v24, v24
    v_exp_f32 v25, v25
    v_smfmac_f32_32x32x32_bf16 v[112:127], v[176:179], v[16:23], v5
    s_bitcmp1_b32 s75, 4
    s_cselect_b32 s77, s76, s63
    s_add_u32 s59, s59, s77
    v_exp_f32 v26, v26
    v_exp_f32 v27, v27
    v_exp_f32 v28, v28
    v_exp_f32 v29, v29
    v_mfma_f32_16x16x32_bf16 v[232:235], v[10:13], v[204:207], v[232:235]
    v_exp_f32 v30, v30
    v_mfma_f32_32x32x4_2b_bf16 v[48:79], a[20:21], v[156:157], v[48:79]
    buffer_store_dwordx4 v[208:211], v236, s[4:7], s59 offen sc1
    v_exp_f32 v31, v31
    v_exp_f32 v32, v32
    v_exp_f32 v33, v33
    v_exp_f32 v34, v34
    v_exp_f32 v35, v35
    v_exp_f32 v36, v36
    v_exp_f32 v37, v37
    v_exp_f32 v38, v38
    v_smfmac_f32_32x32x32_bf16 v[112:127], v[180:183], v[24:31], v5
    v_exp_f32 v39, v39
    v_exp_f32 v40, v40
    v_exp_f32 v41, v41
    v_exp_f32 v42, v42
    v_smfmac_f32_32x32x32_bf16 v[112:127], v[184:187], v[32:39], v5
    v_exp_f32 v43, v43
    v_exp_f32 v44, v44
    v_exp_f32 v45, v45
    v_exp_f32 v46, v46
    v_mfma_f32_16x16x32_bf16 v[232:235], v[10:13], v[208:211], v[232:235]
    v_exp_f32 v47, v47
    v_mfma_f32_32x32x16_bf16 v[16:31], a[0:3], v[144:147], v[80:95]
    ds_read_b128 a[12:15], v2 offset:56320
    v_exp_f32 v48, v48
    v_exp_f32 v49, v49
    v_exp_f32 v50, v50
    v_smfmac_f32_32x32x32_bf16 v[112:127], v[188:191], v[40:47], v5
    s_mov_b64 exec, s[42:43]
    ds_read_b128 v[160:163], v4 offset:51200
    ds_read_b128 v[164:167], v4 offset:51840
    ds_read_b128 v[168:171], v4 offset:52480
    ds_read_b128 v[172:175], v4 offset:53120
    s_mov_b64 exec, -1
    v_exp_f32 v51, v51
    v_exp_f32 v52, v52
    v_exp_f32 v53, v53
    v_mfma_f32_32x32x16_bf16 v[32:47], a[4:7], v[144:147], v[80:95]
    buffer_store_dwordx4 v[212:215], v236, s[4:7], s64 offen sc1
    v_exp_f32 v54, v54
    v_exp_f32 v55, v55
    v_exp_f32 v56, v56
    v_exp_f32 v57, v57
    v_smfmac_f32_32x32x32_bf16 v[128:143], v[176:179], v[48:55], v5
    s_bitcmp1_b32 s75, 6
    s_cselect_b32 s77, s76, s63
    s_add_u32 s64, s64, s77
    ds_read_b128 a[16:19], v2 offset:57344
    ds_read_b64 a[20:21], v3 offset:56320
    v_exp_f32 v58, v58
    v_exp_f32 v59, v59
    v_exp_f32 v60, v60
    v_exp_f32 v61, v61
    v_mfma_f32_16x16x32_bf16 v[232:235], v[10:13], v[212:215], v[232:235]
    v_exp_f32 v62, v62
    v_mfma_f32_32x32x4_2b_bf16 v[16:47], a[8:9], v[148:149], v[16:47]
    buffer_store_dwordx4 v[216:219], v236, s[4:7], s64 offen sc1
    v_exp_f32 v63, v63
    v_exp_f32 v64, v64
    v_exp_f32 v65, v65
    v_exp_f32 v66, v66
    v_exp_f32 v67, v67
    v_exp_f32 v68, v68
    v_exp_f32 v69, v69
    v_exp_f32 v70, v70
    v_smfmac_f32_32x32x32_bf16 v[128:143], v[180:183], v[56:63], v5
    s_bitcmp1_b32 s75, 7
    s_cselect_b32 s77, s76, s63
    s_add_u32 s64, s64, s77
    v_exp_f32 v71, v71
    v_exp_f32 v72, v72
    v_exp_f32 v73, v73
    v_exp_f32 v74, v74
    v_smfmac_f32_32x32x32_bf16 v[128:143], v[184:187], v[64:71], v5
    s_nop 0
    buffer_store_dwordx4 v[220:223], v236, s[4:7], s64 offen sc1
    v_exp_f32 v75, v75
    v_exp_f32 v76, v76
    v_exp_f32 v77, v77
    v_exp_f32 v78, v78
    v_mfma_f32_16x16x32_bf16 v[232:235], v[10:13], v[216:219], v[232:235]
    v_exp_f32 v79, v79
    v_mfma_f32_16x16x32_bf16 v[232:235], v[10:13], v[220:223], v[232:235]
    v_mfma_f32_32x32x16_bf16 v[48:63], a[0:3], v[152:155], v[96:111]
    s_bitcmp1_b32 s75, 8
    s_cselect_b32 s77, s76, s63
    s_add_u32 s64, s64, s77
    v_exp_f32 v16, v16
    v_exp_f32 v17, v17
    v_exp_f32 v18, v18
    v_smfmac_f32_32x32x32_bf16 v[128:143], v[188:191], v[72:79], v5
    s_waitcnt lgkmcnt(0)
    v_exp_f32 v19, v19
    v_exp_f32 v20, v20
    v_exp_f32 v21, v21
    v_mfma_f32_32x32x16_bf16 v[64:79], a[4:7], v[152:155], v[96:111]
    buffer_store_dwordx4 v[224:227], v236, s[4:7], s64 offen sc1
    v_exp_f32 v22, v22
    v_exp_f32 v23, v23
    v_exp_f32 v24, v24
    v_exp_f32 v25, v25
    v_smfmac_f32_32x32x32_bf16 v[112:127], v[160:163], v[16:23], v5
    s_bitcmp1_b32 s75, 9
    s_cselect_b32 s77, s76, s63
    s_add_u32 s64, s64, s77
    v_exp_f32 v26, v26
    v_exp_f32 v27, v27
    v_exp_f32 v28, v28
    v_exp_f32 v29, v29
    v_mfma_f32_16x16x32_bf16 v[232:235], v[10:13], v[224:227], v[232:235]
    v_exp_f32 v30, v30
    v_mfma_f32_32x32x4_2b_bf16 v[48:79], a[8:9], v[156:157], v[48:79]
    buffer_store_dwordx4 v[228:231], v236, s[4:7], s64 offen sc1
    v_exp_f32 v31, v31
    v_exp_f32 v32, v32
    v_exp_f32 v33, v33
    v_exp_f32 v34, v34
    v_exp_f32 v35, v35
    v_exp_f32 v36, v36
    v_exp_f32 v37, v37
    v_exp_f32 v38, v38
    v_smfmac_f32_32x32x32_bf16 v[112:127], v[164:167], v[24:31], v5
    v_exp_f32 v39, v39
    v_exp_f32 v40, v40
    v_exp_f32 v41, v41
    v_exp_f32 v42, v42
    v_smfmac_f32_32x32x32_bf16 v[112:127], v[168:171], v[32:39], v5
    v_exp_f32 v43, v43
    v_exp_f32 v44, v44
    v_exp_f32 v45, v45
    v_exp_f32 v46, v46
    v_mfma_f32_16x16x32_bf16 v[232:235], v[10:13], v[228:231], v[232:235]
    v_exp_f32 v47, v47
    v_mfma_f32_32x32x16_bf16 v[16:31], a[12:15], v[144:147], v[80:95]
    v_add_u32 v2, 61440, v2
    v_add_u32 v3, 61440, v3
    ds_read_b128 a[0:3], v2 offset:0
    v_exp_f32 v48, v48
    v_exp_f32 v49, v49
    v_exp_f32 v50, v50
    v_smfmac_f32_32x32x32_bf16 v[112:127], v[172:175], v[40:47], v5
    s_mov_b64 exec, s[42:43]
    ds_read_b128 v[176:179], v4 offset:56320
    ds_read_b128 v[180:183], v4 offset:56960
    ds_read_b128 v[184:187], v4 offset:57600
    ds_read_b128 v[188:191], v4 offset:58240
    s_mov_b64 exec, -1
    v_exp_f32 v51, v51
    v_exp_f32 v52, v52
    v_exp_f32 v53, v53
    v_mfma_f32_32x32x16_bf16 v[32:47], a[16:19], v[144:147], v[80:95]
    buffer_store_dword v232, v237, s[4:7], s65 offen sc1
    v_exp_f32 v54, v54
    v_exp_f32 v55, v55
    v_exp_f32 v56, v56
    v_exp_f32 v57, v57
    v_smfmac_f32_32x32x32_bf16 v[128:143], v[160:163], v[48:55], v5
    s_add_u32 m0, s66, 0
    ds_read_b128 a[4:7], v2 offset:1024
    ds_read_b64 a[8:9], v3 offset:0
    v_exp_f32 v58, v58
    v_exp_f32 v59, v59
    v_exp_f32 v60, v60
    v_exp_f32 v61, v61
    v_exp_f32 v62, v62
    v_mfma_f32_32x32x4_2b_bf16 v[16:47], a[20:21], v[148:149], v[16:47]
    buffer_load_dwordx4 v6, s[4:7], m0 offen offset:0 sc1 lds
    v_exp_f32 v63, v63
    v_exp_f32 v64, v64
    v_exp_f32 v65, v65
    v_exp_f32 v66, v66
    v_exp_f32 v67, v67
    v_exp_f32 v68, v68
    v_exp_f32 v69, v69
    v_exp_f32 v70, v70
    v_smfmac_f32_32x32x32_bf16 v[128:143], v[164:167], v[56:63], v5
    v_exp_f32 v71, v71
    v_exp_f32 v72, v72
    v_exp_f32 v73, v73
    v_exp_f32 v74, v74
    v_smfmac_f32_32x32x32_bf16 v[128:143], v[168:171], v[64:71], v5
    s_nop 0
    buffer_load_dwordx4 v6, s[4:7], m0 offen offset:1024 sc1 lds
    v_exp_f32 v75, v75
    v_exp_f32 v76, v76
    v_exp_f32 v77, v77
    v_exp_f32 v78, v78
    v_exp_f32 v79, v79
    v_mfma_f32_32x32x16_bf16 v[48:63], a[12:15], v[152:155], v[96:111]
    v_exp_f32 v16, v16
    v_exp_f32 v17, v17
    v_exp_f32 v18, v18
    v_smfmac_f32_32x32x32_bf16 v[128:143], v[172:175], v[72:79], v5
    s_waitcnt lgkmcnt(0)
    v_exp_f32 v19, v19
    v_exp_f32 v20, v20
    v_exp_f32 v21, v21
    v_mfma_f32_32x32x16_bf16 v[64:79], a[16:19], v[152:155], v[96:111]
    buffer_load_dwordx4 v6, s[4:7], m0 offen offset:2048 sc1 lds
    v_exp_f32 v22, v22
    v_exp_f32 v23, v23
    v_exp_f32 v24, v24
    v_exp_f32 v25, v25
    v_smfmac_f32_32x32x32_bf16 v[112:127], v[176:179], v[16:23], v5
    v_exp_f32 v26, v26
    v_exp_f32 v27, v27
    v_exp_f32 v28, v28
    v_exp_f32 v29, v29
    v_exp_f32 v30, v30
    v_mfma_f32_32x32x4_2b_bf16 v[48:79], a[20:21], v[156:157], v[48:79]
    buffer_load_dwordx4 v6, s[4:7], m0 offen offset:3072 sc1 lds
    v_exp_f32 v31, v31
    v_exp_f32 v32, v32
    v_exp_f32 v33, v33
    v_exp_f32 v34, v34
    v_exp_f32 v35, v35
    v_exp_f32 v36, v36
    v_exp_f32 v37, v37
    v_exp_f32 v38, v38
    v_smfmac_f32_32x32x32_bf16 v[112:127], v[180:183], v[24:31], v5
    s_add_u32 m0, s66, 4096
    v_exp_f32 v39, v39
    v_exp_f32 v40, v40
    v_exp_f32 v41, v41
    v_exp_f32 v42, v42
    v_smfmac_f32_32x32x32_bf16 v[112:127], v[184:187], v[32:39], v5
    s_nop 0
    buffer_load_dwordx4 v6, s[4:7], m0 offen offset:0 sc1 lds
    v_exp_f32 v43, v43
    v_exp_f32 v44, v44
    v_exp_f32 v45, v45
    v_exp_f32 v46, v46
    v_exp_f32 v47, v47
    v_mfma_f32_32x32x16_bf16 v[16:31], a[0:3], v[144:147], v[80:95]
    ds_read_b128 a[12:15], v2 offset:5120
    v_exp_f32 v48, v48
    v_exp_f32 v49, v49
    v_exp_f32 v50, v50
    v_smfmac_f32_32x32x32_bf16 v[112:127], v[188:191], v[40:47], v5
    v_add_u32 v4, 61440, v4
    s_mov_b64 exec, s[42:43]
    ds_read_b128 v[160:163], v4 offset:0
    ds_read_b128 v[164:167], v4 offset:640
    ds_read_b128 v[168:171], v4 offset:1280
    ds_read_b128 v[172:175], v4 offset:1920
    s_mov_b64 exec, -1
    v_exp_f32 v51, v51
    v_exp_f32 v52, v52
    v_exp_f32 v53, v53
    v_mfma_f32_32x32x16_bf16 v[32:47], a[4:7], v[144:147], v[80:95]
    buffer_load_dwordx4 v6, s[4:7], m0 offen offset:1024 sc1 lds
    v_exp_f32 v54, v54
    v_exp_f32 v55, v55
    v_exp_f32 v56, v56
    v_exp_f32 v57, v57
    v_smfmac_f32_32x32x32_bf16 v[128:143], v[176:179], v[48:55], v5
    s_nop 0
    ds_read_b128 a[16:19], v2 offset:6144
    ds_read_b64 a[20:21], v3 offset:5120
    v_exp_f32 v58, v58
    v_exp_f32 v59, v59
    v_exp_f32 v60, v60
    v_exp_f32 v61, v61
    v_exp_f32 v62, v62
    v_mfma_f32_32x32x4_2b_bf16 v[16:47], a[8:9], v[148:149], v[16:47]
    buffer_load_dwordx4 v6, s[4:7], m0 offen offset:2048 sc1 lds
    v_exp_f32 v63, v63
    v_exp_f32 v64, v64
    v_exp_f32 v65, v65
    v_exp_f32 v66, v66
    v_exp_f32 v67, v67
    v_exp_f32 v68, v68
    v_exp_f32 v69, v69
    v_exp_f32 v70, v70
    v_smfmac_f32_32x32x32_bf16 v[128:143], v[180:183], v[56:63], v5
    v_exp_f32 v71, v71
    v_exp_f32 v72, v72
    v_exp_f32 v73, v73
    v_exp_f32 v74, v74
    v_smfmac_f32_32x32x32_bf16 v[128:143], v[184:187], v[64:71], v5
    s_nop 0
    buffer_load_dwordx4 v6, s[4:7], m0 offen offset:3072 sc1 lds
    v_exp_f32 v75, v75
    v_exp_f32 v76, v76
    v_exp_f32 v77, v77
    v_exp_f32 v78, v78
    v_exp_f32 v79, v79
    v_mfma_f32_32x32x16_bf16 v[48:63], a[0:3], v[152:155], v[96:111]
    s_add_u32 m0, s66, 8192
    v_exp_f32 v16, v16
    v_exp_f32 v17, v17
    v_exp_f32 v18, v18
    v_smfmac_f32_32x32x32_bf16 v[128:143], v[188:191], v[72:79], v5
    s_waitcnt lgkmcnt(0)
    v_exp_f32 v19, v19
    v_exp_f32 v20, v20
    v_exp_f32 v21, v21
    v_mfma_f32_32x32x16_bf16 v[64:79], a[4:7], v[152:155], v[96:111]
k2_main_kernel_pad_P4:
    s_cbranch_execz k2_main_kernel_tr_gp0
    buffer_load_dwordx4 v6, s[4:7], m0 offen offset:0 sc1 lds
    v_exp_f32 v22, v22
    v_exp_f32 v23, v23
    v_exp_f32 v24, v24
    v_exp_f32 v25, v25
    v_smfmac_f32_32x32x32_bf16 v[112:127], v[160:163], v[16:23], v5
    v_exp_f32 v26, v26
    v_exp_f32 v27, v27
    v_exp_f32 v28, v28
    v_exp_f32 v29, v29
    v_exp_f32 v30, v30
    v_mfma_f32_32x32x4_2b_bf16 v[48:79], a[8:9], v[156:157], v[48:79]
    buffer_load_dwordx4 v6, s[4:7], m0 offen offset:1024 sc1 lds
    v_exp_f32 v31, v31
    v_exp_f32 v32, v32
    v_exp_f32 v33, v33
    v_exp_f32 v34, v34
    v_exp_f32 v35, v35
    v_exp_f32 v36, v36
    v_exp_f32 v37, v37
    v_exp_f32 v38, v38
    v_smfmac_f32_32x32x32_bf16 v[112:127], v[164:167], v[24:31], v5
    v_mul_u32_u24 v14, 40, v0
    v_exp_f32 v39, v39
    v_exp_f32 v40, v40
    v_exp_f32 v41, v41
    v_exp_f32 v42, v42
    v_smfmac_f32_32x32x32_bf16 v[112:127], v[168:171], v[32:39], v5
    s_nop 0
    buffer_load_dword v15, v14, s[4:7], s83 offen sc1
    v_exp_f32 v43, v43
    v_exp_f32 v44, v44
    v_exp_f32 v45, v45
    v_exp_f32 v46, v46
    v_exp_f32 v47, v47
    v_mfma_f32_32x32x16_bf16 v[16:31], a[12:15], v[144:147], v[80:95]
    ds_read_b128 a[0:3], v2 offset:10240
    v_exp_f32 v48, v48
    v_exp_f32 v49, v49
    v_exp_f32 v50, v50
    v_smfmac_f32_32x32x32_bf16 v[112:127], v[172:175], v[40:47], v5
    s_mov_b64 exec, s[42:43]
    ds_read_b128 v[176:179], v4 offset:5120
    ds_read_b128 v[180:183], v4 offset:5760
    ds_read_b128 v[184:187], v4 offset:6400
    ds_read_b128 v[188:191], v4 offset:7040
    s_mov_b64 exec, -1
    v_exp_f32 v51, v51
    v_exp_f32 v52, v52
    v_exp_f32 v53, v53
    v_mfma_f32_32x32x16_bf16 v[32:47], a[16:19], v[144:147], v[80:95]
    v_exp_f32 v54, v54
    v_exp_f32 v55, v55
    v_exp_f32 v56, v56
    v_exp_f32 v57, v57
    v_smfmac_f32_32x32x32_bf16 v[128:143], v[160:163], v[48:55], v5
    s_nop 0
    ds_read_b128 a[4:7], v2 offset:11264
    ds_read_b64 a[8:9], v3 offset:10240
    v_exp_f32 v58, v58
    v_exp_f32 v59, v59
    v_exp_f32 v60, v60
    v_exp_f32 v61, v61
    v_exp_f32 v62, v62
    v_mfma_f32_32x32x4_2b_bf16 v[16:47], a[20:21], v[148:149], v[16:47]
    v_exp_f32 v63, v63
    v_exp_f32 v64, v64
    v_exp_f32 v65, v65
    v_exp_f32 v66, v66
    v_exp_f32 v67, v67
    v_exp_f32 v68, v68
    v_exp_f32 v69, v69
    v_exp_f32 v70, v70
    v_smfmac_f32_32x32x32_bf16 v[128:143], v[164:167], v[56:63], v5
    v_exp_f32 v71, v71
    v_exp_f32 v72, v72
    v_exp_f32 v73, v73
    v_exp_f32 v74, v74
    v_smfmac_f32_32x32x32_bf16 v[128:143], v[168:171], v[64:71], v5
    v_exp_f32 v75, v75
    v_exp_f32 v76, v76
    v_exp_f32 v77, v77
    v_exp_f32 v78, v78
    v_exp_f32 v79, v79
    v_mfma_f32_32x32x16_bf16 v[48:63], a[12:15], v[152:155], v[96:111]
    s_waitcnt vmcnt(11)
    s_barrier
    buffer_store_dword v8, off, s[4:7], s67 sc1
    v_exp_f32 v16, v16
    v_exp_f32 v17, v17
    v_exp_f32 v18, v18
    v_smfmac_f32_32x32x32_bf16 v[128:143], v[172:175], v[72:79], v5
    s_waitcnt lgkmcnt(0)
    v_exp_f32 v19, v19
    v_exp_f32 v20, v20
    v_exp_f32 v21, v21
    v_mfma_f32_32x32x16_bf16 v[64:79], a[16:19], v[152:155], v[96:111]
    v_exp_f32 v22, v22
    v_exp_f32 v23, v23
    v_exp_f32 v24, v24
    v_exp_f32 v25, v25
    v_smfmac_f32_32x32x32_bf16 v[112:127], v[176:179], v[16:23], v5
    v_exp_f32 v26, v26
    v_exp_f32 v27, v27
    v_exp_f32 v28, v28
    v_exp_f32 v29, v29
    v_exp_f32 v30, v30
    v_mfma_f32_32x32x4_2b_bf16 v[48:79], a[20:21], v[156:157], v[48:79]
    v_exp_f32 v31, v31
    v_exp_f32 v32, v32
    v_exp_f32 v33, v33
    v_exp_f32 v34, v34
    v_exp_f32 v35, v35
    v_exp_f32 v36, v36
    v_exp_f32 v37, v37
    v_exp_f32 v38, v38
    v_smfmac_f32_32x32x32_bf16 v[112:127], v[180:183], v[24:31], v5
    v_exp_f32 v39, v39
    v_exp_f32 v40, v40
    v_exp_f32 v41, v41
    v_exp_f32 v42, v42
    v_smfmac_f32_32x32x32_bf16 v[112:127], v[184:187], v[32:39], v5
    v_exp_f32 v43, v43
    v_exp_f32 v44, v44
    v_exp_f32 v45, v45
    v_exp_f32 v46, v46
    v_exp_f32 v47, v47
    v_mfma_f32_32x32x16_bf16 v[16:31], a[0:3], v[144:147], v[80:95]
    ds_read_b128 a[12:15], v2 offset:15360
    v_exp_f32 v48, v48
    v_exp_f32 v49, v49
    v_exp_f32 v50, v50
    v_smfmac_f32_32x32x32_bf16 v[112:127], v[188:191], v[40:47], v5
    s_mov_b64 exec, s[42:43]
    ds_read_b128 v[160:163], v4 offset:10240
    ds_read_b128 v[164:167], v4 offset:10880
    ds_read_b128 v[168:171], v4 offset:11520
    ds_read_b128 v[172:175], v4 offset:12160
    s_mov_b64 exec, -1
    v_exp_f32 v51, v51
    v_exp_f32 v52, v52
    v_exp_f32 v53, v53
    v_mfma_f32_32x32x16_bf16 v[32:47], a[4:7], v[144:147], v[80:95]
    s_mul_i32 s23, s50, 20480
    v_exp_f32 v54, v54
    v_exp_f32 v55, v55
    v_exp_f32 v56, v56
    v_exp_f32 v57, v57
    v_smfmac_f32_32x32x32_bf16 v[128:143], v[176:179], v[48:55], v5
    s_add_u32 s23, s23, 6029312
    ds_read_b128 a[16:19], v2 offset:16384
    ds_read_b64 a[20:21], v3 offset:15360
    v_exp_f32 v58, v58
    v_exp_f32 v59, v59
    v_exp_f32 v60, v60
    v_exp_f32 v61, v61
    v_exp_f32 v62, v62
    v_mfma_f32_32x32x4_2b_bf16 v[16:47], a[8:9], v[148:149], v[16:47]
    s_lshl_b32 s49, s52, 1
    v_exp_f32 v63, v63
    v_exp_f32 v64, v64
    v_exp_f32 v65, v65
    v_exp_f32 v66, v66
    v_exp_f32 v67, v67
    v_exp_f32 v68, v68
    v_exp_f32 v69, v69
    v_exp_f32 v70, v70
    v_smfmac_f32_32x32x32_bf16 v[128:143], v[180:183], v[56:63], v5
    s_and_b32 s40, s3, 1
    v_exp_f32 v71, v71
    v_exp_f32 v72, v72
    v_exp_f32 v73, v73
    v_exp_f32 v74, v74
    v_smfmac_f32_32x32x32_bf16 v[128:143], v[184:187], v[64:71], v5
    s_add_u32 s49, s49, s40
    v_exp_f32 v75, v75
    v_exp_f32 v76, v76
    v_exp_f32 v77, v77
    v_exp_f32 v78, v78
    v_exp_f32 v79, v79
    v_mfma_f32_32x32x16_bf16 v[48:63], a[0:3], v[152:155], v[96:111]
    s_lshl_b32 s48, s49, 10
    v_exp_f32 v16, v16
    v_exp_f32 v17, v17
    v_exp_f32 v18, v18
    v_smfmac_f32_32x32x32_bf16 v[128:143], v[188:191], v[72:79], v5
    s_waitcnt lgkmcnt(0)
    v_exp_f32 v19, v19
    v_exp_f32 v20, v20
    v_exp_f32 v21, v21
    v_mfma_f32_32x32x16_bf16 v[64:79], a[4:7], v[152:155], v[96:111]
    s_add_u32 s48, s48, s23
    v_exp_f32 v22, v22
    v_exp_f32 v23, v23
    v_exp_f32 v24, v24
    v_exp_f32 v25, v25
    v_smfmac_f32_32x32x32_bf16 v[112:127], v[160:163], v[16:23], v5
    s_lshl_b32 s49, s49, 8
    v_exp_f32 v26, v26
    v_exp_f32 v27, v27
    v_exp_f32 v28, v28
    v_exp_f32 v29, v29
    v_exp_f32 v30, v30
    v_mfma_f32_32x32x4_2b_bf16 v[48:79], a[8:9], v[156:157], v[48:79]
    s_add_u32 s49, s49, s23
    v_exp_f32 v31, v31
    v_exp_f32 v32, v32
    v_exp_f32 v33, v33
    v_exp_f32 v34, v34
    v_exp_f32 v35, v35
    v_exp_f32 v36, v36
    v_exp_f32 v37, v37
    v_exp_f32 v38, v38
    v_smfmac_f32_32x32x32_bf16 v[112:127], v[164:167], v[24:31], v5
    s_add_u32 s49, s49, 16384
    v_exp_f32 v39, v39
    v_exp_f32 v40, v40
    v_exp_f32 v41, v41
    v_exp_f32 v42, v42
    v_smfmac_f32_32x32x32_bf16 v[112:127], v[168:171], v[32:39], v5
    s_mul_i32 s40, s40, 40960
    v_exp_f32 v43, v43
    v_exp_f32 v44, v44
    v_exp_f32 v45, v45
    v_exp_f32 v46, v46
    v_exp_f32 v47, v47
    v_mfma_f32_32x32x16_bf16 v[16:31], a[12:15], v[144:147], v[80:95]
    ds_read_b128 a[0:3], v2 offset:20480
    v_exp_f32 v48, v48
    v_exp_f32 v49, v49
    v_exp_f32 v50, v50
    v_smfmac_f32_32x32x32_bf16 v[112:127], v[172:175], v[40:47], v5
    s_mov_b64 exec, s[42:43]
    ds_read_b128 v[176:179], v4 offset:15360
    ds_read_b128 v[180:183], v4 offset:16000
    ds_read_b128 v[184:187], v4 offset:16640
    ds_read_b128 v[188:191], v4 offset:17280
    s_mov_b64 exec, -1
    v_exp_f32 v51, v51
    v_exp_f32 v52, v52
    v_exp_f32 v53, v53
    v_mfma_f32_32x32x16_bf16 v[32:47], a[16:19], v[144:147], v[80:95]
    s_sub_u32 s40, 20480, s40
    v_exp_f32 v54, v54
    v_exp_f32 v55, v55
    v_exp_f32 v56, v56
    v_exp_f32 v57, v57
    v_smfmac_f32_32x32x32_bf16 v[128:143], v[160:163], v[48:55], v5
    s_add_u32 s16, s48, s40
    ds_read_b128 a[4:7], v2 offset:21504
    ds_read_b64 a[8:9], v3 offset:20480
    v_exp_f32 v58, v58
    v_exp_f32 v59, v59
    v_exp_f32 v60, v60
    v_exp_f32 v61, v61
    v_exp_f32 v62, v62
    v_mfma_f32_32x32x4_2b_bf16 v[16:47], a[20:21], v[148:149], v[16:47]
    s_add_u32 s17, s49, s40
    v_exp_f32 v63, v63
    v_exp_f32 v64, v64
    v_exp_f32 v65, v65
    v_exp_f32 v66, v66
    v_exp_f32 v67, v67
    v_exp_f32 v68, v68
    v_exp_f32 v69, v69
    v_exp_f32 v70, v70
    v_smfmac_f32_32x32x32_bf16 v[128:143], v[164:167], v[56:63], v5
    s_lshl_b32 s65, s50, 10
    v_exp_f32 v71, v71
    v_exp_f32 v72, v72
    v_exp_f32 v73, v73
    v_exp_f32 v74, v74
    v_smfmac_f32_32x32x32_bf16 v[128:143], v[168:171], v[64:71], v5
    s_lshl_b32 s66, s52, 7
    v_exp_f32 v75, v75
    v_exp_f32 v76, v76
    v_exp_f32 v77, v77
    v_exp_f32 v78, v78
    v_exp_f32 v79, v79
    v_mfma_f32_32x32x16_bf16 v[48:63], a[12:15], v[152:155], v[96:111]
    s_add_u32 s65, s65, s66
    v_exp_f32 v16, v16
    v_exp_f32 v17, v17
    v_exp_f32 v18, v18
    v_smfmac_f32_32x32x32_bf16 v[128:143], v[172:175], v[72:79], v5
    s_waitcnt lgkmcnt(0)
    v_exp_f32 v19, v19
    v_exp_f32 v20, v20
    v_exp_f32 v21, v21
    v_mfma_f32_32x32x16_bf16 v[64:79], a[16:19], v[152:155], v[96:111]
    s_add_u32 s65, s65, 27525120
    v_exp_f32 v22, v22
    v_exp_f32 v23, v23
    v_exp_f32 v24, v24
    v_exp_f32 v25, v25
    v_smfmac_f32_32x32x32_bf16 v[112:127], v[176:179], v[16:23], v5
    s_and_b32 s40, s3, 1
    v_exp_f32 v26, v26
    v_exp_f32 v27, v27
    v_exp_f32 v28, v28
    v_exp_f32 v29, v29
    v_exp_f32 v30, v30
    v_mfma_f32_32x32x4_2b_bf16 v[48:79], a[20:21], v[156:157], v[48:79]
    s_lshr_b32 s66, s22, 1
    v_exp_f32 v31, v31
    v_exp_f32 v32, v32
    v_exp_f32 v33, v33
    v_exp_f32 v34, v34
    v_exp_f32 v35, v35
    v_exp_f32 v36, v36
    v_exp_f32 v37, v37
    v_exp_f32 v38, v38
    v_smfmac_f32_32x32x32_bf16 v[112:127], v[180:183], v[24:31], v5
    s_lshl_b32 s66, s66, 2
    v_exp_f32 v39, v39
    v_exp_f32 v40, v40
    v_exp_f32 v41, v41
    v_exp_f32 v42, v42
    v_smfmac_f32_32x32x32_bf16 v[112:127], v[184:187], v[32:39], v5
    s_add_u32 s66, s66, s40
    v_exp_f32 v43, v43
    v_exp_f32 v44, v44
    v_exp_f32 v45, v45
    v_exp_f32 v46, v46
    v_exp_f32 v47, v47
    v_mfma_f32_32x32x16_bf16 v[16:31], a[0:3], v[144:147], v[80:95]
    ds_read_b128 a[12:15], v2 offset:25600
    v_exp_f32 v48, v48
    v_exp_f32 v49, v49
    v_exp_f32 v50, v50
    v_smfmac_f32_32x32x32_bf16 v[112:127], v[188:191], v[40:47], v5
    s_mov_b64 exec, s[42:43]
    ds_read_b128 v[160:163], v4 offset:20480
    ds_read_b128 v[164:167], v4 offset:21120
    ds_read_b128 v[168:171], v4 offset:21760
    ds_read_b128 v[172:175], v4 offset:22400
    s_mov_b64 exec, -1
    v_exp_f32 v51, v51
    v_exp_f32 v52, v52
    v_exp_f32 v53, v53
    v_mfma_f32_32x32x16_bf16 v[32:47], a[4:7], v[144:147], v[80:95]
    s_lshl_b32 s66, s66, 9
    v_exp_f32 v54, v54
    v_exp_f32 v55, v55
    v_exp_f32 v56, v56
    v_exp_f32 v57, v57
    v_smfmac_f32_32x32x32_bf16 v[128:143], v[176:179], v[48:55], v5
    s_add_u32 s66, s66, 27525120
    ds_read_b128 a[16:19], v2 offset:26624
    ds_read_b64 a[20:21], v3 offset:25600
    v_exp_f32 v58, v58
    v_exp_f32 v59, v59
    v_exp_f32 v60, v60
    v_exp_f32 v61, v61
    v_exp_f32 v62, v62
    v_mfma_f32_32x32x4_2b_bf16 v[16:47], a[8:9], v[148:149], v[16:47]
    s_lshl_b32 s40, s40, 11
    v_exp_f32 v63, v63
    v_exp_f32 v64, v64
    v_exp_f32 v65, v65
    v_exp_f32 v66, v66
    v_exp_f32 v67, v67
    v_exp_f32 v68, v68
    v_exp_f32 v69, v69
    v_exp_f32 v70, v70
    v_smfmac_f32_32x32x32_bf16 v[128:143], v[180:183], v[56:63], v5
    s_add_u32 s8, s23, s40
    v_exp_f32 v71, v71
    v_exp_f32 v72, v72
    v_exp_f32 v73, v73
    v_exp_f32 v74, v74
    v_smfmac_f32_32x32x32_bf16 v[128:143], v[184:187], v[64:71], v5
    s_add_u32 s8, s8, 16384
    v_exp_f32 v75, v75
    v_exp_f32 v76, v76
    v_exp_f32 v77, v77
    v_exp_f32 v78, v78
    v_exp_f32 v79, v79
    v_mfma_f32_32x32x16_bf16 v[48:63], a[0:3], v[152:155], v[96:111]
    buffer_load_dword v13, v239, s[4:7], s100 offen sc1
    v_exp_f32 v16, v16
    v_exp_f32 v17, v17
    v_exp_f32 v18, v18
    v_smfmac_f32_32x32x32_bf16 v[128:143], v[188:191], v[72:79], v5
    s_waitcnt lgkmcnt(0)
    v_exp_f32 v19, v19
    v_exp_f32 v20, v20
    v_exp_f32 v21, v21
    v_mfma_f32_32x32x16_bf16 v[64:79], a[4:7], v[152:155], v[96:111]
    s_lshl2_add_u32 s24, s40, s23
    v_exp_f32 v22, v22
    v_exp_f32 v23, v23
    v_exp_f32 v24, v24
    v_exp_f32 v25, v25
    v_smfmac_f32_32x32x32_bf16 v[112:127], v[160:163], v[16:23], v5
    s_mul_i32 s11, s40, 20
    v_exp_f32 v26, v26
    v_exp_f32 v27, v27
    v_exp_f32 v28, v28
    v_exp_f32 v29, v29
    v_exp_f32 v30, v30
    v_mfma_f32_32x32x4_2b_bf16 v[48:79], a[8:9], v[156:157], v[48:79]
    s_sub_u32 s10, 20480, s11
    v_exp_f32 v31, v31
    v_exp_f32 v32, v32
    v_exp_f32 v33, v33
    v_exp_f32 v34, v34
    v_exp_f32 v35, v35
    v_exp_f32 v36, v36
    v_exp_f32 v37, v37
    v_exp_f32 v38, v38
    v_smfmac_f32_32x32x32_bf16 v[112:127], v[164:167], v[24:31], v5
    s_add_u32 s9, s24, s10
    v_exp_f32 v39, v39
    v_exp_f32 v40, v40
    v_exp_f32 v41, v41
    v_exp_f32 v42, v42
    v_smfmac_f32_32x32x32_bf16 v[112:127], v[168:171], v[32:39], v5
    s_add_u32 s10, s8, s10
    v_exp_f32 v43, v43
    v_exp_f32 v44, v44
    v_exp_f32 v45, v45
    v_exp_f32 v46, v46
    v_exp_f32 v47, v47
    v_mfma_f32_32x32x16_bf16 v[16:31], a[12:15], v[144:147], v[80:95]
    ds_read_b128 a[0:3], v2 offset:30720
    v_exp_f32 v48, v48
    v_exp_f32 v49, v49
    v_exp_f32 v50, v50
    v_smfmac_f32_32x32x32_bf16 v[112:127], v[172:175], v[40:47], v5
    s_mov_b64 exec, s[42:43]
    ds_read_b128 v[176:179], v4 offset:25600
    ds_read_b128 v[180:183], v4 offset:26240
    ds_read_b128 v[184:187], v4 offset:26880
    ds_read_b128 v[188:191], v4 offset:27520
    s_mov_b64 exec, -1
    v_exp_f32 v51, v51
    v_exp_f32 v52, v52
    v_exp_f32 v53, v53
    v_mfma_f32_32x32x16_bf16 v[32:47], a[16:19], v[144:147], v[80:95]
    s_mul_i32 s12, s40, 5
    v_exp_f32 v54, v54
    v_exp_f32 v55, v55
    v_exp_f32 v56, v56
    v_exp_f32 v57, v57
    v_smfmac_f32_32x32x32_bf16 v[128:143], v[160:163], v[48:55], v5
    s_add_u32 s12, s12, 81920
    ds_read_b128 a[4:7], v2 offset:31744
    ds_read_b64 a[8:9], v3 offset:30720
    v_exp_f32 v58, v58
    v_exp_f32 v59, v59
    v_exp_f32 v60, v60
    v_exp_f32 v61, v61
    v_exp_f32 v62, v62
    v_mfma_f32_32x32x4_2b_bf16 v[16:47], a[20:21], v[148:149], v[16:47]
    s_add_u32 s13, s31, 143360
    v_exp_f32 v63, v63
    v_exp_f32 v64, v64
    v_exp_f32 v65, v65
    v_exp_f32 v66, v66
    v_exp_f32 v67, v67
    v_exp_f32 v68, v68
    v_exp_f32 v69, v69
    v_exp_f32 v70, v70
    v_smfmac_f32_32x32x32_bf16 v[128:143], v[164:167], v[56:63], v5
    s_xor_b32 s14, s3, 1
    v_exp_f32 v71, v71
    v_exp_f32 v72, v72
    v_exp_f32 v73, v73
    v_exp_f32 v74, v74
    v_smfmac_f32_32x32x32_bf16 v[128:143], v[168:171], v[64:71], v5
    s_mul_i32 s14, s14, 5120
    v_exp_f32 v75, v75
    v_exp_f32 v76, v76
    v_exp_f32 v77, v77
    v_exp_f32 v78, v78
    v_exp_f32 v79, v79
    v_mfma_f32_32x32x16_bf16 v[48:63], a[12:15], v[152:155], v[96:111]
    s_add_u32 s14, s14, 143360
    v_exp_f32 v16, v16
    v_exp_f32 v17, v17
    v_exp_f32 v18, v18
    v_smfmac_f32_32x32x32_bf16 v[128:143], v[172:175], v[72:79], v5
    s_waitcnt lgkmcnt(0)
    v_exp_f32 v19, v19
    v_exp_f32 v20, v20
    v_exp_f32 v21, v21
    v_mfma_f32_32x32x16_bf16 v[64:79], a[16:19], v[152:155], v[96:111]
    s_and_b32 s40, s38, 1
    v_exp_f32 v22, v22
    v_exp_f32 v23, v23
    v_exp_f32 v24, v24
    v_exp_f32 v25, v25
    v_smfmac_f32_32x32x32_bf16 v[112:127], v[176:179], v[16:23], v5
    s_mul_i32 s50, s40, 8
    v_exp_f32 v26, v26
    v_exp_f32 v27, v27
    v_exp_f32 v28, v28
    v_exp_f32 v29, v29
    v_exp_f32 v30, v30
    v_mfma_f32_32x32x4_2b_bf16 v[48:79], a[20:21], v[156:157], v[48:79]
    s_lshr_b32 s40, s39, 2
    v_exp_f32 v31, v31
    v_exp_f32 v32, v32
    v_exp_f32 v33, v33
    v_exp_f32 v34, v34
    v_exp_f32 v35, v35
    v_exp_f32 v36, v36
    v_exp_f32 v37, v37
    v_exp_f32 v38, v38
    v_smfmac_f32_32x32x32_bf16 v[112:127], v[180:183], v[24:31], v5
    s_add_u32 s50, s50, s40
    v_exp_f32 v39, v39
    v_exp_f32 v40, v40
    v_exp_f32 v41, v41
    v_exp_f32 v42, v42
    v_smfmac_f32_32x32x32_bf16 v[112:127], v[184:187], v[32:39], v5
    s_lshr_b32 s40, s38, 1
    v_exp_f32 v43, v43
    v_exp_f32 v44, v44
    v_exp_f32 v45, v45
    v_exp_f32 v46, v46
    v_exp_f32 v47, v47
    v_mfma_f32_32x32x16_bf16 v[16:31], a[0:3], v[144:147], v[80:95]
    ds_read_b128 a[12:15], v2 offset:35840
    v_exp_f32 v48, v48
    v_exp_f32 v49, v49
    v_exp_f32 v50, v50
    v_smfmac_f32_32x32x32_bf16 v[112:127], v[188:191], v[40:47], v5
    s_mov_b64 exec, s[42:43]
    ds_read_b128 v[160:163], v4 offset:30720
    ds_read_b128 v[164:167], v4 offset:31360
    ds_read_b128 v[168:171], v4 offset:32000
    ds_read_b128 v[172:175], v4 offset:32640
    s_mov_b64 exec, -1
    v_exp_f32 v51, v51
    v_exp_f32 v52, v52
    v_exp_f32 v53, v53
    v_mfma_f32_32x32x16_bf16 v[32:47], a[4:7], v[144:147], v[80:95]
    s_lshl_b32 s40, s40, 2
    v_exp_f32 v54, v54
    v_exp_f32 v55, v55
    v_exp_f32 v56, v56
    v_exp_f32 v57, v57
    v_smfmac_f32_32x32x32_bf16 v[128:143], v[176:179], v[48:55], v5
    s_and_b32 s51, s39, 3
    ds_read_b128 a[16:19], v2 offset:36864
    ds_read_b64 a[20:21], v3 offset:35840
    v_exp_f32 v58, v58
    v_exp_f32 v59, v59
    v_exp_f32 v60, v60
    v_exp_f32 v61, v61
    v_exp_f32 v62, v62
    v_mfma_f32_32x32x4_2b_bf16 v[16:47], a[8:9], v[148:149], v[16:47]
    s_add_u32 s51, s51, s40
    v_exp_f32 v63, v63
    v_exp_f32 v64, v64
    v_exp_f32 v65, v65
    v_exp_f32 v66, v66
    v_exp_f32 v67, v67
    v_exp_f32 v68, v68
    v_exp_f32 v69, v69
    v_exp_f32 v70, v70
    v_smfmac_f32_32x32x32_bf16 v[128:143], v[180:183], v[56:63], v5
    s_mul_i32 s59, s3, 7168
    v_exp_f32 v71, v71
    v_exp_f32 v72, v72
    v_exp_f32 v73, v73
    v_exp_f32 v74, v74
    v_smfmac_f32_32x32x32_bf16 v[128:143], v[184:187], v[64:71], v5
    s_mul_i32 s53, s51, 286720
    v_exp_f32 v75, v75
    v_exp_f32 v76, v76
    v_exp_f32 v77, v77
    v_exp_f32 v78, v78
    v_exp_f32 v79, v79
    v_mfma_f32_32x32x16_bf16 v[48:63], a[0:3], v[152:155], v[96:111]
    s_waitcnt vmcnt(0)
    v_cmp_gt_u32 vcc, 1, v13
    s_cbranch_vccnz k2_main_kernel_pr
k2_main_kernel_prx:
    s_barrier
    s_add_u32 m0, s31, 0
    v_exp_f32 v16, v16
    v_exp_f32 v17, v17
    v_exp_f32 v18, v18
    v_smfmac_f32_32x32x32_bf16 v[128:143], v[188:191], v[72:79], v5
    s_waitcnt lgkmcnt(0)
    v_exp_f32 v19, v19
    v_exp_f32 v20, v20
    v_exp_f32 v21, v21
    v_mfma_f32_32x32x16_bf16 v[64:79], a[4:7], v[152:155], v[96:111]
    buffer_load_dwordx4 v9, s[4:7], m0 offen offset:0 sc1 lds
    v_exp_f32 v22, v22
    v_exp_f32 v23, v23
    v_exp_f32 v24, v24
    v_exp_f32 v25, v25
    v_smfmac_f32_32x32x32_bf16 v[112:127], v[160:163], v[16:23], v5
    s_add_u32 s53, s53, s59
    v_exp_f32 v26, v26
    v_exp_f32 v27, v27
    v_exp_f32 v28, v28
    v_exp_f32 v29, v29
    v_exp_f32 v30, v30
    v_mfma_f32_32x32x4_2b_bf16 v[48:79], a[8:9], v[156:157], v[48:79]
    buffer_load_dwordx4 v9, s[4:7], m0 offen offset:1024 sc1 lds
    v_exp_f32 v31, v31
    v_exp_f32 v32, v32
    v_exp_f32 v33, v33
    v_exp_f32 v34, v34
    v_exp_f32 v35, v35
    v_exp_f32 v36, v36
    v_exp_f32 v37, v37
    v_exp_f32 v38, v38
    v_smfmac_f32_32x32x32_bf16 v[112:127], v[164:167], v[24:31], v5
    s_add_u32 s53, s53, 19922944
    v_exp_f32 v39, v39
    v_exp_f32 v40, v40
    v_exp_f32 v41, v41
    v_exp_f32 v42, v42
    v_smfmac_f32_32x32x32_bf16 v[112:127], v[168:171], v[32:39], v5
    s_mul_i32 s26, s51, 7
    buffer_load_dwordx4 v9, s[4:7], m0 offen offset:2048 sc1 lds
    v_exp_f32 v43, v43
    v_exp_f32 v44, v44
    v_exp_f32 v45, v45
    v_exp_f32 v46, v46
    v_exp_f32 v47, v47
    v_mfma_f32_32x32x16_bf16 v[16:31], a[12:15], v[144:147], v[80:95]
    ds_read_b128 a[0:3], v2 offset:40960
    v_exp_f32 v48, v48
    v_exp_f32 v49, v49
    v_exp_f32 v50, v50
    v_smfmac_f32_32x32x32_bf16 v[112:127], v[172:175], v[40:47], v5
    s_mov_b64 exec, s[42:43]
    ds_read_b128 v[176:179], v4 offset:35840
    ds_read_b128 v[180:183], v4 offset:36480
    ds_read_b128 v[184:187], v4 offset:37120
    ds_read_b128 v[188:191], v4 offset:37760
    s_mov_b64 exec, -1
    v_exp_f32 v51, v51
    v_exp_f32 v52, v52
    v_exp_f32 v53, v53
    v_mfma_f32_32x32x16_bf16 v[32:47], a[16:19], v[144:147], v[80:95]
    buffer_load_dwordx4 v9, s[4:7], m0 offen offset:3072 sc1 lds
    v_exp_f32 v54, v54
    v_exp_f32 v55, v55
    v_exp_f32 v56, v56
    v_exp_f32 v57, v57
    v_smfmac_f32_32x32x32_bf16 v[128:143], v[160:163], v[48:55], v5
    s_add_u32 m0, s31, 4096
    ds_read_b128 a[4:7], v2 offset:41984
    ds_read_b64 a[8:9], v3 offset:40960
    v_exp_f32 v58, v58
    v_exp_f32 v59, v59
    v_exp_f32 v60, v60
    v_exp_f32 v61, v61
    v_exp_f32 v62, v62
    v_mfma_f32_32x32x4_2b_bf16 v[16:47], a[20:21], v[148:149], v[16:47]
    buffer_load_dwordx4 v9, s[4:7], m0 offen offset:0 sc1 lds
    v_exp_f32 v63, v63
    v_exp_f32 v64, v64
    v_exp_f32 v65, v65
    v_exp_f32 v66, v66
    v_exp_f32 v67, v67
    v_exp_f32 v68, v68
    v_exp_f32 v69, v69
    v_exp_f32 v70, v70
    v_smfmac_f32_32x32x32_bf16 v[128:143], v[164:167], v[56:63], v5
    v_and_b32 v14, 31, v0
    v_lshlrev_b32 v14, 10, v14
    v_exp_f32 v71, v71
    v_exp_f32 v72, v72
    v_exp_f32 v73, v73
    v_exp_f32 v74, v74
    v_smfmac_f32_32x32x32_bf16 v[128:143], v[168:171], v[64:71], v5
    s_add_u32 s35, s26, s3
    buffer_load_dword v15, v14, s[4:7], s101 offen sc1
    v_exp_f32 v75, v75
    v_exp_f32 v76, v76
    v_exp_f32 v77, v77
    v_exp_f32 v78, v78
    v_exp_f32 v79, v79
    v_mfma_f32_32x32x16_bf16 v[48:63], a[12:15], v[152:155], v[96:111]
    s_add_u32 s37, s71, 0
    v_exp_f32 v16, v16
    v_exp_f32 v17, v17
    v_exp_f32 v18, v18
    v_smfmac_f32_32x32x32_bf16 v[128:143], v[172:175], v[72:79], v5
    s_waitcnt lgkmcnt(0)
    v_exp_f32 v19, v19
    v_exp_f32 v20, v20
    v_exp_f32 v21, v21
    v_mfma_f32_32x32x16_bf16 v[64:79], a[16:19], v[152:155], v[96:111]
    buffer_load_dwordx4 a[160:163], v1, s[4:7], s37 offen offset:0 sc1
    v_exp_f32 v22, v22
    v_exp_f32 v23, v23
    v_exp_f32 v24, v24
    v_exp_f32 v25, v25
    v_smfmac_f32_32x32x32_bf16 v[112:127], v[176:179], v[16:23], v5
    s_lshl_b32 s56, s35, 10
    v_exp_f32 v26, v26
    v_exp_f32 v27, v27
    v_exp_f32 v28, v28
    v_exp_f32 v29, v29
    v_exp_f32 v30, v30
    v_mfma_f32_32x32x4_2b_bf16 v[48:79], a[20:21], v[156:157], v[48:79]
    buffer_load_dwordx4 a[164:167], v1, s[4:7], s37 offen offset:1024 sc1
    v_exp_f32 v31, v31
    v_exp_f32 v32, v32
    v_exp_f32 v33, v33
    v_exp_f32 v34, v34
    v_exp_f32 v35, v35
    v_exp_f32 v36, v36
    v_exp_f32 v37, v37
    v_exp_f32 v38, v38
    v_smfmac_f32_32x32x32_bf16 v[112:127], v[180:183], v[24:31], v5
    s_add_u32 s56, s56, 5767168
    v_exp_f32 v39, v39
    v_exp_f32 v40, v40
    v_exp_f32 v41, v41
    v_exp_f32 v42, v42
    v_smfmac_f32_32x32x32_bf16 v[112:127], v[184:187], v[32:39], v5
    s_add_u32 s57, s56, 4096
    buffer_load_dwordx4 a[168:171], v1, s[4:7], s37 offen offset:2048 sc1
    v_exp_f32 v43, v43
    v_exp_f32 v44, v44
    v_exp_f32 v45, v45
    v_exp_f32 v46, v46
    v_exp_f32 v47, v47
    v_mfma_f32_32x32x16_bf16 v[16:31], a[0:3], v[144:147], v[80:95]
    ds_read_b128 a[12:15], v2 offset:46080
    v_exp_f32 v48, v48
    v_exp_f32 v49, v49
    v_exp_f32 v50, v50
    v_smfmac_f32_32x32x32_bf16 v[112:127], v[188:191], v[40:47], v5
    s_mov_b64 exec, s[42:43]
    ds_read_b128 v[160:163], v4 offset:40960
    ds_read_b128 v[164:167], v4 offset:41600
    ds_read_b128 v[168:171], v4 offset:42240
    ds_read_b128 v[172:175], v4 offset:42880
    s_mov_b64 exec, -1
    v_exp_f32 v51, v51
    v_exp_f32 v52, v52
    v_exp_f32 v53, v53
    v_mfma_f32_32x32x16_bf16 v[32:47], a[4:7], v[144:147], v[80:95]
    buffer_load_dwordx4 a[172:175], v1, s[4:7], s37 offen offset:3072 sc1
    v_exp_f32 v54, v54
    v_exp_f32 v55, v55
    v_exp_f32 v56, v56
    v_exp_f32 v57, v57
    v_smfmac_f32_32x32x32_bf16 v[128:143], v[176:179], v[48:55], v5
    s_add_u32 s37, s71, 4096
    ds_read_b128 a[16:19], v2 offset:47104
    ds_read_b64 a[20:21], v3 offset:46080
    v_exp_f32 v58, v58
    v_exp_f32 v59, v59
    v_exp_f32 v60, v60
    v_exp_f32 v61, v61
    v_exp_f32 v62, v62
    v_mfma_f32_32x32x4_2b_bf16 v[16:47], a[8:9], v[148:149], v[16:47]
    buffer_load_dwordx4 a[176:179], v1, s[4:7], s37 offen offset:0 sc1
    v_exp_f32 v63, v63
    v_exp_f32 v64, v64
    v_exp_f32 v65, v65
    v_exp_f32 v66, v66
    v_exp_f32 v67, v67
    v_exp_f32 v68, v68
    v_exp_f32 v69, v69
    v_exp_f32 v70, v70
    v_smfmac_f32_32x32x32_bf16 v[128:143], v[180:183], v[56:63], v5
    s_mul_i32 s25, s22, 20480
    v_exp_f32 v71, v71
    v_exp_f32 v72, v72
    v_exp_f32 v73, v73
    v_exp_f32 v74, v74
    v_smfmac_f32_32x32x32_bf16 v[128:143], v[184:187], v[64:71], v5
    s_mul_i32 s26, s21, 160
    buffer_load_dwordx4 a[180:183], v1, s[4:7], s37 offen offset:1024 sc1
    v_exp_f32 v75, v75
    v_exp_f32 v76, v76
    v_exp_f32 v77, v77
    v_exp_f32 v78, v78
    v_exp_f32 v79, v79
    v_mfma_f32_32x32x16_bf16 v[48:63], a[0:3], v[152:155], v[96:111]
    s_add_u32 s25, s25, s26
    v_exp_f32 v16, v16
    v_exp_f32 v17, v17
    v_exp_f32 v18, v18
    v_smfmac_f32_32x32x32_bf16 v[128:143], v[188:191], v[72:79], v5
    s_waitcnt lgkmcnt(0)
    v_exp_f32 v19, v19
    v_exp_f32 v20, v20
    v_exp_f32 v21, v21
    v_mfma_f32_32x32x16_bf16 v[64:79], a[4:7], v[152:155], v[96:111]
    buffer_load_dwordx4 a[184:187], v1, s[4:7], s37 offen offset:2048 sc1
    v_exp_f32 v22, v22
    v_exp_f32 v23, v23
    v_exp_f32 v24, v24
    v_exp_f32 v25, v25
    v_smfmac_f32_32x32x32_bf16 v[112:127], v[160:163], v[16:23], v5
    s_mul_i32 s32, s3, 3072
    v_exp_f32 v26, v26
    v_exp_f32 v27, v27
    v_exp_f32 v28, v28
    v_exp_f32 v29, v29
    v_exp_f32 v30, v30
    v_mfma_f32_32x32x4_2b_bf16 v[48:79], a[8:9], v[156:157], v[48:79]
    buffer_load_dwordx4 a[188:191], v1, s[4:7], s37 offen offset:3072 sc1
    v_exp_f32 v31, v31
    v_exp_f32 v32, v32
    v_exp_f32 v33, v33
    v_exp_f32 v34, v34
    v_exp_f32 v35, v35
    v_exp_f32 v36, v36
    v_exp_f32 v37, v37
    v_exp_f32 v38, v38
    v_smfmac_f32_32x32x32_bf16 v[112:127], v[164:167], v[24:31], v5
k2_main_kernel_pad_P5:
    s_cbranch_execz k2_main_kernel_tr_gp0
    s_add_u32 m0, s31, 20480
    v_exp_f32 v39, v39
    v_exp_f32 v40, v40
    v_exp_f32 v41, v41
    v_exp_f32 v42, v42
    v_smfmac_f32_32x32x32_bf16 v[112:127], v[168:171], v[32:39], v5
    s_add_u32 s32, s32, 102400
    buffer_load_dwordx4 v9, s[4:7], m0 offen offset:0 sc1 lds
    v_exp_f32 v43, v43
    v_exp_f32 v44, v44
    v_exp_f32 v45, v45
    v_exp_f32 v46, v46
    v_exp_f32 v47, v47
    v_mfma_f32_32x32x16_bf16 v[16:31], a[12:15], v[144:147], v[80:95]
    ds_read_b128 a[0:3], v2 offset:51200
    v_exp_f32 v48, v48
    v_exp_f32 v49, v49
    v_exp_f32 v50, v50
    v_smfmac_f32_32x32x32_bf16 v[112:127], v[172:175], v[40:47], v5
    s_mov_b64 exec, s[42:43]
    ds_read_b128 v[176:179], v4 offset:46080
    ds_read_b128 v[180:183], v4 offset:46720
    ds_read_b128 v[184:187], v4 offset:47360
    ds_read_b128 v[188:191], v4 offset:48000
    s_mov_b64 exec, -1
    v_exp_f32 v51, v51
    v_exp_f32 v52, v52
    v_exp_f32 v53, v53
    v_mfma_f32_32x32x16_bf16 v[32:47], a[16:19], v[144:147], v[80:95]
    buffer_load_dwordx4 v9, s[4:7], m0 offen offset:1024 sc1 lds
    v_exp_f32 v54, v54
    v_exp_f32 v55, v55
    v_exp_f32 v56, v56
    v_exp_f32 v57, v57
    v_smfmac_f32_32x32x32_bf16 v[128:143], v[160:163], v[48:55], v5
    s_lshr_b32 s35, s22, 1
    ds_read_b128 a[4:7], v2 offset:52224
    ds_read_b64 a[8:9], v3 offset:51200
    v_exp_f32 v58, v58
    v_exp_f32 v59, v59
    v_exp_f32 v60, v60
    v_exp_f32 v61, v61
    v_exp_f32 v62, v62
    v_mfma_f32_32x32x4_2b_bf16 v[16:47], a[20:21], v[148:149], v[16:47]
    buffer_load_dwordx4 v9, s[4:7], m0 offen offset:2048 sc1 lds
    v_exp_f32 v63, v63
    v_exp_f32 v64, v64
    v_exp_f32 v65, v65
    v_exp_f32 v66, v66
    v_exp_f32 v67, v67
    v_exp_f32 v68, v68
    v_exp_f32 v69, v69
    v_exp_f32 v70, v70
    v_smfmac_f32_32x32x32_bf16 v[128:143], v[164:167], v[56:63], v5
    s_mul_i32 s27, s35, 40960
    v_exp_f32 v71, v71
    v_exp_f32 v72, v72
    v_exp_f32 v73, v73
    v_exp_f32 v74, v74
    v_smfmac_f32_32x32x32_bf16 v[128:143], v[168:171], v[64:71], v5
    s_mul_i32 s28, s21, 5120
    buffer_load_dwordx4 v9, s[4:7], m0 offen offset:3072 sc1 lds
    v_exp_f32 v75, v75
    v_exp_f32 v76, v76
    v_exp_f32 v77, v77
    v_exp_f32 v78, v78
    v_exp_f32 v79, v79
    v_mfma_f32_32x32x16_bf16 v[48:63], a[12:15], v[152:155], v[96:111]
    s_add_u32 m0, s31, 24576
    v_exp_f32 v16, v16
    v_exp_f32 v17, v17
    v_exp_f32 v18, v18
    v_smfmac_f32_32x32x32_bf16 v[128:143], v[172:175], v[72:79], v5
    s_waitcnt lgkmcnt(0)
    v_exp_f32 v19, v19
    v_exp_f32 v20, v20
    v_exp_f32 v21, v21
    v_mfma_f32_32x32x16_bf16 v[64:79], a[16:19], v[152:155], v[96:111]
    buffer_load_dwordx4 v9, s[4:7], m0 offen offset:0 sc1 lds
    v_exp_f32 v22, v22
    v_exp_f32 v23, v23
    v_exp_f32 v24, v24
    v_exp_f32 v25, v25
    v_smfmac_f32_32x32x32_bf16 v[112:127], v[176:179], v[16:23], v5
    s_add_u32 s37, s71, 8192
    v_exp_f32 v26, v26
    v_exp_f32 v27, v27
    v_exp_f32 v28, v28
    v_exp_f32 v29, v29
    v_exp_f32 v30, v30
    v_mfma_f32_32x32x4_2b_bf16 v[48:79], a[20:21], v[156:157], v[48:79]
    buffer_load_dwordx4 a[192:195], v1, s[4:7], s37 offen offset:0 sc1
    v_exp_f32 v31, v31
    v_exp_f32 v32, v32
    v_exp_f32 v33, v33
    v_exp_f32 v34, v34
    v_exp_f32 v35, v35
    v_exp_f32 v36, v36
    v_exp_f32 v37, v37
    v_exp_f32 v38, v38
    v_smfmac_f32_32x32x32_bf16 v[112:127], v[180:183], v[24:31], v5
    s_add_u32 s27, s27, s28
    v_exp_f32 v39, v39
    v_exp_f32 v40, v40
    v_exp_f32 v41, v41
    v_exp_f32 v42, v42
    v_smfmac_f32_32x32x32_bf16 v[112:127], v[184:187], v[32:39], v5
    s_and_b32 s36, s22, 1
    buffer_load_dwordx4 a[196:199], v1, s[4:7], s37 offen offset:1024 sc1
    v_exp_f32 v43, v43
    v_exp_f32 v44, v44
    v_exp_f32 v45, v45
    v_exp_f32 v46, v46
    v_exp_f32 v47, v47
    v_mfma_f32_32x32x16_bf16 v[16:31], a[0:3], v[144:147], v[80:95]
    ds_read_b128 a[12:15], v2 offset:56320
    v_exp_f32 v48, v48
    v_exp_f32 v49, v49
    v_exp_f32 v50, v50
    v_smfmac_f32_32x32x32_bf16 v[112:127], v[188:191], v[40:47], v5
    s_mov_b64 exec, s[42:43]
    ds_read_b128 v[160:163], v4 offset:51200
    ds_read_b128 v[164:167], v4 offset:51840
    ds_read_b128 v[168:171], v4 offset:52480
    ds_read_b128 v[172:175], v4 offset:53120
    s_mov_b64 exec, -1
    v_exp_f32 v51, v51
    v_exp_f32 v52, v52
    v_exp_f32 v53, v53
    v_mfma_f32_32x32x16_bf16 v[32:47], a[4:7], v[144:147], v[80:95]
    buffer_load_dwordx4 a[200:203], v1, s[4:7], s37 offen offset:2048 sc1
    v_exp_f32 v54, v54
    v_exp_f32 v55, v55
    v_exp_f32 v56, v56
    v_exp_f32 v57, v57
    v_smfmac_f32_32x32x32_bf16 v[128:143], v[176:179], v[48:55], v5
    s_lshl_b32 s28, s36, 8
    ds_read_b128 a[16:19], v2 offset:57344
    ds_read_b64 a[20:21], v3 offset:56320
    v_exp_f32 v58, v58
    v_exp_f32 v59, v59
    v_exp_f32 v60, v60
    v_exp_f32 v61, v61
    v_exp_f32 v62, v62
    v_mfma_f32_32x32x4_2b_bf16 v[16:47], a[8:9], v[148:149], v[16:47]
    buffer_load_dwordx4 a[204:207], v1, s[4:7], s37 offen offset:3072 sc1
    v_exp_f32 v63, v63
    v_exp_f32 v64, v64
    v_exp_f32 v65, v65
    v_exp_f32 v66, v66
    v_exp_f32 v67, v67
    v_exp_f32 v68, v68
    v_exp_f32 v69, v69
    v_exp_f32 v70, v70
    v_smfmac_f32_32x32x32_bf16 v[128:143], v[180:183], v[56:63], v5
    s_add_u32 s37, s71, 12288
    v_exp_f32 v71, v71
    v_exp_f32 v72, v72
    v_exp_f32 v73, v73
    v_exp_f32 v74, v74
    v_smfmac_f32_32x32x32_bf16 v[128:143], v[184:187], v[64:71], v5
    s_add_u32 s27, s27, s28
    buffer_load_dwordx4 a[208:211], v1, s[4:7], s37 offen offset:0 sc1
    v_exp_f32 v75, v75
    v_exp_f32 v76, v76
    v_exp_f32 v77, v77
    v_exp_f32 v78, v78
    v_exp_f32 v79, v79
    v_mfma_f32_32x32x16_bf16 v[48:63], a[0:3], v[152:155], v[96:111]
    s_barrier
    v_exp_f32 v16, v16
    v_exp_f32 v17, v17
    v_exp_f32 v18, v18
    v_smfmac_f32_32x32x32_bf16 v[128:143], v[188:191], v[72:79], v5
    s_waitcnt lgkmcnt(0)
    v_exp_f32 v19, v19
    v_exp_f32 v20, v20
    v_exp_f32 v21, v21
    v_mfma_f32_32x32x16_bf16 v[64:79], a[4:7], v[152:155], v[96:111]
    buffer_load_dwordx4 a[212:215], v1, s[4:7], s37 offen offset:1024 sc1
    v_exp_f32 v22, v22
    v_exp_f32 v23, v23
    v_exp_f32 v24, v24
    v_exp_f32 v25, v25
    v_smfmac_f32_32x32x32_bf16 v[112:127], v[160:163], v[16:23], v5
    s_add_u32 s27, s27, 8650752
    v_exp_f32 v26, v26
    v_exp_f32 v27, v27
    v_exp_f32 v28, v28
    v_exp_f32 v29, v29
    v_exp_f32 v30, v30
    v_mfma_f32_32x32x4_2b_bf16 v[48:79], a[8:9], v[156:157], v[48:79]
    buffer_load_dwordx4 a[216:219], v1, s[4:7], s37 offen offset:2048 sc1
    v_exp_f32 v31, v31
    v_exp_f32 v32, v32
    v_exp_f32 v33, v33
    v_exp_f32 v34, v34
    v_exp_f32 v35, v35
    v_exp_f32 v36, v36
    v_exp_f32 v37, v37
    v_exp_f32 v38, v38
    v_smfmac_f32_32x32x32_bf16 v[112:127], v[164:167], v[24:31], v5
    s_add_u32 s29, s27, 4096
    v_exp_f32 v39, v39
    v_exp_f32 v40, v40
    v_exp_f32 v41, v41
    v_exp_f32 v42, v42
    v_smfmac_f32_32x32x32_bf16 v[112:127], v[168:171], v[32:39], v5
    s_lshl_b32 s30, s22, 10
    buffer_load_dwordx4 a[220:223], v1, s[4:7], s37 offen offset:3072 sc1
    v_exp_f32 v43, v43
    v_exp_f32 v44, v44
    v_exp_f32 v45, v45
    v_exp_f32 v46, v46
    v_exp_f32 v47, v47
    v_mfma_f32_32x32x16_bf16 v[16:31], a[12:15], v[144:147], v[80:95]
    s_add_u32 m0, s31, 40960
    v_add_u32 v2, 61440, v2
    v_add_u32 v3, 61440, v3
    ds_read_b128 a[0:3], v2 offset:0
    v_exp_f32 v48, v48
    v_exp_f32 v49, v49
    v_exp_f32 v50, v50
    v_smfmac_f32_32x32x32_bf16 v[112:127], v[172:175], v[40:47], v5
    s_mov_b64 exec, s[42:43]
    ds_read_b128 v[176:179], v4 offset:56320
    ds_read_b128 v[180:183], v4 offset:56960
    ds_read_b128 v[184:187], v4 offset:57600
    ds_read_b128 v[188:191], v4 offset:58240
    s_mov_b64 exec, -1
    v_exp_f32 v51, v51
    v_exp_f32 v52, v52
    v_exp_f32 v53, v53
    v_mfma_f32_32x32x16_bf16 v[32:47], a[16:19], v[144:147], v[80:95]
    buffer_load_dwordx4 v9, s[4:7], m0 offen offset:0 sc1 lds
    v_exp_f32 v54, v54
    v_exp_f32 v55, v55
    v_exp_f32 v56, v56
    v_exp_f32 v57, v57
    v_smfmac_f32_32x32x32_bf16 v[128:143], v[160:163], v[48:55], v5
    s_lshl_b32 s36, s21, 7
    ds_read_b128 a[4:7], v2 offset:1024
    ds_read_b64 a[8:9], v3 offset:0
    v_exp_f32 v58, v58
    v_exp_f32 v59, v59
    v_exp_f32 v60, v60
    v_exp_f32 v61, v61
    v_exp_f32 v62, v62
    v_mfma_f32_32x32x4_2b_bf16 v[16:47], a[20:21], v[148:149], v[16:47]
    buffer_load_dwordx4 v9, s[4:7], m0 offen offset:1024 sc1 lds
    v_exp_f32 v63, v63
    v_exp_f32 v64, v64
    v_exp_f32 v65, v65
    v_exp_f32 v66, v66
    v_exp_f32 v67, v67
    v_exp_f32 v68, v68
    v_exp_f32 v69, v69
    v_exp_f32 v70, v70
    v_smfmac_f32_32x32x32_bf16 v[128:143], v[164:167], v[56:63], v5
    s_add_u32 s30, s30, s36
    v_exp_f32 v71, v71
    v_exp_f32 v72, v72
    v_exp_f32 v73, v73
    v_exp_f32 v74, v74
    v_smfmac_f32_32x32x32_bf16 v[128:143], v[168:171], v[64:71], v5
    s_add_u32 s67, s30, 27262976
    buffer_load_dwordx4 v9, s[4:7], m0 offen offset:2048 sc1 lds
    v_exp_f32 v75, v75
    v_exp_f32 v76, v76
    v_exp_f32 v77, v77
    v_exp_f32 v78, v78
    v_exp_f32 v79, v79
    v_mfma_f32_32x32x16_bf16 v[48:63], a[12:15], v[152:155], v[96:111]
    s_add_u32 s30, s30, 11272192
    v_exp_f32 v16, v16
    v_exp_f32 v17, v17
    v_exp_f32 v18, v18
    v_smfmac_f32_32x32x32_bf16 v[128:143], v[172:175], v[72:79], v5
    s_waitcnt lgkmcnt(0)
    v_exp_f32 v19, v19
    v_exp_f32 v20, v20
    v_exp_f32 v21, v21
    v_mfma_f32_32x32x16_bf16 v[64:79], a[16:19], v[152:155], v[96:111]
    buffer_load_dwordx4 v9, s[4:7], m0 offen offset:3072 sc1 lds
    v_exp_f32 v22, v22
    v_exp_f32 v23, v23
    v_exp_f32 v24, v24
    v_exp_f32 v25, v25
    v_smfmac_f32_32x32x32_bf16 v[112:127], v[176:179], v[16:23], v5
    s_add_u32 m0, s31, 45056
    v_exp_f32 v26, v26
    v_exp_f32 v27, v27
    v_exp_f32 v28, v28
    v_exp_f32 v29, v29
    v_exp_f32 v30, v30
    v_mfma_f32_32x32x4_2b_bf16 v[48:79], a[20:21], v[156:157], v[48:79]
    buffer_load_dwordx4 v9, s[4:7], m0 offen offset:0 sc1 lds
    v_exp_f32 v31, v31
    v_exp_f32 v32, v32
    v_exp_f32 v33, v33
    v_exp_f32 v34, v34
    v_exp_f32 v35, v35
    v_exp_f32 v36, v36
    v_exp_f32 v37, v37
    v_exp_f32 v38, v38
    v_smfmac_f32_32x32x32_bf16 v[112:127], v[180:183], v[24:31], v5
    s_add_u32 s37, s71, 16384
    v_exp_f32 v39, v39
    v_exp_f32 v40, v40
    v_exp_f32 v41, v41
    v_exp_f32 v42, v42
    v_smfmac_f32_32x32x32_bf16 v[112:127], v[184:187], v[32:39], v5
    s_lshl_b32 s52, s50, 2
    buffer_load_dwordx4 a[224:227], v1, s[4:7], s37 offen offset:0 sc1
    v_exp_f32 v43, v43
    v_exp_f32 v44, v44
    v_exp_f32 v45, v45
    v_exp_f32 v46, v46
    v_exp_f32 v47, v47
    v_mfma_f32_32x32x16_bf16 v[16:31], a[0:3], v[144:147], v[80:95]
    ds_read_b128 a[12:15], v2 offset:5120
    v_exp_f32 v48, v48
    v_exp_f32 v49, v49
    v_exp_f32 v50, v50
    v_smfmac_f32_32x32x32_bf16 v[112:127], v[188:191], v[40:47], v5
    v_add_u32 v4, 61440, v4
    s_mov_b64 exec, s[42:43]
    ds_read_b128 v[160:163], v4 offset:0
    ds_read_b128 v[164:167], v4 offset:640
    ds_read_b128 v[168:171], v4 offset:1280
    ds_read_b128 v[172:175], v4 offset:1920
    s_mov_b64 exec, -1
    v_exp_f32 v51, v51
    v_exp_f32 v52, v52
    v_exp_f32 v53, v53
    v_mfma_f32_32x32x16_bf16 v[32:47], a[4:7], v[144:147], v[80:95]
    buffer_load_dwordx4 a[228:231], v1, s[4:7], s37 offen offset:1024 sc1
    v_exp_f32 v54, v54
    v_exp_f32 v55, v55
    v_exp_f32 v56, v56
    v_exp_f32 v57, v57
    v_smfmac_f32_32x32x32_bf16 v[128:143], v[176:179], v[48:55], v5
    s_add_u32 s52, s52, s3
    ds_read_b128 a[16:19], v2 offset:6144
    ds_read_b64 a[20:21], v3 offset:5120
    v_exp_f32 v58, v58
    v_exp_f32 v59, v59
    v_exp_f32 v60, v60
    v_exp_f32 v61, v61
    v_exp_f32 v62, v62
    v_mfma_f32_32x32x4_2b_bf16 v[16:47], a[8:9], v[148:149], v[16:47]
    buffer_load_dwordx4 a[232:235], v1, s[4:7], s37 offen offset:2048 sc1
    v_exp_f32 v63, v63
    v_exp_f32 v64, v64
    v_exp_f32 v65, v65
    v_exp_f32 v66, v66
    v_exp_f32 v67, v67
    v_exp_f32 v68, v68
    v_exp_f32 v69, v69
    v_exp_f32 v70, v70
    v_smfmac_f32_32x32x32_bf16 v[128:143], v[180:183], v[56:63], v5
    s_mul_i32 s54, s52, 40960
    v_exp_f32 v71, v71
    v_exp_f32 v72, v72
    v_exp_f32 v73, v73
    v_exp_f32 v74, v74
    v_smfmac_f32_32x32x32_bf16 v[128:143], v[184:187], v[64:71], v5
    s_add_u32 s54, s54, 8650752
    buffer_load_dwordx4 a[236:239], v1, s[4:7], s37 offen offset:3072 sc1
    v_exp_f32 v75, v75
    v_exp_f32 v76, v76
    v_exp_f32 v77, v77
    v_exp_f32 v78, v78
    v_exp_f32 v79, v79
    v_mfma_f32_32x32x16_bf16 v[48:63], a[0:3], v[152:155], v[96:111]
    s_add_u32 s37, s71, 20480
    v_exp_f32 v16, v16
    v_exp_f32 v17, v17
    v_exp_f32 v18, v18
    v_smfmac_f32_32x32x32_bf16 v[128:143], v[188:191], v[72:79], v5
    s_waitcnt lgkmcnt(0)
    v_exp_f32 v19, v19
    v_exp_f32 v20, v20
    v_exp_f32 v21, v21
    v_mfma_f32_32x32x16_bf16 v[64:79], a[4:7], v[152:155], v[96:111]
    buffer_load_dwordx4 a[240:243], v1, s[4:7], s37 offen offset:0 sc1
    v_exp_f32 v22, v22
    v_exp_f32 v23, v23
    v_exp_f32 v24, v24
    v_exp_f32 v25, v25
    v_smfmac_f32_32x32x32_bf16 v[112:127], v[160:163], v[16:23], v5
    s_lshl_b32 s55, s52, 11
    v_exp_f32 v26, v26
    v_exp_f32 v27, v27
    v_exp_f32 v28, v28
    v_exp_f32 v29, v29
    v_exp_f32 v30, v30
    v_mfma_f32_32x32x4_2b_bf16 v[48:79], a[8:9], v[156:157], v[48:79]
    buffer_load_dwordx4 a[244:247], v1, s[4:7], s37 offen offset:1024 sc1
    v_exp_f32 v31, v31
    v_exp_f32 v32, v32
    v_exp_f32 v33, v33
    v_exp_f32 v34, v34
    v_exp_f32 v35, v35
    v_exp_f32 v36, v36
    v_exp_f32 v37, v37
    v_exp_f32 v38, v38
    v_smfmac_f32_32x32x32_bf16 v[112:127], v[164:167], v[24:31], v5
    s_add_u32 s68, s55, 27262976
    v_exp_f32 v39, v39
    v_exp_f32 v40, v40
    v_exp_f32 v41, v41
    v_exp_f32 v42, v42
    v_smfmac_f32_32x32x32_bf16 v[112:127], v[168:171], v[32:39], v5
    s_add_u32 s55, s55, 11272192
    buffer_load_dwordx4 a[248:251], v1, s[4:7], s37 offen offset:2048 sc1
    v_exp_f32 v43, v43
    v_exp_f32 v44, v44
    v_exp_f32 v45, v45
    v_exp_f32 v46, v46
    v_exp_f32 v47, v47
    v_mfma_f32_32x32x16_bf16 v[16:31], a[12:15], v[144:147], v[80:95]
    ds_read_b128 a[0:3], v2 offset:10240
    v_exp_f32 v48, v48
    v_exp_f32 v49, v49
    v_exp_f32 v50, v50
    v_smfmac_f32_32x32x32_bf16 v[112:127], v[172:175], v[40:47], v5
    s_mov_b64 exec, s[42:43]
    ds_read_b128 v[176:179], v4 offset:5120
    ds_read_b128 v[180:183], v4 offset:5760
    ds_read_b128 v[184:187], v4 offset:6400
    ds_read_b128 v[188:191], v4 offset:7040
    s_mov_b64 exec, -1
    v_exp_f32 v51, v51
    v_exp_f32 v52, v52
    v_exp_f32 v53, v53
    v_mfma_f32_32x32x16_bf16 v[32:47], a[16:19], v[144:147], v[80:95]
    buffer_load_dwordx4 a[252:255], v1, s[4:7], s37 offen offset:3072 sc1
    v_exp_f32 v54, v54
    v_exp_f32 v55, v55
    v_exp_f32 v56, v56
    v_exp_f32 v57, v57
    v_smfmac_f32_32x32x32_bf16 v[128:143], v[160:163], v[48:55], v5
    s_add_u32 m0, s31, 61440
    ds_read_b128 a[4:7], v2 offset:11264
    ds_read_b64 a[8:9], v3 offset:10240
    v_exp_f32 v58, v58
    v_exp_f32 v59, v59
    v_exp_f32 v60, v60
    v_exp_f32 v61, v61
    v_exp_f32 v62, v62
    v_mfma_f32_32x32x4_2b_bf16 v[16:47], a[20:21], v[148:149], v[16:47]
    buffer_load_dwordx4 v9, s[4:7], m0 offen offset:0 sc1 lds
    v_exp_f32 v63, v63
    v_exp_f32 v64, v64
    v_exp_f32 v65, v65
    v_exp_f32 v66, v66
    v_exp_f32 v67, v67
    v_exp_f32 v68, v68
    v_exp_f32 v69, v69
    v_exp_f32 v70, v70
    v_smfmac_f32_32x32x32_bf16 v[128:143], v[164:167], v[56:63], v5
    s_mul_i32 s58, s52, 114688
    v_exp_f32 v71, v71
    v_exp_f32 v72, v72
    v_exp_f32 v73, v73
    v_exp_f32 v74, v74
    v_smfmac_f32_32x32x32_bf16 v[128:143], v[168:171], v[64:71], v5
    s_lshr_b32 s36, s51, 2
    buffer_load_dwordx4 v9, s[4:7], m0 offen offset:1024 sc1 lds
    v_exp_f32 v75, v75
    v_exp_f32 v76, v76
    v_exp_f32 v77, v77
    v_exp_f32 v78, v78
    v_exp_f32 v79, v79
    v_mfma_f32_32x32x16_bf16 v[48:63], a[12:15], v[152:155], v[96:111]
    s_mul_i32 s36, s36, 14336
    v_exp_f32 v16, v16
    v_exp_f32 v17, v17
    v_exp_f32 v18, v18
    v_smfmac_f32_32x32x32_bf16 v[128:143], v[172:175], v[72:79], v5
    s_waitcnt lgkmcnt(0)
    v_exp_f32 v19, v19
    v_exp_f32 v20, v20
    v_exp_f32 v21, v21
    v_mfma_f32_32x32x16_bf16 v[64:79], a[16:19], v[152:155], v[96:111]
    buffer_load_dwordx4 v9, s[4:7], m0 offen offset:2048 sc1 lds
    v_exp_f32 v22, v22
    v_exp_f32 v23, v23
    v_exp_f32 v24, v24
    v_exp_f32 v25, v25
    v_smfmac_f32_32x32x32_bf16 v[112:127], v[176:179], v[16:23], v5
    s_add_u32 s58, s58, s36
    v_exp_f32 v26, v26
    v_exp_f32 v27, v27
    v_exp_f32 v28, v28
    v_exp_f32 v29, v29
    v_exp_f32 v30, v30
    v_mfma_f32_32x32x4_2b_bf16 v[48:79], a[20:21], v[156:157], v[48:79]
    buffer_load_dwordx4 v9, s[4:7], m0 offen offset:3072 sc1 lds
    v_exp_f32 v31, v31
    v_exp_f32 v32, v32
    v_exp_f32 v33, v33
    v_exp_f32 v34, v34
    v_exp_f32 v35, v35
    v_exp_f32 v36, v36
    v_exp_f32 v37, v37
    v_exp_f32 v38, v38
    v_smfmac_f32_32x32x32_bf16 v[112:127], v[180:183], v[24:31], v5
    s_add_u32 m0, s31, 65536
    v_exp_f32 v39, v39
    v_exp_f32 v40, v40
    v_exp_f32 v41, v41
    v_exp_f32 v42, v42
    v_smfmac_f32_32x32x32_bf16 v[112:127], v[184:187], v[32:39], v5
    s_add_u32 s58, s58, 11403264
    buffer_load_dwordx4 v9, s[4:7], m0 offen offset:0 sc1 lds
    v_exp_f32 v43, v43
    v_exp_f32 v44, v44
    v_exp_f32 v45, v45
    v_exp_f32 v46, v46
    v_exp_f32 v47, v47
    v_mfma_f32_32x32x16_bf16 v[16:31], a[0:3], v[144:147], v[80:95]
    s_add_u32 s37, s71, 24576
    ds_read_b128 a[12:15], v2 offset:15360
    v_exp_f32 v48, v48
    v_exp_f32 v49, v49
    v_exp_f32 v50, v50
    v_smfmac_f32_32x32x32_bf16 v[112:127], v[188:191], v[40:47], v5
    s_mov_b64 exec, s[42:43]
    ds_read_b128 v[160:163], v4 offset:10240
    ds_read_b128 v[164:167], v4 offset:10880
    ds_read_b128 v[168:171], v4 offset:11520
    ds_read_b128 v[172:175], v4 offset:12160
    s_mov_b64 exec, -1
    v_exp_f32 v51, v51
    v_exp_f32 v52, v52
    v_exp_f32 v53, v53
    v_mfma_f32_32x32x16_bf16 v[32:47], a[4:7], v[144:147], v[80:95]
    buffer_load_dwordx4 v[192:195], v1, s[4:7], s37 offen offset:0 sc1
    v_exp_f32 v54, v54
    v_exp_f32 v55, v55
    v_exp_f32 v56, v56
    v_exp_f32 v57, v57
    v_smfmac_f32_32x32x32_bf16 v[128:143], v[176:179], v[48:55], v5
    s_and_b32 s35, s51, 3
    ds_read_b128 a[16:19], v2 offset:16384
    ds_read_b64 a[20:21], v3 offset:15360
    v_exp_f32 v58, v58
    v_exp_f32 v59, v59
    v_exp_f32 v60, v60
    v_exp_f32 v61, v61
    v_exp_f32 v62, v62
    v_mfma_f32_32x32x4_2b_bf16 v[16:47], a[8:9], v[148:149], v[16:47]
    buffer_load_dwordx4 v[196:199], v1, s[4:7], s37 offen offset:1024 sc1
    v_exp_f32 v63, v63
    v_exp_f32 v64, v64
    v_exp_f32 v65, v65
    v_exp_f32 v66, v66
    v_exp_f32 v67, v67
    v_exp_f32 v68, v68
    v_exp_f32 v69, v69
    v_exp_f32 v70, v70
    v_smfmac_f32_32x32x32_bf16 v[128:143], v[180:183], v[56:63], v5
    s_lshl_b32 s36, s35, 9
    v_exp_f32 v71, v71
    v_exp_f32 v72, v72
    v_exp_f32 v73, v73
    v_exp_f32 v74, v74
    v_smfmac_f32_32x32x32_bf16 v[128:143], v[184:187], v[64:71], v5
    s_add_u32 s62, s58, s36
    buffer_load_dwordx4 v[200:203], v1, s[4:7], s37 offen offset:2048 sc1
    v_exp_f32 v75, v75
    v_exp_f32 v76, v76
    v_exp_f32 v77, v77
    v_exp_f32 v78, v78
    v_exp_f32 v79, v79
    v_mfma_f32_32x32x16_bf16 v[48:63], a[0:3], v[152:155], v[96:111]
    s_add_u32 s62, s62, 12288
    v_exp_f32 v16, v16
    v_exp_f32 v17, v17
    v_exp_f32 v18, v18
    v_smfmac_f32_32x32x32_bf16 v[128:143], v[188:191], v[72:79], v5
    s_waitcnt lgkmcnt(0)
    v_exp_f32 v19, v19
    v_exp_f32 v20, v20
    v_exp_f32 v21, v21
    v_mfma_f32_32x32x16_bf16 v[64:79], a[4:7], v[152:155], v[96:111]
    buffer_load_dwordx4 v[204:207], v1, s[4:7], s37 offen offset:3072 sc1
    v_exp_f32 v22, v22
    v_exp_f32 v23, v23
    v_exp_f32 v24, v24
    v_exp_f32 v25, v25
    v_smfmac_f32_32x32x32_bf16 v[112:127], v[160:163], v[16:23], v5
    s_add_u32 s37, s71, 28672
    v_exp_f32 v26, v26
    v_exp_f32 v27, v27
    v_exp_f32 v28, v28
    v_exp_f32 v29, v29
    v_exp_f32 v30, v30
    v_mfma_f32_32x32x4_2b_bf16 v[48:79], a[8:9], v[156:157], v[48:79]
    buffer_load_dwordx4 v[208:211], v1, s[4:7], s37 offen offset:0 sc1
    v_exp_f32 v31, v31
    v_exp_f32 v32, v32
    v_exp_f32 v33, v33
    v_exp_f32 v34, v34
    v_exp_f32 v35, v35
    v_exp_f32 v36, v36
    v_exp_f32 v37, v37
    v_exp_f32 v38, v38
    v_smfmac_f32_32x32x32_bf16 v[112:127], v[164:167], v[24:31], v5
    s_lshl_b32 s36, s35, 10
    v_exp_f32 v39, v39
    v_exp_f32 v40, v40
    v_exp_f32 v41, v41
    v_exp_f32 v42, v42
    v_smfmac_f32_32x32x32_bf16 v[112:127], v[168:171], v[32:39], v5
    s_add_u32 s61, s58, s36
    buffer_load_dwordx4 v[212:215], v1, s[4:7], s37 offen offset:1024 sc1
    v_exp_f32 v43, v43
    v_exp_f32 v44, v44
    v_exp_f32 v45, v45
    v_exp_f32 v46, v46
    v_exp_f32 v47, v47
    v_mfma_f32_32x32x16_bf16 v[16:31], a[12:15], v[144:147], v[80:95]
    ds_read_b128 a[0:3], v2 offset:20480
    v_exp_f32 v48, v48
    v_exp_f32 v49, v49
    v_exp_f32 v50, v50
    v_smfmac_f32_32x32x32_bf16 v[112:127], v[172:175], v[40:47], v5
    s_mov_b64 exec, s[42:43]
    ds_read_b128 v[176:179], v4 offset:15360
    ds_read_b128 v[180:183], v4 offset:16000
    ds_read_b128 v[184:187], v4 offset:16640
    ds_read_b128 v[188:191], v4 offset:17280
    s_mov_b64 exec, -1
    v_exp_f32 v51, v51
    v_exp_f32 v52, v52
    v_exp_f32 v53, v53
    v_mfma_f32_32x32x16_bf16 v[32:47], a[16:19], v[144:147], v[80:95]
    buffer_load_dwordx4 v[216:219], v1, s[4:7], s37 offen offset:2048 sc1
    v_exp_f32 v54, v54
    v_exp_f32 v55, v55
    v_exp_f32 v56, v56
    v_exp_f32 v57, v57
    v_smfmac_f32_32x32x32_bf16 v[128:143], v[160:163], v[48:55], v5
    s_add_u32 s61, s61, 8192
    ds_read_b128 a[4:7], v2 offset:21504
    ds_read_b64 a[8:9], v3 offset:20480
    v_exp_f32 v58, v58
    v_exp_f32 v59, v59
    v_exp_f32 v60, v60
    v_exp_f32 v61, v61
    v_exp_f32 v62, v62
    v_mfma_f32_32x32x4_2b_bf16 v[16:47], a[20:21], v[148:149], v[16:47]
    buffer_load_dwordx4 v[220:223], v1, s[4:7], s37 offen offset:3072 sc1
    v_exp_f32 v63, v63
    v_exp_f32 v64, v64
    v_exp_f32 v65, v65
    v_exp_f32 v66, v66
    v_exp_f32 v67, v67
    v_exp_f32 v68, v68
    v_exp_f32 v69, v69
    v_exp_f32 v70, v70
    v_smfmac_f32_32x32x32_bf16 v[128:143], v[164:167], v[56:63], v5
    s_add_u32 m0, s31, 81920
    v_exp_f32 v71, v71
    v_exp_f32 v72, v72
    v_exp_f32 v73, v73
    v_exp_f32 v74, v74
    v_smfmac_f32_32x32x32_bf16 v[128:143], v[168:171], v[64:71], v5
    s_lshl_b32 s36, s35, 11
    buffer_load_dwordx4 v9, s[4:7], m0 offen offset:0 sc1 lds
    v_exp_f32 v75, v75
    v_exp_f32 v76, v76
    v_exp_f32 v77, v77
    v_exp_f32 v78, v78
    v_exp_f32 v79, v79
    v_mfma_f32_32x32x16_bf16 v[48:63], a[12:15], v[152:155], v[96:111]
    s_add_u32 s60, s58, s36
    v_exp_f32 v16, v16
    v_exp_f32 v17, v17
    v_exp_f32 v18, v18
    v_smfmac_f32_32x32x32_bf16 v[128:143], v[172:175], v[72:79], v5
    s_waitcnt lgkmcnt(0)
    v_exp_f32 v19, v19
    v_exp_f32 v20, v20
    v_exp_f32 v21, v21
    v_mfma_f32_32x32x16_bf16 v[64:79], a[16:19], v[152:155], v[96:111]
    buffer_load_dwordx4 v9, s[4:7], m0 offen offset:1024 sc1 lds
    v_exp_f32 v22, v22
    v_exp_f32 v23, v23
    v_exp_f32 v24, v24
    v_exp_f32 v25, v25
    v_smfmac_f32_32x32x32_bf16 v[112:127], v[176:179], v[16:23], v5
    s_lshr_b32 s69, s52, 1
    v_exp_f32 v26, v26
    v_exp_f32 v27, v27
    v_exp_f32 v28, v28
    v_exp_f32 v29, v29
    v_exp_f32 v30, v30
    v_mfma_f32_32x32x4_2b_bf16 v[48:79], a[20:21], v[156:157], v[48:79]
    buffer_load_dwordx4 v9, s[4:7], m0 offen offset:2048 sc1 lds
    v_exp_f32 v31, v31
    v_exp_f32 v32, v32
    v_exp_f32 v33, v33
    v_exp_f32 v34, v34
    v_exp_f32 v35, v35
    v_exp_f32 v36, v36
    v_exp_f32 v37, v37
    v_exp_f32 v38, v38
    v_smfmac_f32_32x32x32_bf16 v[112:127], v[180:183], v[24:31], v5
    s_lshl_b32 s69, s69, 12
    v_exp_f32 v39, v39
    v_exp_f32 v40, v40
    v_exp_f32 v41, v41
    v_exp_f32 v42, v42
    v_smfmac_f32_32x32x32_bf16 v[112:127], v[184:187], v[32:39], v5
    s_and_b32 s36, s52, 1
    buffer_load_dwordx4 v9, s[4:7], m0 offen offset:3072 sc1 lds
    v_exp_f32 v43, v43
    v_exp_f32 v44, v44
    v_exp_f32 v45, v45
    v_exp_f32 v46, v46
    v_exp_f32 v47, v47
    v_mfma_f32_32x32x16_bf16 v[16:31], a[0:3], v[144:147], v[80:95]
    s_add_u32 m0, s31, 86016
    ds_read_b128 a[12:15], v2 offset:25600
    v_exp_f32 v48, v48
    v_exp_f32 v49, v49
    v_exp_f32 v50, v50
    v_smfmac_f32_32x32x32_bf16 v[112:127], v[188:191], v[40:47], v5
    s_mov_b64 exec, s[42:43]
    ds_read_b128 v[160:163], v4 offset:20480
    ds_read_b128 v[164:167], v4 offset:21120
    ds_read_b128 v[168:171], v4 offset:21760
    ds_read_b128 v[172:175], v4 offset:22400
    s_mov_b64 exec, -1
    v_exp_f32 v51, v51
    v_exp_f32 v52, v52
    v_exp_f32 v53, v53
    v_mfma_f32_32x32x16_bf16 v[32:47], a[4:7], v[144:147], v[80:95]
    buffer_load_dwordx4 v9, s[4:7], m0 offen offset:0 sc1 lds
    v_exp_f32 v54, v54
    v_exp_f32 v55, v55
    v_exp_f32 v56, v56
    v_exp_f32 v57, v57
    v_smfmac_f32_32x32x32_bf16 v[128:143], v[176:179], v[48:55], v5
    s_add_u32 s37, s71, 32768
    ds_read_b128 a[16:19], v2 offset:26624
    ds_read_b64 a[20:21], v3 offset:25600
    v_exp_f32 v58, v58
    v_exp_f32 v59, v59
    v_exp_f32 v60, v60
    v_exp_f32 v61, v61
    v_exp_f32 v62, v62
    v_mfma_f32_32x32x4_2b_bf16 v[16:47], a[8:9], v[148:149], v[16:47]
    buffer_load_dwordx4 v[224:227], v1, s[4:7], s37 offen offset:0 sc1
    v_exp_f32 v63, v63
    v_exp_f32 v64, v64
    v_exp_f32 v65, v65
    v_exp_f32 v66, v66
    v_exp_f32 v67, v67
    v_exp_f32 v68, v68
    v_exp_f32 v69, v69
    v_exp_f32 v70, v70
    v_smfmac_f32_32x32x32_bf16 v[128:143], v[180:183], v[56:63], v5
    s_lshl_b32 s36, s36, 7
    v_exp_f32 v71, v71
    v_exp_f32 v72, v72
    v_exp_f32 v73, v73
    v_exp_f32 v74, v74
    v_smfmac_f32_32x32x32_bf16 v[128:143], v[184:187], v[64:71], v5
k2_main_kernel_pad_P6:
    s_cbranch_execz k2_main_kernel_tr_gp0
    s_add_u32 s69, s69, s36
    buffer_load_dwordx4 v[228:231], v1, s[4:7], s37 offen offset:1024 sc1
    v_exp_f32 v75, v75
    v_exp_f32 v76, v76
    v_exp_f32 v77, v77
    v_exp_f32 v78, v78
    v_exp_f32 v79, v79
    v_mfma_f32_32x32x16_bf16 v[48:63], a[0:3], v[152:155], v[96:111]
    s_waitcnt vmcnt(2)
    s_barrier
    v_cmp_ne_u32 vcc, v8, v15
    v_exp_f32 v16, v16
    v_exp_f32 v17, v17
    v_exp_f32 v18, v18
    v_smfmac_f32_32x32x32_bf16 v[128:143], v[188:191], v[72:79], v5
    s_waitcnt lgkmcnt(0)
    v_exp_f32 v19, v19
    v_exp_f32 v20, v20
    v_exp_f32 v21, v21
    v_mfma_f32_32x32x16_bf16 v[64:79], a[4:7], v[152:155], v[96:111]
    buffer_load_dwordx4 v[232:235], v1, s[4:7], s37 offen offset:2048 sc1
    v_exp_f32 v22, v22
    v_exp_f32 v23, v23
    v_exp_f32 v24, v24
    v_exp_f32 v25, v25
    v_smfmac_f32_32x32x32_bf16 v[112:127], v[160:163], v[16:23], v5
    s_lshl_b32 s36, s51, 8
    v_exp_f32 v26, v26
    v_exp_f32 v27, v27
    v_exp_f32 v28, v28
    v_exp_f32 v29, v29
    v_exp_f32 v30, v30
    v_mfma_f32_32x32x4_2b_bf16 v[48:79], a[8:9], v[156:157], v[48:79]
    buffer_load_dwordx4 v[236:239], v1, s[4:7], s37 offen offset:3072 sc1
    v_exp_f32 v31, v31
    v_exp_f32 v32, v32
    v_exp_f32 v33, v33
    v_exp_f32 v34, v34
    v_exp_f32 v35, v35
    v_exp_f32 v36, v36
    v_exp_f32 v37, v37
    v_exp_f32 v38, v38
    v_smfmac_f32_32x32x32_bf16 v[112:127], v[164:167], v[24:31], v5
    s_add_u32 s37, s71, 36864
    v_exp_f32 v39, v39
    v_exp_f32 v40, v40
    v_exp_f32 v41, v41
    v_exp_f32 v42, v42
    v_smfmac_f32_32x32x32_bf16 v[112:127], v[168:171], v[32:39], v5
    s_add_u32 s69, s69, s36
    buffer_load_dwordx4 v[240:243], v1, s[4:7], s37 offen offset:0 sc1
    v_exp_f32 v43, v43
    v_exp_f32 v44, v44
    v_exp_f32 v45, v45
    v_exp_f32 v46, v46
    v_exp_f32 v47, v47
    v_mfma_f32_32x32x16_bf16 v[16:31], a[12:15], v[144:147], v[80:95]
    s_or_b32 s101, vcc_lo, vcc_hi
    ds_read_b128 a[0:3], v2 offset:30720
    v_exp_f32 v48, v48
    v_exp_f32 v49, v49
    v_exp_f32 v50, v50
    v_smfmac_f32_32x32x32_bf16 v[112:127], v[172:175], v[40:47], v5
    s_mov_b64 exec, s[42:43]
    ds_read_b128 v[176:179], v4 offset:25600
    ds_read_b128 v[180:183], v4 offset:26240
    ds_read_b128 v[184:187], v4 offset:26880
    ds_read_b128 v[188:191], v4 offset:27520
    s_mov_b64 exec, -1
    v_exp_f32 v51, v51
    v_exp_f32 v52, v52
    v_exp_f32 v53, v53
    v_mfma_f32_32x32x16_bf16 v[32:47], a[16:19], v[144:147], v[80:95]
    buffer_load_dwordx4 v[244:247], v1, s[4:7], s37 offen offset:1024 sc1
    v_exp_f32 v54, v54
    v_exp_f32 v55, v55
    v_exp_f32 v56, v56
    v_exp_f32 v57, v57
    v_smfmac_f32_32x32x32_bf16 v[128:143], v[160:163], v[48:55], v5
    s_add_u32 s69, s69, 27394048
    ds_read_b128 a[4:7], v2 offset:31744
    ds_read_b64 a[8:9], v3 offset:30720
    v_exp_f32 v58, v58
    v_exp_f32 v59, v59
    v_exp_f32 v60, v60
    v_exp_f32 v61, v61
    v_exp_f32 v62, v62
    v_mfma_f32_32x32x4_2b_bf16 v[16:47], a[20:21], v[148:149], v[16:47]
    buffer_load_dwordx4 v[248:251], v1, s[4:7], s37 offen offset:2048 sc1
    v_exp_f32 v63, v63
    v_exp_f32 v64, v64
    v_exp_f32 v65, v65
    v_exp_f32 v66, v66
    v_exp_f32 v67, v67
    v_exp_f32 v68, v68
    v_exp_f32 v69, v69
    v_exp_f32 v70, v70
    v_smfmac_f32_32x32x32_bf16 v[128:143], v[164:167], v[56:63], v5
    s_lshl_b32 s70, s20, 12
    v_exp_f32 v71, v71
    v_exp_f32 v72, v72
    v_exp_f32 v73, v73
    v_exp_f32 v74, v74
    v_smfmac_f32_32x32x32_bf16 v[128:143], v[168:171], v[64:71], v5
    s_add_u32 s70, s70, 27394048
    buffer_load_dwordx4 v[252:255], v1, s[4:7], s37 offen offset:3072 sc1
    v_exp_f32 v75, v75
    v_exp_f32 v76, v76
    v_exp_f32 v77, v77
    v_exp_f32 v78, v78
    v_exp_f32 v79, v79
    v_mfma_f32_32x32x16_bf16 v[48:63], a[12:15], v[152:155], v[96:111]
    s_add_u32 m0, s59, 114688
    s_add_u32 s33, s53, 0
    v_exp_f32 v16, v16
    v_exp_f32 v17, v17
    v_exp_f32 v18, v18
    v_smfmac_f32_32x32x32_bf16 v[128:143], v[172:175], v[72:79], v5
    s_waitcnt lgkmcnt(0)
    v_exp_f32 v19, v19
    v_exp_f32 v20, v20
    v_exp_f32 v21, v21
    v_mfma_f32_32x32x16_bf16 v[64:79], a[16:19], v[152:155], v[96:111]
    buffer_load_dwordx4 v1, s[4:7], s33 offen offset:0 sc1 lds
    v_exp_f32 v22, v22
    v_exp_f32 v23, v23
    v_exp_f32 v24, v24
    v_exp_f32 v25, v25
    v_smfmac_f32_32x32x32_bf16 v[112:127], v[176:179], v[16:23], v5
    s_lshr_b32 s36, s3, 1
    v_exp_f32 v26, v26
    v_exp_f32 v27, v27
    v_exp_f32 v28, v28
    v_exp_f32 v29, v29
    v_exp_f32 v30, v30
    v_mfma_f32_32x32x4_2b_bf16 v[48:79], a[20:21], v[156:157], v[48:79]
    buffer_load_dwordx4 v1, s[4:7], s33 offen offset:1024 sc1 lds
    v_exp_f32 v31, v31
    v_exp_f32 v32, v32
    v_exp_f32 v33, v33
    v_exp_f32 v34, v34
    v_exp_f32 v35, v35
    v_exp_f32 v36, v36
    v_exp_f32 v37, v37
    v_exp_f32 v38, v38
    v_smfmac_f32_32x32x32_bf16 v[112:127], v[180:183], v[24:31], v5
    s_lshl_b32 s36, s36, 7
    v_exp_f32 v39, v39
    v_exp_f32 v40, v40
    v_exp_f32 v41, v41
    v_exp_f32 v42, v42
    v_smfmac_f32_32x32x32_bf16 v[112:127], v[184:187], v[32:39], v5
    s_add_u32 s72, s70, s36
    buffer_load_dwordx4 v1, s[4:7], s33 offen offset:2048 sc1 lds
    v_exp_f32 v43, v43
    v_exp_f32 v44, v44
    v_exp_f32 v45, v45
    v_exp_f32 v46, v46
    v_exp_f32 v47, v47
    v_mfma_f32_32x32x16_bf16 v[16:31], a[0:3], v[144:147], v[80:95]
    ds_read_b128 a[12:15], v2 offset:35840
    v_exp_f32 v48, v48
    v_exp_f32 v49, v49
    v_exp_f32 v50, v50
    v_smfmac_f32_32x32x32_bf16 v[112:127], v[188:191], v[40:47], v5
    s_mov_b64 exec, s[42:43]
    ds_read_b128 v[160:163], v4 offset:30720
    ds_read_b128 v[164:167], v4 offset:31360
    ds_read_b128 v[168:171], v4 offset:32000
    ds_read_b128 v[172:175], v4 offset:32640
    s_mov_b64 exec, -1
    v_exp_f32 v51, v51
    v_exp_f32 v52, v52
    v_exp_f32 v53, v53
    v_mfma_f32_32x32x16_bf16 v[32:47], a[4:7], v[144:147], v[80:95]
    buffer_load_dwordx4 v1, s[4:7], s33 offen offset:3072 sc1 lds
    v_exp_f32 v54, v54
    v_exp_f32 v55, v55
    v_exp_f32 v56, v56
    v_exp_f32 v57, v57
    v_smfmac_f32_32x32x32_bf16 v[128:143], v[176:179], v[48:55], v5
    s_add_u32 m0, s59, 118784
    s_add_u32 s33, s53, 4096
    ds_read_b128 a[16:19], v2 offset:36864
    ds_read_b64 a[20:21], v3 offset:35840
    v_exp_f32 v58, v58
    v_exp_f32 v59, v59
    v_exp_f32 v60, v60
    v_exp_f32 v61, v61
    v_exp_f32 v62, v62
    v_mfma_f32_32x32x4_2b_bf16 v[16:47], a[8:9], v[148:149], v[16:47]
    buffer_load_dwordx4 v1, s[4:7], s33 offen offset:0 sc1 lds
    v_exp_f32 v63, v63
    v_exp_f32 v64, v64
    v_exp_f32 v65, v65
    v_exp_f32 v66, v66
    v_exp_f32 v67, v67
    v_exp_f32 v68, v68
    v_exp_f32 v69, v69
    v_exp_f32 v70, v70
    v_smfmac_f32_32x32x32_bf16 v[128:143], v[180:183], v[56:63], v5
    s_lshl_b32 s36, s3, 10
    v_exp_f32 v71, v71
    v_exp_f32 v72, v72
    v_exp_f32 v73, v73
    v_exp_f32 v74, v74
    v_smfmac_f32_32x32x32_bf16 v[128:143], v[184:187], v[64:71], v5
    s_add_u32 s70, s70, s36
    buffer_load_dwordx4 v1, s[4:7], s33 offen offset:1024 sc1 lds
    v_exp_f32 v75, v75
    v_exp_f32 v76, v76
    v_exp_f32 v77, v77
    v_exp_f32 v78, v78
    v_exp_f32 v79, v79
    v_mfma_f32_32x32x16_bf16 v[48:63], a[0:3], v[152:155], v[96:111]
    s_mul_i32 s35, s20, 229376
    v_exp_f32 v16, v16
    v_exp_f32 v17, v17
    v_exp_f32 v18, v18
    v_smfmac_f32_32x32x32_bf16 v[128:143], v[188:191], v[72:79], v5
    s_waitcnt lgkmcnt(0)
    v_exp_f32 v19, v19
    v_exp_f32 v20, v20
    v_exp_f32 v21, v21
    v_mfma_f32_32x32x16_bf16 v[64:79], a[4:7], v[152:155], v[96:111]
    buffer_load_dwordx4 v1, s[4:7], s33 offen offset:2048 sc1 lds
    v_exp_f32 v22, v22
    v_exp_f32 v23, v23
    v_exp_f32 v24, v24
    v_exp_f32 v25, v25
    v_smfmac_f32_32x32x32_bf16 v[112:127], v[160:163], v[16:23], v5
    s_mul_i32 s36, s3, 14336
    v_exp_f32 v26, v26
    v_exp_f32 v27, v27
    v_exp_f32 v28, v28
    v_exp_f32 v29, v29
    v_exp_f32 v30, v30
    v_mfma_f32_32x32x4_2b_bf16 v[48:79], a[8:9], v[156:157], v[48:79]
    s_add_u32 s35, s35, s36
    v_exp_f32 v31, v31
    v_exp_f32 v32, v32
    v_exp_f32 v33, v33
    v_exp_f32 v34, v34
    v_exp_f32 v35, v35
    v_exp_f32 v36, v36
    v_exp_f32 v37, v37
    v_exp_f32 v38, v38
    v_smfmac_f32_32x32x32_bf16 v[112:127], v[164:167], v[24:31], v5
    s_add_u32 s35, s35, 11403264
    v_exp_f32 v39, v39
    v_exp_f32 v40, v40
    v_exp_f32 v41, v41
    v_exp_f32 v42, v42
    v_smfmac_f32_32x32x32_bf16 v[112:127], v[168:171], v[32:39], v5
    s_mul_i32 s63, s22, 57344
    v_exp_f32 v43, v43
    v_exp_f32 v44, v44
    v_exp_f32 v45, v45
    v_exp_f32 v46, v46
    v_exp_f32 v47, v47
    v_mfma_f32_32x32x16_bf16 v[16:31], a[12:15], v[144:147], v[80:95]
    s_add_u32 s63, s63, 11415552
    v_exp_f32 v48, v48
    v_exp_f32 v49, v49
    v_exp_f32 v50, v50
    v_smfmac_f32_32x32x32_bf16 v[112:127], v[172:175], v[40:47], v5
    s_mov_b64 exec, s[42:43]
    ds_read_b128 v[176:179], v4 offset:35840
    ds_read_b128 v[180:183], v4 offset:36480
    ds_read_b128 v[184:187], v4 offset:37120
    ds_read_b128 v[188:191], v4 offset:37760
    s_mov_b64 exec, -1
    v_exp_f32 v51, v51
    v_exp_f32 v52, v52
    v_exp_f32 v53, v53
    v_mfma_f32_32x32x16_bf16 v[32:47], a[16:19], v[144:147], v[80:95]
    s_mul_i32 s64, s3, 10240
    v_exp_f32 v54, v54
    v_exp_f32 v55, v55
    v_exp_f32 v56, v56
    v_exp_f32 v57, v57
    v_smfmac_f32_32x32x32_bf16 v[128:143], v[160:163], v[48:55], v5
    s_add_u32 s36, s3, 1
    v_exp_f32 v58, v58
    v_exp_f32 v59, v59
    v_exp_f32 v60, v60
    v_exp_f32 v61, v61
    v_exp_f32 v62, v62
    v_mfma_f32_32x32x4_2b_bf16 v[16:47], a[20:21], v[148:149], v[16:47]
    s_and_b32 s36, s36, 3
    v_exp_f32 v63, v63
    v_exp_f32 v64, v64
    v_exp_f32 v65, v65
    v_exp_f32 v66, v66
    v_exp_f32 v67, v67
    v_exp_f32 v68, v68
    v_exp_f32 v69, v69
    v_exp_f32 v70, v70
    v_smfmac_f32_32x32x32_bf16 v[128:143], v[164:167], v[56:63], v5
    s_mul_i32 s73, s36, 57344
    v_exp_f32 v71, v71
    v_exp_f32 v72, v72
    v_exp_f32 v73, v73
    v_exp_f32 v74, v74
    v_smfmac_f32_32x32x32_bf16 v[128:143], v[168:171], v[64:71], v5
    s_add_u32 s73, s73, s35
    v_exp_f32 v75, v75
    v_exp_f32 v76, v76
    v_exp_f32 v77, v77
    v_exp_f32 v78, v78
    v_exp_f32 v79, v79
    v_mfma_f32_32x32x16_bf16 v[48:63], a[12:15], v[152:155], v[96:111]
    s_mul_i32 s77, s36, 5120
    v_exp_f32 v16, v16
    v_exp_f32 v17, v17
    v_exp_f32 v18, v18
    v_smfmac_f32_32x32x32_bf16 v[128:143], v[172:175], v[72:79], v5
    s_waitcnt lgkmcnt(0)
    v_exp_f32 v19, v19
    v_exp_f32 v20, v20
    v_exp_f32 v21, v21
    v_mfma_f32_32x32x16_bf16 v[64:79], a[16:19], v[152:155], v[96:111]
    s_add_u32 s36, s3, 2
    v_exp_f32 v22, v22
    v_exp_f32 v23, v23
    v_exp_f32 v24, v24
    v_exp_f32 v25, v25
    v_smfmac_f32_32x32x32_bf16 v[112:127], v[176:179], v[16:23], v5
    s_and_b32 s36, s36, 3
    v_exp_f32 v26, v26
    v_exp_f32 v27, v27
    v_exp_f32 v28, v28
    v_exp_f32 v29, v29
    v_exp_f32 v30, v30
    v_mfma_f32_32x32x4_2b_bf16 v[48:79], a[20:21], v[156:157], v[48:79]
    s_mul_i32 s74, s36, 57344
    v_exp_f32 v31, v31
    v_exp_f32 v32, v32
    v_exp_f32 v33, v33
    v_exp_f32 v34, v34
    v_exp_f32 v35, v35
    v_exp_f32 v36, v36
    v_exp_f32 v37, v37
    v_exp_f32 v38, v38
    v_smfmac_f32_32x32x32_bf16 v[112:127], v[180:183], v[24:31], v5
    s_add_u32 s74, s74, s35
    v_exp_f32 v39, v39
    v_exp_f32 v40, v40
    v_exp_f32 v41, v41
    v_exp_f32 v42, v42
    v_smfmac_f32_32x32x32_bf16 v[112:127], v[184:187], v[32:39], v5
    s_mul_i32 s78, s36, 5120
    v_exp_f32 v43, v43
    v_exp_f32 v44, v44
    v_exp_f32 v45, v45
    v_exp_f32 v46, v46
    v_exp_f32 v47, v47
    s_nop 0
    s_add_u32 s36, s3, 3
    v_exp_f32 v48, v48
    v_exp_f32 v49, v49
    v_exp_f32 v50, v50
    v_smfmac_f32_32x32x32_bf16 v[112:127], v[188:191], v[40:47], v5
    s_and_b32 s36, s36, 3
    v_exp_f32 v51, v51
    v_exp_f32 v52, v52
    v_exp_f32 v53, v53
    v_exp_f32 v54, v54
    v_exp_f32 v55, v55
    v_exp_f32 v56, v56
    v_exp_f32 v57, v57
    v_smfmac_f32_32x32x32_bf16 v[128:143], v[176:179], v[48:55], v5
    s_mul_i32 s75, s36, 57344
    v_exp_f32 v58, v58
    v_exp_f32 v59, v59
    v_exp_f32 v60, v60
    v_exp_f32 v61, v61
    v_exp_f32 v62, v62
    v_exp_f32 v63, v63
    v_exp_f32 v64, v64
    v_exp_f32 v65, v65
    v_exp_f32 v66, v66
    v_exp_f32 v67, v67
    v_exp_f32 v68, v68
    v_exp_f32 v69, v69
    v_exp_f32 v70, v70
    v_smfmac_f32_32x32x32_bf16 v[128:143], v[180:183], v[56:63], v5
    s_add_u32 s75, s75, s35
    v_exp_f32 v71, v71
    v_exp_f32 v72, v72
    v_exp_f32 v73, v73
    v_exp_f32 v74, v74
    v_smfmac_f32_32x32x32_bf16 v[128:143], v[184:187], v[64:71], v5
    s_mul_i32 s79, s36, 5120
    v_exp_f32 v75, v75
    v_exp_f32 v76, v76
    v_exp_f32 v77, v77
    v_exp_f32 v78, v78
    v_exp_f32 v79, v79
    s_nop 1
    v_smfmac_f32_32x32x32_bf16 v[128:143], v[188:191], v[72:79], v5
k2_main_kernel_fin:
    v_and_b32 v12, 15, v0
    v_lshlrev_b32 v12, 4, v12
    v_bfe_u32 v13, v0, 4, 1
    v_lshl_add_u32 v12, v13, 3, v12
    v_mov_b32 v11, 0x5f800000
    v_rcp_f32 v10, v124
    v_cmp_nle_f32 s[82:83], v124, v11
    v_mul_f32 v112, v112, v10
    v_mul_f32 v113, v113, v10
    v_mul_f32 v114, v114, v10
    v_mul_f32 v115, v115, v10
    v_mul_f32 v116, v116, v10
    v_mul_f32 v117, v117, v10
    v_mul_f32 v118, v118, v10
    v_mul_f32 v119, v119, v10
    v_mul_f32 v120, v120, v10
    v_mul_f32 v121, v121, v10
    v_mul_f32 v122, v122, v10
    v_mul_f32 v123, v123, v10
    v_cvt_pk_bf16_f32 v16, v112, v113
    v_cvt_pk_bf16_f32 v17, v114, v115
    v_cvt_pk_bf16_f32 v18, v116, v117
    v_cvt_pk_bf16_f32 v19, v118, v119
    v_cvt_pk_bf16_f32 v20, v120, v121
    v_cvt_pk_bf16_f32 v21, v122, v123
    s_cmp_lg_u32 s101, 0
    s_cbranch_scc1 k2_main_kernel_vs1
    buffer_store_dwordx4 v[16:19], v1, s[4:7], s48 offen
    s_mov_b32 exec_hi, 0
    buffer_store_dwordx2 v[20:21], v12, s[4:7], s49 offen
k2_main_kernel_vs1x:
    s_mov_b32 exec_hi, -1
    v_rcp_f32 v10, v140
    v_cmp_nle_f32 vcc, v140, v11
    v_mul_f32 v128, v128, v10
    v_mul_f32 v129, v129, v10
    v_mul_f32 v130, v130, v10
    v_mul_f32 v131, v131, v10
    v_mul_f32 v132, v132, v10
    v_mul_f32 v133, v133, v10
    v_mul_f32 v134, v134, v10
    v_mul_f32 v135, v135, v10
    v_mul_f32 v136, v136, v10
    v_mul_f32 v137, v137, v10
    v_mul_f32 v138, v138, v10
    v_mul_f32 v139, v139, v10
    v_cvt_pk_bf16_f32 v24, v128, v129
    v_cvt_pk_bf16_f32 v25, v130, v131
    v_cvt_pk_bf16_f32 v26, v132, v133
    v_cvt_pk_bf16_f32 v27, v134, v135
    v_cvt_pk_bf16_f32 v28, v136, v137
    v_cvt_pk_bf16_f32 v29, v138, v139
    s_cmp_lg_u32 s101, 0
    s_cbranch_scc1 k2_main_kernel_vs2
    buffer_store_dwordx4 v[24:27], v1, s[4:7], s16 offen
    s_mov_b32 exec_hi, 0
    buffer_store_dwordx2 v[28:29], v12, s[4:7], s17 offen
k2_main_kernel_vs2x:
    s_mov_b32 exec_hi, -1
    s_or_b64 vcc, vcc, s[82:83]
    s_cmp_lg_u32 s41, 0
    s_cbranch_scc1 k2_main_kernel_fin2
    s_cbranch_vccnz k2_main_kernel_slow
k2_main_kernel_fin2:
    v_add_u32 v2, 0x10000, v1
    v_add_u32 v3, 0x20000, v1
    s_add_u32 s36, s3, 4
    s_and_b32 s36, s36, 3
    s_mul_i32 s76, s36, 57344
    s_add_u32 s76, s76, s35
    s_mul_i32 s80, s36, 5120
    v_add_u32 v176, s11, v1
    v_add_u32 v177, s12, v1
    ds_read_b128 v[152:155], v176 offset:0
    v_and_b32 v187, 3, v0
    v_lshlrev_b32 v187, 7, v187
    v_bfe_u32 v13, v0, 2, 1
    v_lshl_add_u32 v187, v13, 10, v187
    ds_read_b128 v[156:159], v176 offset:1024
    v_and_b32 v13, 15, v0
    v_lshrrev_b32 v14, 4, v0
    v_lshlrev_b32 v188, 4, v13
    v_lshl_add_u32 v188, v14, 9, v188
    ds_read_b128 v[160:163], v176 offset:2048
    v_lshlrev_b32 v189, 4, v13
    v_lshrrev_b32 v15, 5, v0
    v_lshl_add_u32 v189, v15, 9, v189
    v_lshlrev_b32 v186, 3, v13
    ds_read_b128 v[164:167], v176 offset:3072
    v_lshl_add_u32 v186, v14, 9, v186
    v_mul_u32_u24 v4, 56832, v15
    v_add_u32 v4, v4, v1
    v_bfe_u32 v15, v0, 4, 1
    ds_read_b128 a[96:99], v176 offset:4096
    v_lshl_add_u32 v189, v15, 3, v189
    v_add_u32 v191, 0x10000, v188
    v_mul_u32_u24 v11, 160, v13
    v_lshl_add_u32 v11, v14, 3, v11
    ds_read_b128 a[100:103], v176 offset:5120
    v_add_u32 v11, s32, v11
    v_lshlrev_b32 v12, 7, v13
    v_add_u32 v15, 0, v0
    v_mul_u32_u24 v14, 205, v15
    ds_read_b128 a[104:107], v176 offset:6144
    v_lshrrev_b32 v14, 11, v14
    v_mul_u32_u24 v14, 1120, v14
    v_lshl_add_u32 v8, v15, 4, v14
    v_add_u32 v15, 64, v0
    ds_read_b128 a[108:111], v176 offset:7168
    v_mul_u32_u24 v14, 205, v15
    v_lshrrev_b32 v14, 11, v14
    v_mul_u32_u24 v14, 1120, v14
    v_lshl_add_u32 v9, v15, 4, v14
    s_waitcnt vmcnt(0)
    s_cmp_lg_u32 s101, 0
    s_cbranch_scc1 k2_main_kernel_vs3
    buffer_store_dword v7, off, s[4:7], s65
k2_main_kernel_vs3x:
    ds_read_b128 a[112:115], v176 offset:8192
    v_add_u32 v15, 128, v0
    v_mul_u32_u24 v14, 205, v15
    v_lshrrev_b32 v14, 11, v14
    v_mul_u32_u24 v14, 1120, v14
    ds_read_b128 a[116:119], v176 offset:9216
    v_lshl_add_u32 v10, v15, 4, v14
    v_accvgpr_read_b32 v17, a22
    v_accvgpr_read_b32 v19, a23
    v_accvgpr_read_b32 v21, a24
    ds_read_b128 a[120:123], v176 offset:10240
    v_accvgpr_read_b32 v23, a25
    v_accvgpr_read_b32 v25, a26
    v_accvgpr_read_b32 v27, a27
    v_accvgpr_read_b32 v29, a28
    ds_read_b128 a[124:127], v176 offset:11264
    v_accvgpr_read_b32 v31, a29
    v_accvgpr_read_b32 v33, a30
    v_accvgpr_read_b32 v35, a31
    v_lshlrev_b32 v16, 16, v17
    buffer_load_dword v13, v187, s[4:7], s66 offen sc1
    ds_read_b128 a[128:131], v176 offset:12288
    v_and_b32 v17, 0xffff0000, v17
    v_lshlrev_b32 v18, 16, v19
    v_and_b32 v19, 0xffff0000, v19
    v_lshlrev_b32 v20, 16, v21
    s_mov_b64 exec, 0
    s_cmp_eq_u32 s3, 0
    s_cbranch_scc1 k2_main_kernel_pad_P7
    s_cmp_eq_u32 s3, 1
    s_cbranch_scc1 k2_main_kernel_pad_P8
    s_cmp_eq_u32 s3, 2
    s_cbranch_scc1 k2_main_kernel_pad_Tpo
    s_branch k2_main_kernel_pad_P9
k2_main_kernel_tr_r13:
    s_mov_b64 exec, -1
    ds_read_b128 a[132:135], v176 offset:13312
    v_and_b32 v21, 0xffff0000, v21
    v_lshlrev_b32 v22, 16, v23
    v_and_b32 v23, 0xffff0000, v23
    v_lshlrev_b32 v24, 16, v25
    ds_read_b128 a[136:139], v176 offset:14336
    v_and_b32 v25, 0xffff0000, v25
    v_lshlrev_b32 v26, 16, v27
    v_and_b32 v27, 0xffff0000, v27
    v_lshlrev_b32 v28, 16, v29
    ds_read_b128 a[140:143], v176 offset:15360
    v_and_b32 v29, 0xffff0000, v29
    v_lshlrev_b32 v30, 16, v31
    v_and_b32 v31, 0xffff0000, v31
    v_lshlrev_b32 v32, 16, v33
    ds_read_b128 a[144:147], v176 offset:16384
    v_and_b32 v33, 0xffff0000, v33
    v_lshlrev_b32 v34, 16, v35
    v_and_b32 v35, 0xffff0000, v35
    ds_read_b128 a[148:151], v176 offset:17408
    ds_read_b128 a[152:155], v176 offset:18432
    ds_read_b128 a[156:159], v176 offset:19456
    ds_read_b128 v[56:59], v176 offset:20480
    ds_read_b128 v[60:63], v176 offset:21504
    ds_read_b128 v[64:67], v176 offset:22528
    ds_read_b128 v[68:71], v176 offset:23552
    s_waitcnt vmcnt(0)
    v_cmp_gt_u32 vcc, 1, v13
    s_cbranch_vccnz k2_main_kernel_po
k2_main_kernel_pox:
    buffer_load_dwordx4 a[0:3], v1, s[4:7], s9 offen offset:0 sc1
    buffer_load_dwordx4 a[4:7], v1, s[4:7], s9 offen offset:1024 sc1
    ds_read_b128 v[72:75], v176 offset:24576
    ds_read_b128 v[76:79], v176 offset:25600
    ds_read_b128 v[80:83], v176 offset:26624
    ds_read_b128 v[84:87], v176 offset:27648
    buffer_load_dwordx4 a[8:11], v1, s[4:7], s9 offen offset:2048 sc1
    ds_read_b128 v[88:91], v176 offset:28672
    ds_read_b128 v[92:95], v176 offset:29696
    ds_read_b128 v[96:99], v176 offset:30720
    ds_read_b128 v[100:103], v176 offset:31744
    buffer_load_dwordx4 a[12:15], v1, s[4:7], s9 offen offset:3072 sc1
    ds_read_b128 v[104:107], v176 offset:32768
    ds_read_b128 v[108:111], v176 offset:33792
    ds_read_b128 v[112:115], v176 offset:34816
    ds_read_b128 v[116:119], v176 offset:35840
    s_add_u32 s34, s9, 4096
    buffer_load_dwordx4 a[16:19], v1, s[4:7], s34 offen offset:0 sc1
    ds_read_b128 v[120:123], v176 offset:36864
    ds_read_b128 v[124:127], v176 offset:37888
    ds_read_b128 v[128:131], v176 offset:38912
    ds_read_b128 v[132:135], v176 offset:39936
    buffer_load_dwordx4 a[20:23], v1, s[4:7], s34 offen offset:1024 sc1
    ds_read_b128 v[136:139], v177 offset:0
    ds_read_b128 v[140:143], v177 offset:1024
    ds_read_b128 v[144:147], v177 offset:2048
    ds_read_b128 v[148:151], v177 offset:3072
    buffer_load_dwordx4 a[24:27], v1, s[4:7], s34 offen offset:2048 sc1
    ds_read_b128 a[80:83], v177 offset:4096
    ds_read_b128 a[84:87], v177 offset:5120
    ds_read_b128 a[88:91], v177 offset:6144
    ds_read_b128 a[92:95], v177 offset:7168
    buffer_load_dwordx4 a[28:31], v1, s[4:7], s34 offen offset:3072 sc1
    ds_read_b128 v[168:171], v177 offset:8192
    ds_read_b128 v[172:175], v177 offset:9216
    v_lshlrev_b32 v187, 1, v12
    v_add_u32 v14, s13, v1
    v_add_u32 v15, s14, v1
    s_waitcnt lgkmcnt(0)
    s_waitcnt vmcnt(7)
    v_mfma_f32_16x16x32_bf16 v[36:39], v[152:155], a[0:3], 0
    v_mfma_f32_16x16x32_bf16 v[40:43], v[156:159], a[0:3], 0
    buffer_load_dwordx4 a[32:35], v1, s[4:7], s10 offen offset:0 sc1
    v_mfma_f32_16x16x32_bf16 v[44:47], v[160:163], a[0:3], 0
    v_mfma_f32_16x16x32_bf16 v[48:51], v[164:167], a[0:3], 0
    v_mfma_f32_16x16x32_bf16 v[52:55], a[96:99], a[0:3], 0
    s_waitcnt vmcnt(7)
    v_mfma_f32_16x16x32_bf16 v[36:39], a[100:103], a[4:7], v[36:39]
    v_mfma_f32_16x16x32_bf16 v[40:43], a[104:107], a[4:7], v[40:43]
    buffer_load_dwordx4 a[36:39], v1, s[4:7], s10 offen offset:1024 sc1
    v_mfma_f32_16x16x32_bf16 v[44:47], a[108:111], a[4:7], v[44:47]
    v_mfma_f32_16x16x32_bf16 v[48:51], a[112:115], a[4:7], v[48:51]
    v_mfma_f32_16x16x32_bf16 v[52:55], a[116:119], a[4:7], v[52:55]
    s_waitcnt vmcnt(7)
    v_mfma_f32_16x16x32_bf16 v[36:39], a[120:123], a[8:11], v[36:39]
    v_mfma_f32_16x16x32_bf16 v[40:43], a[124:127], a[8:11], v[40:43]
    buffer_load_dwordx4 a[40:43], v1, s[4:7], s24 offen offset:0 sc1
    v_mfma_f32_16x16x32_bf16 v[44:47], a[128:131], a[8:11], v[44:47]
    v_mfma_f32_16x16x32_bf16 v[48:51], a[132:135], a[8:11], v[48:51]
    v_mfma_f32_16x16x32_bf16 v[52:55], a[136:139], a[8:11], v[52:55]
    s_waitcnt vmcnt(7)
    v_mfma_f32_16x16x32_bf16 v[36:39], a[140:143], a[12:15], v[36:39]
    v_mfma_f32_16x16x32_bf16 v[40:43], a[144:147], a[12:15], v[40:43]
    buffer_load_dwordx4 a[44:47], v1, s[4:7], s24 offen offset:1024 sc1
    v_mfma_f32_16x16x32_bf16 v[44:47], a[148:151], a[12:15], v[44:47]
    v_mfma_f32_16x16x32_bf16 v[48:51], a[152:155], a[12:15], v[48:51]
    v_mfma_f32_16x16x32_bf16 v[52:55], a[156:159], a[12:15], v[52:55]
    s_waitcnt vmcnt(7)
    v_mfma_f32_16x16x32_bf16 v[36:39], v[56:59], a[16:19], v[36:39]
    v_mfma_f32_16x16x32_bf16 v[40:43], v[60:63], a[16:19], v[40:43]
    buffer_load_dwordx4 a[48:51], v1, s[4:7], s24 offen offset:2048 sc1
    v_mfma_f32_16x16x32_bf16 v[44:47], v[64:67], a[16:19], v[44:47]
    v_mfma_f32_16x16x32_bf16 v[48:51], v[68:71], a[16:19], v[48:51]
    v_mfma_f32_16x16x32_bf16 v[52:55], v[72:75], a[16:19], v[52:55]
    s_waitcnt vmcnt(7)
    v_mfma_f32_16x16x32_bf16 v[36:39], v[76:79], a[20:23], v[36:39]
    v_mfma_f32_16x16x32_bf16 v[40:43], v[80:83], a[20:23], v[40:43]
    buffer_load_dwordx4 a[52:55], v1, s[4:7], s24 offen offset:3072 sc1
    v_mfma_f32_16x16x32_bf16 v[44:47], v[84:87], a[20:23], v[44:47]
    v_mfma_f32_16x16x32_bf16 v[48:51], v[88:91], a[20:23], v[48:51]
    v_mfma_f32_16x16x32_bf16 v[52:55], v[92:95], a[20:23], v[52:55]
    s_waitcnt vmcnt(7)
    v_mfma_f32_16x16x32_bf16 v[36:39], v[96:99], a[24:27], v[36:39]
    v_mfma_f32_16x16x32_bf16 v[40:43], v[100:103], a[24:27], v[40:43]
    s_add_u32 s34, s24, 4096
    buffer_load_dwordx4 a[56:59], v1, s[4:7], s34 offen offset:0 sc1
    v_mfma_f32_16x16x32_bf16 v[44:47], v[104:107], a[24:27], v[44:47]
    v_mfma_f32_16x16x32_bf16 v[48:51], v[108:111], a[24:27], v[48:51]
    v_mfma_f32_16x16x32_bf16 v[52:55], v[112:115], a[24:27], v[52:55]
    s_waitcnt vmcnt(7)
    v_mfma_f32_16x16x32_bf16 v[36:39], v[116:119], a[28:31], v[36:39]
    v_mfma_f32_16x16x32_bf16 v[40:43], v[120:123], a[28:31], v[40:43]
    buffer_load_dwordx4 a[60:63], v1, s[4:7], s34 offen offset:1024 sc1
    v_mfma_f32_16x16x32_bf16 v[44:47], v[124:127], a[28:31], v[44:47]
    v_mfma_f32_16x16x32_bf16 v[48:51], v[128:131], a[28:31], v[48:51]
    v_mfma_f32_16x16x32_bf16 v[52:55], v[132:135], a[28:31], v[52:55]
    s_waitcnt vmcnt(7)
    v_mfma_f32_16x16x32_bf16 v[36:39], v[136:139], a[32:35], v[36:39]
    v_mfma_f32_16x16x32_bf16 v[40:43], v[140:143], a[32:35], v[40:43]
    buffer_load_dwordx4 a[64:67], v1, s[4:7], s34 offen offset:2048 sc1
    v_mfma_f32_16x16x32_bf16 v[44:47], v[144:147], a[32:35], v[44:47]
    v_mfma_f32_16x16x32_bf16 v[48:51], v[148:151], a[32:35], v[48:51]
    v_mfma_f32_16x16x32_bf16 v[52:55], a[80:83], a[32:35], v[52:55]
    s_waitcnt vmcnt(7)
    v_mfma_f32_16x16x32_bf16 v[36:39], a[84:87], a[36:39], v[36:39]
    v_mfma_f32_16x16x32_bf16 v[40:43], a[88:91], a[36:39], v[40:43]
    buffer_load_dwordx4 a[68:71], v1, s[4:7], s34 offen offset:3072 sc1
    v_mfma_f32_16x16x32_bf16 v[44:47], a[92:95], a[36:39], v[44:47]
    v_mfma_f32_16x16x32_bf16 v[48:51], v[168:171], a[36:39], v[48:51]
    v_mfma_f32_16x16x32_bf16 v[52:55], v[172:175], a[36:39], v[52:55]
    s_barrier
    s_waitcnt vmcnt(7)
    v_mfma_f32_16x16x32_bf16 v[16:19], v[152:155], a[40:43], v[16:19]
    v_mfma_f32_16x16x32_bf16 v[20:23], v[156:159], a[40:43], v[20:23]
    buffer_load_dwordx4 a[72:75], v1, s[4:7], s8 offen offset:0 sc1
    v_mfma_f32_16x16x32_bf16 v[24:27], v[160:163], a[40:43], v[24:27]
    ds_write_b128 v14, v[36:39] offset:0
    v_mfma_f32_16x16x32_bf16 v[28:31], v[164:167], a[40:43], v[28:31]
    v_mfma_f32_16x16x32_bf16 v[32:35], a[96:99], a[40:43], v[32:35]
    ds_write_b128 v14, v[40:43] offset:1024
    s_waitcnt vmcnt(7)
    v_mfma_f32_16x16x32_bf16 v[16:19], a[100:103], a[44:47], v[16:19]
    v_mfma_f32_16x16x32_bf16 v[20:23], a[104:107], a[44:47], v[20:23]
    ds_write_b128 v14, v[44:47] offset:2048
    buffer_load_dwordx4 a[76:79], v1, s[4:7], s8 offen offset:1024 sc1
    v_mfma_f32_16x16x32_bf16 v[24:27], a[108:111], a[44:47], v[24:27]
    v_mfma_f32_16x16x32_bf16 v[28:31], a[112:115], a[44:47], v[28:31]
    ds_write_b128 v14, v[48:51] offset:3072
    v_mfma_f32_16x16x32_bf16 v[32:35], a[116:119], a[44:47], v[32:35]
    s_waitcnt vmcnt(7)
    v_mfma_f32_16x16x32_bf16 v[16:19], a[120:123], a[48:51], v[16:19]
    ds_write_b128 v14, v[52:55] offset:4096
    v_mfma_f32_16x16x32_bf16 v[20:23], a[124:127], a[48:51], v[20:23]
    buffer_load_dwordx4 v[152:155], v1, s[4:7], s56 offen offset:0 sc1
    v_mfma_f32_16x16x32_bf16 v[24:27], a[128:131], a[48:51], v[24:27]
k2_main_kernel_pad_P7:
    s_cbranch_execz k2_main_kernel_tr_r13
    v_mfma_f32_16x16x32_bf16 v[28:31], a[132:135], a[48:51], v[28:31]
    v_mfma_f32_16x16x32_bf16 v[32:35], a[136:139], a[48:51], v[32:35]
    s_waitcnt vmcnt(7)
    v_mfma_f32_16x16x32_bf16 v[16:19], a[140:143], a[52:55], v[16:19]
    v_mfma_f32_16x16x32_bf16 v[20:23], a[144:147], a[52:55], v[20:23]
    buffer_load_dwordx4 v[160:163], v1, s[4:7], s57 offen offset:0 sc1
    v_mfma_f32_16x16x32_bf16 v[24:27], a[148:151], a[52:55], v[24:27]
    v_mfma_f32_16x16x32_bf16 v[28:31], a[152:155], a[52:55], v[28:31]
    v_mfma_f32_16x16x32_bf16 v[32:35], a[156:159], a[52:55], v[32:35]
    s_waitcnt vmcnt(7)
    v_mfma_f32_16x16x32_bf16 v[16:19], v[56:59], a[56:59], v[16:19]
    v_mfma_f32_16x16x32_bf16 v[20:23], v[60:63], a[56:59], v[20:23]
    s_add_u32 m0, s59, 0
    s_add_u32 s33, s53, 28672
    buffer_load_dwordx4 v1, s[4:7], s33 offen offset:0 sc1 lds
    v_mfma_f32_16x16x32_bf16 v[24:27], v[64:67], a[56:59], v[24:27]
    v_mfma_f32_16x16x32_bf16 v[28:31], v[68:71], a[56:59], v[28:31]
    v_mfma_f32_16x16x32_bf16 v[32:35], v[72:75], a[56:59], v[32:35]
    s_waitcnt lgkmcnt(0)
    s_barrier
    s_waitcnt vmcnt(7)
    v_mfma_f32_16x16x32_bf16 v[16:19], v[76:79], a[60:63], v[16:19]
    ds_read_b128 v[36:39], v15 offset:0
    v_mfma_f32_16x16x32_bf16 v[20:23], v[80:83], a[60:63], v[20:23]
    ds_read_b128 v[40:43], v15 offset:1024
    buffer_load_dwordx4 v1, s[4:7], s33 offen offset:1024 sc1 lds
    v_mfma_f32_16x16x32_bf16 v[24:27], v[84:87], a[60:63], v[24:27]
    ds_read_b128 v[44:47], v15 offset:2048
    v_mfma_f32_16x16x32_bf16 v[28:31], v[88:91], a[60:63], v[28:31]
    ds_read_b128 v[48:51], v15 offset:3072
    v_mfma_f32_16x16x32_bf16 v[32:35], v[92:95], a[60:63], v[32:35]
    ds_read_b128 v[52:55], v15 offset:4096
    s_waitcnt vmcnt(7)
    v_mfma_f32_16x16x32_bf16 v[16:19], v[96:99], a[64:67], v[16:19]
    v_mfma_f32_16x16x32_bf16 v[20:23], v[100:103], a[64:67], v[20:23]
    buffer_load_dwordx4 v1, s[4:7], s33 offen offset:2048 sc1 lds
    v_mfma_f32_16x16x32_bf16 v[24:27], v[104:107], a[64:67], v[24:27]
    v_mfma_f32_16x16x32_bf16 v[28:31], v[108:111], a[64:67], v[28:31]
    v_mfma_f32_16x16x32_bf16 v[32:35], v[112:115], a[64:67], v[32:35]
    s_waitcnt vmcnt(7)
    v_mfma_f32_16x16x32_bf16 v[16:19], v[116:119], a[68:71], v[16:19]
    v_mfma_f32_16x16x32_bf16 v[20:23], v[120:123], a[68:71], v[20:23]
    buffer_load_dwordx4 v1, s[4:7], s33 offen offset:3072 sc1 lds
    v_mfma_f32_16x16x32_bf16 v[24:27], v[124:127], a[68:71], v[24:27]
    v_mfma_f32_16x16x32_bf16 v[28:31], v[128:131], a[68:71], v[28:31]
    v_mfma_f32_16x16x32_bf16 v[32:35], v[132:135], a[68:71], v[32:35]
    s_waitcnt vmcnt(7)
    v_mfma_f32_16x16x32_bf16 v[16:19], v[136:139], a[72:75], v[16:19]
    v_mfma_f32_16x16x32_bf16 v[20:23], v[140:143], a[72:75], v[20:23]
    s_add_u32 m0, s59, 4096
    s_add_u32 s33, s53, 32768
    buffer_load_dwordx4 v1, s[4:7], s33 offen offset:0 sc1 lds
    v_mfma_f32_16x16x32_bf16 v[24:27], v[144:147], a[72:75], v[24:27]
    v_mfma_f32_16x16x32_bf16 v[28:31], v[148:151], a[72:75], v[28:31]
    v_mfma_f32_16x16x32_bf16 v[32:35], a[80:83], a[72:75], v[32:35]
    s_waitcnt vmcnt(7)
    v_mfma_f32_16x16x32_bf16 v[16:19], a[84:87], a[76:79], v[16:19]
    v_mfma_f32_16x16x32_bf16 v[20:23], a[88:91], a[76:79], v[20:23]
    buffer_load_dwordx4 v1, s[4:7], s33 offen offset:1024 sc1 lds
    v_mfma_f32_16x16x32_bf16 v[24:27], a[92:95], a[76:79], v[24:27]
    v_mfma_f32_16x16x32_bf16 v[28:31], v[168:171], a[76:79], v[28:31]
    v_mfma_f32_16x16x32_bf16 v[32:35], v[172:175], a[76:79], v[32:35]
    s_waitcnt lgkmcnt(0)
    s_nop 2
    v_pk_add_f32 v[16:17], v[16:17], v[36:37]
    v_pk_add_f32 v[18:19], v[18:19], v[38:39]
    v_pk_add_f32 v[20:21], v[20:21], v[40:41]
    v_pk_add_f32 v[22:23], v[22:23], v[42:43]
    v_pk_add_f32 v[24:25], v[24:25], v[44:45]
    v_pk_add_f32 v[26:27], v[26:27], v[46:47]
    v_pk_add_f32 v[28:29], v[28:29], v[48:49]
    v_pk_add_f32 v[30:31], v[30:31], v[50:51]
    v_pk_add_f32 v[32:33], v[32:33], v[52:53]
    v_pk_add_f32 v[34:35], v[34:35], v[54:55]
    v_cvt_pk_bf16_f32 v176, v16, v17
    v_cvt_pk_bf16_f32 v177, v18, v19
    v_cvt_pk_bf16_f32 v178, v20, v21
    v_cvt_pk_bf16_f32 v179, v22, v23
    v_cvt_pk_bf16_f32 v180, v24, v25
    v_cvt_pk_bf16_f32 v181, v26, v27
    v_cvt_pk_bf16_f32 v182, v28, v29
    v_cvt_pk_bf16_f32 v183, v30, v31
    v_cvt_pk_bf16_f32 v184, v32, v33
    v_cvt_pk_bf16_f32 v185, v34, v35
    buffer_store_dwordx4 v[176:179], v188, s[4:7], s27 offen sc1
    buffer_store_dwordx4 v[180:183], v188, s[4:7], s27 offen offset:2048 sc1
    buffer_store_dwordx2 v[184:185], v189, s[4:7], s29 offen sc1
    v_mov_b32 v36, 0
    v_mov_b32 v37, 0
    v_mov_b32 v40, 0x3f803f80
    v_dot2c_f32_bf16 v36, v176, v40
    v_dot2c_f32_bf16 v37, v176, v176
    v_dot2c_f32_bf16 v36, v177, v40
    v_dot2c_f32_bf16 v37, v177, v177
    v_dot2c_f32_bf16 v36, v178, v40
    v_dot2c_f32_bf16 v37, v178, v178
    v_dot2c_f32_bf16 v36, v179, v40
    v_dot2c_f32_bf16 v37, v179, v179
    v_dot2c_f32_bf16 v36, v180, v40
    v_dot2c_f32_bf16 v37, v180, v180
    v_dot2c_f32_bf16 v36, v181, v40
    v_dot2c_f32_bf16 v37, v181, v181
    v_dot2c_f32_bf16 v36, v182, v40
    v_dot2c_f32_bf16 v37, v182, v182
    v_dot2c_f32_bf16 v36, v183, v40
    v_dot2c_f32_bf16 v37, v183, v183
    v_dot2c_f32_bf16 v36, v184, v40
    v_dot2c_f32_bf16 v37, v184, v184
    v_dot2c_f32_bf16 v36, v185, v40
    v_dot2c_f32_bf16 v37, v185, v185
    v_lshlrev_b32 v41, 3, v0
    s_nop 1
    v_mov_b32 v38, v36
    v_mov_b32 v39, v37
    s_nop 0
    v_permlane32_swap_b32 v36, v38
    v_permlane32_swap_b32 v37, v39
    v_add_f32 v36, v36, v38
    v_add_f32 v37, v37, v39
    v_mov_b32 v38, v36
    v_mov_b32 v39, v37
    s_nop 0
    v_permlane16_swap_b32 v36, v38
    v_permlane16_swap_b32 v37, v39
    v_add_f32 v36, v36, v38
    v_add_f32 v37, v37, v39
    s_mov_b64 exec, 0xffff
    buffer_store_dwordx2 v[36:37], v41, s[4:7], s30 offen sc1
    s_mov_b64 exec, -1
    v_add_u32 v0, 0x20000, v188
k2_main_kernel_m16:
    buffer_load_dwordx4 v1, s[4:7], s33 offen offset:2048 sc1 lds
    s_add_u32 m0, s59, 28672
    s_add_u32 s33, s53, 57344
    buffer_load_dwordx4 v1, s[4:7], s33 offen offset:0 sc1 lds
    buffer_load_dwordx4 v1, s[4:7], s33 offen offset:1024 sc1 lds
    buffer_load_dwordx4 v1, s[4:7], s33 offen offset:2048 sc1 lds
    s_waitcnt vmcnt(5)
    buffer_store_dword v7, off, s[4:7], s67 sc1
    buffer_load_dwordx4 v1, s[4:7], s33 offen offset:3072 sc1 lds
    s_add_u32 m0, s59, 32768
    s_add_u32 s33, s53, 61440
    buffer_load_dwordx4 v1, s[4:7], s33 offen offset:0 sc1 lds
    buffer_load_dwordx4 v1, s[4:7], s33 offen offset:1024 sc1 lds
    s_mov_b64 exec, 0
    s_cmp_eq_u32 s3, 0
    s_cbranch_scc1 k2_main_kernel_pad_P10
    s_cmp_eq_u32 s3, 1
    s_cbranch_scc1 k2_main_kernel_tr_c3
    s_cmp_eq_u32 s3, 2
    s_cbranch_scc1 k2_main_kernel_tr_c3
k2_main_kernel_tr_c3:
    s_mov_b64 exec, -1
    v_mov_b32 v38, 2
    s_waitcnt vmcnt(8)
    buffer_store_dword v38, off, s[4:7], s67 sc1
    s_waitcnt lgkmcnt(0)
    s_barrier
    buffer_load_dwordx4 v1, s[4:7], s33 offen offset:2048 sc1 lds
    s_add_u32 m0, s59, 57344
    s_add_u32 s33, s53, 86016
    buffer_load_dwordx4 v1, s[4:7], s33 offen offset:0 sc1 lds
    buffer_load_dwordx4 v1, s[4:7], s33 offen offset:1024 sc1 lds
    buffer_load_dwordx4 v1, s[4:7], s33 offen offset:2048 sc1 lds
    buffer_load_dwordx4 v1, s[4:7], s33 offen offset:3072 sc1 lds
    s_add_u32 m0, s59, 61440
    s_add_u32 s33, s53, 90112
    buffer_load_dwordx4 v1, s[4:7], s33 offen offset:0 sc1 lds
    buffer_load_dwordx4 v1, s[4:7], s33 offen offset:1024 sc1 lds
    buffer_load_dwordx4 v1, s[4:7], s33 offen offset:2048 sc1 lds
    s_add_u32 m0, s59, 86016
    s_add_u32 s33, s53, 114688
    buffer_load_dwordx4 v1, s[4:7], s33 offen offset:0 sc1 lds
    buffer_load_dwordx4 v1, s[4:7], s33 offen offset:1024 sc1 lds
    buffer_load_dwordx4 v1, s[4:7], s33 offen offset:2048 sc1 lds
    buffer_load_dwordx4 v1, s[4:7], s33 offen offset:3072 sc1 lds
    s_add_u32 m0, s59, 90112
    s_add_u32 s33, s53, 118784
    buffer_load_dwordx4 v1, s[4:7], s33 offen offset:0 sc1 lds
    buffer_load_dwordx4 v1, s[4:7], s33 offen offset:1024 sc1 lds
    buffer_load_dword v13, v12, s[4:7], s68 offen sc1
    buffer_load_dwordx4 v1, s[4:7], s33 offen offset:2048 sc1 lds
    ds_read_b128 v[112:115], v191 offset:49152
    ds_read_b128 v[116:119], v191 offset:49408
    ds_read_b128 v[120:123], v191 offset:51200
    ds_read_b128 v[124:127], v191 offset:51456
    ds_read_b128 v[128:131], v191 offset:53248
    ds_read_b128 v[132:135], v191 offset:53504
    ds_read_b128 v[136:139], v191 offset:55296
    ds_read_b128 v[140:143], v191 offset:55552
    s_waitcnt vmcnt(1)
    v_cmp_gt_u32 vcc, 1, v13
    s_cbranch_vccnz k2_main_kernel_p1
k2_main_kernel_p1x:
    s_add_u32 s34, s54, 0
    buffer_load_dwordx4 a[0:3], v188, s[4:7], s34 offen offset:0 sc1
    buffer_load_dwordx4 a[4:7], v188, s[4:7], s34 offen offset:256 sc1
    buffer_load_dwordx4 a[8:11], v188, s[4:7], s34 offen offset:2048 sc1
    buffer_load_dwordx4 a[12:15], v188, s[4:7], s34 offen offset:2304 sc1
    s_add_u32 s34, s54, 4096
    buffer_load_dwordx4 a[16:19], v188, s[4:7], s34 offen offset:0 sc1
    buffer_load_dwordx4 a[20:23], v188, s[4:7], s34 offen offset:256 sc1
    buffer_load_dwordx4 a[24:27], v188, s[4:7], s34 offen offset:2048 sc1
    buffer_load_dwordx4 a[28:31], v188, s[4:7], s34 offen offset:2304 sc1
    s_add_u32 s34, s54, 8192
    buffer_load_dwordx4 a[32:35], v188, s[4:7], s34 offen offset:0 sc1
    buffer_load_dwordx4 a[36:39], v188, s[4:7], s34 offen offset:256 sc1
    buffer_load_dwordx4 a[40:43], v188, s[4:7], s34 offen offset:2048 sc1
    buffer_load_dwordx4 a[44:47], v188, s[4:7], s34 offen offset:2304 sc1
    s_waitcnt vmcnt(11)
    s_waitcnt lgkmcnt(6)
    v_mfma_f32_16x16x32_bf16 v[16:19], v[112:115], a[0:3], 0
    s_waitcnt vmcnt(10)
    v_mfma_f32_16x16x32_bf16 v[24:27], v[112:115], a[4:7], 0
    s_add_u32 s34, s54, 12288
    ds_read_b128 v[112:115], v191 offset:57344
    v_mfma_f32_16x16x32_bf16 v[20:23], v[116:119], a[0:3], 0
    buffer_load_dwordx4 a[48:51], v188, s[4:7], s34 offen offset:0 sc1
    v_mfma_f32_16x16x32_bf16 v[28:31], v[116:119], a[4:7], 0
    s_waitcnt lgkmcnt(5)
    ds_read_b128 v[116:119], v191 offset:57600
    v_mfma_f32_16x16x32_bf16 v[32:35], v[120:123], a[0:3], 0
    v_mfma_f32_16x16x32_bf16 v[40:43], v[120:123], a[4:7], 0
    ds_read_b128 v[120:123], v191 offset:59392
    v_mfma_f32_16x16x32_bf16 v[36:39], v[124:127], a[0:3], 0
    buffer_load_dwordx4 a[52:55], v188, s[4:7], s34 offen offset:256 sc1
    v_mfma_f32_16x16x32_bf16 v[44:47], v[124:127], a[4:7], 0
    s_waitcnt lgkmcnt(5)
    ds_read_b128 v[124:127], v191 offset:59648
    v_mfma_f32_16x16x32_bf16 v[48:51], v[128:131], a[0:3], 0
    v_mov_b32 v15, 0
    v_add_f32 v152, v152, v153
    v_mfma_f32_16x16x32_bf16 v[56:59], v[128:131], a[4:7], 0
    s_lshl_b32 s36, s3, 10
    ds_read_b128 v[128:131], v191 offset:61440
    v_add_f32 v154, v154, v155
    v_mfma_f32_16x16x32_bf16 v[52:55], v[132:135], a[0:3], 0
    buffer_load_dword v13, v12, s[4:7], s68 offen sc1
    v_mfma_f32_16x16x32_bf16 v[60:63], v[132:135], a[4:7], 0
    s_waitcnt vmcnt(11) lgkmcnt(5)
    ds_read_b128 v[132:135], v191 offset:61696
    v_add_f32 v152, v152, v154
    v_mfma_f32_16x16x32_bf16 v[16:19], v[136:139], a[8:11], v[16:19]
    buffer_load_dwordx4 a[56:59], v188, s[4:7], s34 offen offset:2048 sc1
    v_mfma_f32_16x16x32_bf16 v[24:27], v[136:139], a[12:15], v[24:27]
    ds_read_b128 v[136:139], v191 offset:63488
    v_add_f32 v160, v160, v161
    v_mfma_f32_16x16x32_bf16 v[20:23], v[140:143], a[8:11], v[20:23]
    v_add_f32 v162, v162, v163
    v_add_f32 v160, v160, v162
    v_mfma_f32_16x16x32_bf16 v[28:31], v[140:143], a[12:15], v[28:31]
    s_waitcnt lgkmcnt(5)
    ds_read_b128 v[140:143], v191 offset:63744
    v_cvt_pk_bf16_f32 v169, v152, v15
    v_mfma_f32_16x16x32_bf16 v[32:35], v[112:115], a[8:11], v[32:35]
    buffer_load_dwordx4 a[60:63], v188, s[4:7], s34 offen offset:2304 sc1
    v_mfma_f32_16x16x32_bf16 v[40:43], v[112:115], a[12:15], v[40:43]
    ds_read_b128 v[112:115], v0 offset:0
    v_lshlrev_b32 v153, 16, v169
    v_mfma_f32_16x16x32_bf16 v[36:39], v[116:119], a[8:11], v[36:39]
    s_add_u32 s34, s54, 16384
    v_sub_f32 v153, v152, v153
    v_cvt_pk_bf16_f32 v168, v152, v153
    v_mfma_f32_16x16x32_bf16 v[44:47], v[116:119], a[12:15], v[44:47]
    s_waitcnt lgkmcnt(5)
    ds_read_b128 v[116:119], v0 offset:256
    v_cvt_pk_bf16_f32 v173, v160, v15
    v_mfma_f32_16x16x32_bf16 v[48:51], v[120:123], a[8:11], v[48:51]
    v_lshlrev_b32 v161, 16, v173
    v_sub_f32 v161, v160, v161
    v_mfma_f32_16x16x32_bf16 v[56:59], v[120:123], a[12:15], v[56:59]
    ds_read_b128 v[120:123], v0 offset:2048
    v_cvt_pk_bf16_f32 v172, v160, v161
    v_mfma_f32_16x16x32_bf16 v[52:55], v[124:127], a[8:11], v[52:55]
    buffer_load_dwordx4 a[64:67], v188, s[4:7], s34 offen offset:0 sc1
    v_mfma_f32_16x16x32_bf16 v[60:63], v[124:127], a[12:15], v[60:63]
    s_waitcnt vmcnt(12) lgkmcnt(5)
    ds_read_b128 v[124:127], v0 offset:2304
    v_add_u32 v14, s36, v3
    v_mfma_f32_16x16x32_bf16 v[16:19], v[128:131], a[16:19], v[16:19]
    ds_write_b64 v14, v[168:169] offset:24576
    v_mfma_f32_16x16x32_bf16 v[24:27], v[128:131], a[20:23], v[24:27]
    ds_read_b128 v[128:131], v0 offset:4096
    v_mfma_f32_16x16x32_bf16 v[20:23], v[132:135], a[16:19], v[20:23]
    buffer_load_dwordx4 a[68:71], v188, s[4:7], s34 offen offset:256 sc1
    v_mfma_f32_16x16x32_bf16 v[28:31], v[132:135], a[20:23], v[28:31]
    s_waitcnt lgkmcnt(5)
    ds_read_b128 v[132:135], v0 offset:4352
    v_mfma_f32_16x16x32_bf16 v[32:35], v[136:139], a[16:19], v[32:35]
    ds_write_b64 v14, v[172:173] offset:28672
    v_mfma_f32_16x16x32_bf16 v[40:43], v[136:139], a[20:23], v[40:43]
    ds_read_b128 v[136:139], v0 offset:6144
    v_mfma_f32_16x16x32_bf16 v[36:39], v[140:143], a[16:19], v[36:39]
    buffer_load_dwordx4 a[72:75], v188, s[4:7], s34 offen offset:2048 sc1
    v_mfma_f32_16x16x32_bf16 v[44:47], v[140:143], a[20:23], v[44:47]
    s_waitcnt lgkmcnt(5)
    ds_read_b128 v[140:143], v0 offset:6400
    v_mfma_f32_16x16x32_bf16 v[48:51], v[112:115], a[16:19], v[48:51]
    v_mfma_f32_16x16x32_bf16 v[56:59], v[112:115], a[20:23], v[56:59]
    ds_read_b128 v[112:115], v0 offset:8192
    v_mfma_f32_16x16x32_bf16 v[52:55], v[116:119], a[16:19], v[52:55]
    v_mfma_f32_16x16x32_bf16 v[60:63], v[116:119], a[20:23], v[60:63]
    s_waitcnt vmcnt(12) lgkmcnt(5)
    ds_read_b128 v[116:119], v0 offset:8448
    v_mfma_f32_16x16x32_bf16 v[16:19], v[120:123], a[24:27], v[16:19]
    buffer_load_dwordx4 a[76:79], v188, s[4:7], s34 offen offset:2304 sc1
    v_mfma_f32_16x16x32_bf16 v[24:27], v[120:123], a[28:31], v[24:27]
    s_add_u32 s34, s54, 20480
    ds_read_b128 v[120:123], v0 offset:10240
    v_mfma_f32_16x16x32_bf16 v[20:23], v[124:127], a[24:27], v[20:23]
    v_mfma_f32_16x16x32_bf16 v[28:31], v[124:127], a[28:31], v[28:31]
    s_waitcnt lgkmcnt(5)
    ds_read_b128 v[124:127], v0 offset:10496
    v_mfma_f32_16x16x32_bf16 v[32:35], v[128:131], a[24:27], v[32:35]
    s_barrier
    buffer_load_dwordx4 a[80:83], v188, s[4:7], s34 offen offset:0 sc1
    v_mfma_f32_16x16x32_bf16 v[40:43], v[128:131], a[28:31], v[40:43]
    ds_read_b128 v[128:131], v188 offset:0
    v_mfma_f32_16x16x32_bf16 v[36:39], v[132:135], a[24:27], v[36:39]
    v_mfma_f32_16x16x32_bf16 v[44:47], v[132:135], a[28:31], v[44:47]
    s_waitcnt lgkmcnt(5)
    ds_read_b128 v[132:135], v188 offset:256
    v_mfma_f32_16x16x32_bf16 v[48:51], v[136:139], a[24:27], v[48:51]
    v_mfma_f32_16x16x32_bf16 v[56:59], v[136:139], a[28:31], v[56:59]
    ds_read_b128 v[136:139], v188 offset:2048
    v_mfma_f32_16x16x32_bf16 v[52:55], v[140:143], a[24:27], v[52:55]
    buffer_load_dwordx4 a[84:87], v188, s[4:7], s34 offen offset:256 sc1
    v_mfma_f32_16x16x32_bf16 v[60:63], v[140:143], a[28:31], v[60:63]
    s_waitcnt vmcnt(13) lgkmcnt(5)
    ds_read_b128 v[140:143], v188 offset:2304
    v_mfma_f32_16x16x32_bf16 v[16:19], v[112:115], a[32:35], v[16:19]
    v_mfma_f32_16x16x32_bf16 v[24:27], v[112:115], a[36:39], v[24:27]
    ds_read_b128 v[112:115], v188 offset:4096
    v_mfma_f32_16x16x32_bf16 v[20:23], v[116:119], a[32:35], v[20:23]
    buffer_load_dwordx4 a[88:91], v188, s[4:7], s34 offen offset:2048 sc1
    v_mfma_f32_16x16x32_bf16 v[28:31], v[116:119], a[36:39], v[28:31]
    s_waitcnt lgkmcnt(5)
    ds_read_b128 v[116:119], v188 offset:4352
    v_mfma_f32_16x16x32_bf16 v[32:35], v[120:123], a[32:35], v[32:35]
    v_mfma_f32_16x16x32_bf16 v[40:43], v[120:123], a[36:39], v[40:43]
    ds_read_b128 v[120:123], v188 offset:6144
    v_mfma_f32_16x16x32_bf16 v[36:39], v[124:127], a[32:35], v[36:39]
    v_mfma_f32_16x16x32_bf16 v[44:47], v[124:127], a[36:39], v[44:47]
    s_waitcnt lgkmcnt(5)
    ds_read_b128 v[124:127], v188 offset:6400
    v_mfma_f32_16x16x32_bf16 v[48:51], v[128:131], a[32:35], v[48:51]
    buffer_load_dwordx4 a[92:95], v188, s[4:7], s34 offen offset:2304 sc1
    v_mfma_f32_16x16x32_bf16 v[56:59], v[128:131], a[36:39], v[56:59]
    s_add_u32 s34, s54, 24576
    ds_read_b128 v[128:131], v188 offset:8192
    v_mfma_f32_16x16x32_bf16 v[52:55], v[132:135], a[32:35], v[52:55]
    s_waitcnt vmcnt(10)
    v_cmp_gt_u32 vcc, 2, v13
    v_mfma_f32_16x16x32_bf16 v[60:63], v[132:135], a[36:39], v[60:63]
    s_cbranch_vccnz k2_main_kernel_ps
k2_main_kernel_psx:
    s_waitcnt lgkmcnt(5)
    ds_read_b128 v[132:135], v188 offset:8448
    v_mfma_f32_16x16x32_bf16 v[16:19], v[136:139], a[40:43], v[16:19]
    v_mfma_f32_16x16x32_bf16 v[24:27], v[136:139], a[44:47], v[24:27]
    ds_read_b128 v[136:139], v188 offset:10240
    v_mfma_f32_16x16x32_bf16 v[20:23], v[140:143], a[40:43], v[20:23]
    buffer_load_dwordx4 a[96:99], v188, s[4:7], s34 offen offset:0 sc1
    v_mfma_f32_16x16x32_bf16 v[28:31], v[140:143], a[44:47], v[28:31]
    s_waitcnt lgkmcnt(5)
    ds_read_b128 v[140:143], v188 offset:10496
    v_mfma_f32_16x16x32_bf16 v[32:35], v[112:115], a[40:43], v[32:35]
    v_mfma_f32_16x16x32_bf16 v[40:43], v[112:115], a[44:47], v[40:43]
    ds_read_b128 v[112:115], v188 offset:12288
    v_mfma_f32_16x16x32_bf16 v[36:39], v[116:119], a[40:43], v[36:39]
    buffer_load_dwordx2 v[144:145], v186, s[4:7], s55 offen offset:0 sc1
    v_mfma_f32_16x16x32_bf16 v[44:47], v[116:119], a[44:47], v[44:47]
    s_waitcnt lgkmcnt(5)
    ds_read_b128 v[116:119], v188 offset:12544
    v_mfma_f32_16x16x32_bf16 v[48:51], v[120:123], a[40:43], v[48:51]
    buffer_load_dwordx2 v[146:147], v186, s[4:7], s55 offen offset:128 sc1
    v_mfma_f32_16x16x32_bf16 v[56:59], v[120:123], a[44:47], v[56:59]
    ds_read_b128 v[120:123], v188 offset:14336
    v_mfma_f32_16x16x32_bf16 v[52:55], v[124:127], a[40:43], v[52:55]
    buffer_load_dwordx2 v[148:149], v186, s[4:7], s55 offen offset:256 sc1
    v_mfma_f32_16x16x32_bf16 v[60:63], v[124:127], a[44:47], v[60:63]
    s_waitcnt lgkmcnt(5)
    ds_read_b128 v[124:127], v188 offset:14592
    v_mfma_f32_16x16x32_bf16 v[16:19], v[128:131], a[48:51], v[16:19]
    buffer_load_dwordx2 v[150:151], v186, s[4:7], s55 offen offset:384 sc1
    v_mfma_f32_16x16x32_bf16 v[24:27], v[128:131], a[52:55], v[24:27]
    ds_read_b128 v[128:131], v188 offset:16384
    v_mfma_f32_16x16x32_bf16 v[20:23], v[132:135], a[48:51], v[20:23]
    buffer_load_dwordx4 a[100:103], v188, s[4:7], s34 offen offset:256 sc1
    v_mfma_f32_16x16x32_bf16 v[28:31], v[132:135], a[52:55], v[28:31]
    s_waitcnt lgkmcnt(5)
    ds_read_b128 v[132:135], v188 offset:16640
    v_mfma_f32_16x16x32_bf16 v[32:35], v[136:139], a[48:51], v[32:35]
    v_mfma_f32_16x16x32_bf16 v[40:43], v[136:139], a[52:55], v[40:43]
    ds_read_b128 v[136:139], v188 offset:18432
    v_mfma_f32_16x16x32_bf16 v[36:39], v[140:143], a[48:51], v[36:39]
    v_mfma_f32_16x16x32_bf16 v[44:47], v[140:143], a[52:55], v[44:47]
    s_waitcnt lgkmcnt(5)
    ds_read_b128 v[140:143], v188 offset:18688
    v_mfma_f32_16x16x32_bf16 v[48:51], v[112:115], a[48:51], v[48:51]
    buffer_load_dwordx4 a[104:107], v188, s[4:7], s34 offen offset:2048 sc1
    v_mfma_f32_16x16x32_bf16 v[56:59], v[112:115], a[52:55], v[56:59]
    ds_read_b128 v[112:115], v188 offset:20480
    v_mfma_f32_16x16x32_bf16 v[52:55], v[116:119], a[48:51], v[52:55]
    v_mfma_f32_16x16x32_bf16 v[60:63], v[116:119], a[52:55], v[60:63]
    s_waitcnt vmcnt(15) lgkmcnt(5)
    ds_read_b128 v[116:119], v188 offset:20736
    v_mfma_f32_16x16x32_bf16 v[16:19], v[120:123], a[56:59], v[16:19]
    buffer_load_dwordx4 a[108:111], v188, s[4:7], s34 offen offset:2304 sc1
    v_mfma_f32_16x16x32_bf16 v[24:27], v[120:123], a[60:63], v[24:27]
    ds_read_b128 v[120:123], v188 offset:22528
    v_mfma_f32_16x16x32_bf16 v[20:23], v[124:127], a[56:59], v[20:23]
    s_add_u32 s34, s54, 28672
    v_mfma_f32_16x16x32_bf16 v[28:31], v[124:127], a[60:63], v[28:31]
    s_waitcnt lgkmcnt(5)
    ds_read_b128 v[124:127], v188 offset:22784
    v_mfma_f32_16x16x32_bf16 v[32:35], v[128:131], a[56:59], v[32:35]
    v_mfma_f32_16x16x32_bf16 v[40:43], v[128:131], a[60:63], v[40:43]
    ds_read_b128 v[128:131], v188 offset:24576
    v_mfma_f32_16x16x32_bf16 v[36:39], v[132:135], a[56:59], v[36:39]
    buffer_load_dwordx4 a[112:115], v188, s[4:7], s34 offen offset:0 sc1
    v_mfma_f32_16x16x32_bf16 v[44:47], v[132:135], a[60:63], v[44:47]
    s_waitcnt lgkmcnt(5)
    ds_read_b128 v[132:135], v188 offset:24832
    v_mfma_f32_16x16x32_bf16 v[48:51], v[136:139], a[56:59], v[48:51]
    v_mfma_f32_16x16x32_bf16 v[56:59], v[136:139], a[60:63], v[56:59]
    ds_read_b128 v[136:139], v188 offset:26624
    v_mfma_f32_16x16x32_bf16 v[52:55], v[140:143], a[56:59], v[52:55]
    buffer_load_dwordx4 a[116:119], v188, s[4:7], s34 offen offset:256 sc1
    v_mfma_f32_16x16x32_bf16 v[60:63], v[140:143], a[60:63], v[60:63]
    s_waitcnt vmcnt(16) lgkmcnt(5)
    ds_read_b128 v[140:143], v188 offset:26880
    v_mfma_f32_16x16x32_bf16 v[16:19], v[112:115], a[64:67], v[16:19]
    s_barrier
    v_mfma_f32_16x16x32_bf16 v[24:27], v[112:115], a[68:71], v[24:27]
    ds_read_b128 v[112:115], v188 offset:28672
    v_mfma_f32_16x16x32_bf16 v[20:23], v[116:119], a[64:67], v[20:23]
    v_mfma_f32_16x16x32_bf16 v[28:31], v[116:119], a[68:71], v[28:31]
    s_waitcnt lgkmcnt(5)
    ds_read_b128 v[116:119], v188 offset:28928
    v_mfma_f32_16x16x32_bf16 v[32:35], v[120:123], a[64:67], v[32:35]
    buffer_load_dwordx4 a[120:123], v188, s[4:7], s34 offen offset:2048 sc1
    v_mfma_f32_16x16x32_bf16 v[40:43], v[120:123], a[68:71], v[40:43]
    ds_read_b128 v[120:123], v188 offset:30720
    v_mfma_f32_16x16x32_bf16 v[36:39], v[124:127], a[64:67], v[36:39]
    v_mfma_f32_16x16x32_bf16 v[44:47], v[124:127], a[68:71], v[44:47]
    s_waitcnt lgkmcnt(5)
    ds_read_b128 v[124:127], v188 offset:30976
    v_mfma_f32_16x16x32_bf16 v[48:51], v[128:131], a[64:67], v[48:51]
    buffer_load_dwordx4 a[124:127], v188, s[4:7], s34 offen offset:2304 sc1
    v_mfma_f32_16x16x32_bf16 v[56:59], v[128:131], a[68:71], v[56:59]
    ds_read_b128 v[128:131], v188 offset:32768
    v_mfma_f32_16x16x32_bf16 v[52:55], v[132:135], a[64:67], v[52:55]
    s_add_u32 s34, s54, 32768
    v_mfma_f32_16x16x32_bf16 v[60:63], v[132:135], a[68:71], v[60:63]
    s_waitcnt vmcnt(16) lgkmcnt(5)
    ds_read_b128 v[132:135], v188 offset:33024
    v_mfma_f32_16x16x32_bf16 v[16:19], v[136:139], a[72:75], v[16:19]
    v_mfma_f32_16x16x32_bf16 v[24:27], v[136:139], a[76:79], v[24:27]
    ds_read_b128 v[136:139], v188 offset:34816
    v_mfma_f32_16x16x32_bf16 v[20:23], v[140:143], a[72:75], v[20:23]
    buffer_load_dwordx4 a[128:131], v188, s[4:7], s34 offen offset:0 sc1
    v_mfma_f32_16x16x32_bf16 v[28:31], v[140:143], a[76:79], v[28:31]
    s_waitcnt lgkmcnt(5)
    ds_read_b128 v[140:143], v188 offset:35072
    v_mfma_f32_16x16x32_bf16 v[32:35], v[112:115], a[72:75], v[32:35]
    v_mfma_f32_16x16x32_bf16 v[40:43], v[112:115], a[76:79], v[40:43]
    ds_read_b128 v[112:115], v188 offset:36864
    v_mfma_f32_16x16x32_bf16 v[36:39], v[116:119], a[72:75], v[36:39]
    buffer_load_dwordx4 a[132:135], v188, s[4:7], s34 offen offset:256 sc1
    v_mfma_f32_16x16x32_bf16 v[44:47], v[116:119], a[76:79], v[44:47]
    s_waitcnt lgkmcnt(5)
    ds_read_b128 v[116:119], v188 offset:37120
    v_mfma_f32_16x16x32_bf16 v[48:51], v[120:123], a[72:75], v[48:51]
    v_mfma_f32_16x16x32_bf16 v[56:59], v[120:123], a[76:79], v[56:59]
    ds_read_b128 v[120:123], v188 offset:38912
    v_mfma_f32_16x16x32_bf16 v[52:55], v[124:127], a[72:75], v[52:55]
    v_mfma_f32_16x16x32_bf16 v[60:63], v[124:127], a[76:79], v[60:63]
    s_waitcnt vmcnt(16) lgkmcnt(5)
    ds_read_b128 v[124:127], v188 offset:39168
    v_mfma_f32_16x16x32_bf16 v[16:19], v[128:131], a[80:83], v[16:19]
    s_waitcnt vmcnt(9)
    v_add_f32 v144, v144, v146
    v_add_f32 v145, v145, v147
    v_mfma_f32_16x16x32_bf16 v[24:27], v[128:131], a[84:87], v[24:27]
    ds_read_b128 v[128:131], v188 offset:40960
    v_add_f32 v148, v148, v150
    v_mfma_f32_16x16x32_bf16 v[20:23], v[132:135], a[80:83], v[20:23]
    buffer_load_dwordx4 a[136:139], v188, s[4:7], s34 offen offset:2048 sc1
    v_mfma_f32_16x16x32_bf16 v[28:31], v[132:135], a[84:87], v[28:31]
    s_waitcnt lgkmcnt(5)
    ds_read_b128 v[132:135], v188 offset:41216
    v_add_f32 v149, v149, v151
    v_mfma_f32_16x16x32_bf16 v[32:35], v[136:139], a[80:83], v[32:35]
    v_add_f32 v144, v144, v148
    v_add_f32 v145, v145, v149
    v_mfma_f32_16x16x32_bf16 v[40:43], v[136:139], a[84:87], v[40:43]
    ds_read_b128 v[136:139], v188 offset:43008
    v_mov_b32 v146, v144
    v_mfma_f32_16x16x32_bf16 v[36:39], v[140:143], a[80:83], v[36:39]
    buffer_load_dwordx4 a[140:143], v188, s[4:7], s34 offen offset:2304 sc1
    v_mfma_f32_16x16x32_bf16 v[44:47], v[140:143], a[84:87], v[44:47]
    s_waitcnt lgkmcnt(5)
    ds_read_b128 v[140:143], v188 offset:43264
    v_mov_b32 v147, v145
    v_mfma_f32_16x16x32_bf16 v[48:51], v[112:115], a[80:83], v[48:51]
    s_add_u32 s34, s54, 36864
    v_permlane16_swap_b32 v144, v146
    v_mfma_f32_16x16x32_bf16 v[56:59], v[112:115], a[84:87], v[56:59]
    ds_read_b128 v[112:115], v188 offset:45056
    v_add_f32 v144, v144, v146
    v_mfma_f32_16x16x32_bf16 v[52:55], v[116:119], a[80:83], v[52:55]
    v_permlane16_swap_b32 v145, v147
    v_mfma_f32_16x16x32_bf16 v[60:63], v[116:119], a[84:87], v[60:63]
    s_waitcnt lgkmcnt(5)
    ds_read_b128 v[116:119], v188 offset:45312
    v_add_f32 v145, v145, v147
    v_mfma_f32_16x16x32_bf16 v[16:19], v[120:123], a[88:91], v[16:19]
    buffer_load_dwordx4 a[144:147], v188, s[4:7], s34 offen offset:0 sc1
    v_mfma_f32_16x16x32_bf16 v[24:27], v[120:123], a[92:95], v[24:27]
    ds_read_b128 v[120:123], v188 offset:47104
    v_mul_f32 v146, -0.0015625, v144
    v_mfma_f32_16x16x32_bf16 v[20:23], v[124:127], a[88:91], v[20:23]
    v_mul_f32 v147, v146, v146
    v_mov_b32 v148, 0.0015625
    v_mfma_f32_16x16x32_bf16 v[28:31], v[124:127], a[92:95], v[28:31]
    s_waitcnt lgkmcnt(5)
    ds_read_b128 v[124:127], v188 offset:47360
    v_fma_f32 v6, v145, v148, -v147
    v_mfma_f32_16x16x32_bf16 v[32:35], v[128:131], a[88:91], v[32:35]
    buffer_load_dwordx4 a[148:151], v188, s[4:7], s34 offen offset:256 sc1
    v_mfma_f32_16x16x32_bf16 v[40:43], v[128:131], a[92:95], v[40:43]
    ds_read_b128 v[128:131], v188 offset:49152
    v_add_f32 v6, 1e-05, v6
    v_mfma_f32_16x16x32_bf16 v[36:39], v[132:135], a[88:91], v[36:39]
    v_rsq_f32 v5, v6
    v_mfma_f32_16x16x32_bf16 v[44:47], v[132:135], a[92:95], v[44:47]
    s_waitcnt lgkmcnt(5)
    ds_read_b128 v[132:135], v188 offset:49408
    v_cvt_pk_bf16_f32 v168, v146, v146
    v_mfma_f32_16x16x32_bf16 v[48:51], v[136:139], a[88:91], v[48:51]
    v_mul_f32 v5, -1.4426950408889634, v5
    v_lshlrev_b32 v148, 16, v168
    v_mfma_f32_16x16x32_bf16 v[56:59], v[136:139], a[92:95], v[56:59]
    ds_read_b128 v[136:139], v188 offset:51200
    v_sub_f32 v148, v146, v148
    v_mfma_f32_16x16x32_bf16 v[52:55], v[140:143], a[88:91], v[52:55]
    buffer_load_dwordx4 a[152:155], v188, s[4:7], s34 offen offset:2048 sc1
    v_mfma_f32_16x16x32_bf16 v[60:63], v[140:143], a[92:95], v[60:63]
    s_waitcnt vmcnt(13) lgkmcnt(5)
    ds_read_b128 v[140:143], v188 offset:51456
    v_mov_b32 v149, 0
    v_mfma_f32_16x16x32_bf16 v[16:19], v[112:115], a[96:99], v[16:19]
    v_cvt_pk_bf16_f32 v169, v148, v149
    v_and_b32 v12, 0x380, v12
    v_mfma_f32_16x16x32_bf16 v[24:27], v[112:115], a[100:103], v[24:27]
    ds_read_b128 v[112:115], v188 offset:53248
    v_mov_b32 v190, v6
    v_mfma_f32_16x16x32_bf16 v[20:23], v[116:119], a[96:99], v[20:23]
    buffer_load_dwordx4 a[156:159], v188, s[4:7], s34 offen offset:2304 sc1
    v_mfma_f32_16x16x32_bf16 v[28:31], v[116:119], a[100:103], v[28:31]
    s_waitcnt lgkmcnt(5)
    ds_read_b128 v[116:119], v188 offset:53504
    v_mov_b32 v189, v5
    v_mfma_f32_16x16x32_bf16 v[32:35], v[120:123], a[96:99], v[32:35]
    s_add_u32 m0, s59, 114688
    v_permlane32_swap_b32 v6, v190
    v_mfma_f32_16x16x32_bf16 v[40:43], v[120:123], a[100:103], v[40:43]
    s_add_u32 s33, s53, 143360
    ds_read_b128 v[120:123], v188 offset:55296
    v_mfma_f32_16x16x32_bf16 v[36:39], v[124:127], a[96:99], v[36:39]
    v_permlane32_swap_b32 v5, v189
    v_mfma_f32_16x16x32_bf16 v[44:47], v[124:127], a[100:103], v[44:47]
    s_waitcnt lgkmcnt(5)
    ds_read_b128 v[124:127], v188 offset:55552
    v_mfma_f32_16x16x32_bf16 v[48:51], v[128:131], a[96:99], v[48:51]
    s_barrier
    buffer_load_dwordx4 v1, s[4:7], s33 offen offset:0 sc1 lds
    v_mfma_f32_16x16x32_bf16 v[56:59], v[128:131], a[100:103], v[56:59]
    ds_read_b128 v[128:131], v188 offset:57344
    v_mfma_f32_16x16x32_bf16 v[52:55], v[132:135], a[96:99], v[52:55]
    v_mfma_f32_16x16x32_bf16 v[60:63], v[132:135], a[100:103], v[60:63]
    s_waitcnt vmcnt(13) lgkmcnt(5)
    ds_read_b128 v[132:135], v188 offset:57600
    v_mfma_f32_16x16x32_bf16 v[16:19], v[136:139], a[104:107], v[16:19]
    buffer_load_dwordx4 v1, s[4:7], s33 offen offset:1024 sc1 lds
    v_mfma_f32_16x16x32_bf16 v[24:27], v[136:139], a[108:111], v[24:27]
    ds_read_b128 v[136:139], v188 offset:59392
    v_mfma_f32_16x16x32_bf16 v[20:23], v[140:143], a[104:107], v[20:23]
    v_mfma_f32_16x16x32_bf16 v[28:31], v[140:143], a[108:111], v[28:31]
k2_main_kernel_pad_P8:
    s_cbranch_execz k2_main_kernel_tr_r13
    s_waitcnt lgkmcnt(5)
    ds_read_b128 v[140:143], v188 offset:59648
    v_mfma_f32_16x16x32_bf16 v[32:35], v[112:115], a[104:107], v[32:35]
    v_mfma_f32_16x16x32_bf16 v[40:43], v[112:115], a[108:111], v[40:43]
    ds_read_b128 v[112:115], v3 offset:24576
    v_mfma_f32_16x16x32_bf16 v[36:39], v[116:119], a[104:107], v[36:39]
    buffer_load_dwordx4 v1, s[4:7], s33 offen offset:2048 sc1 lds
    v_mfma_f32_16x16x32_bf16 v[44:47], v[116:119], a[108:111], v[44:47]
    s_waitcnt lgkmcnt(5)
    ds_read_b128 v[116:119], v188 offset:61440
    v_mfma_f32_16x16x32_bf16 v[48:51], v[120:123], a[104:107], v[48:51]
    v_mfma_f32_16x16x32_bf16 v[56:59], v[120:123], a[108:111], v[56:59]
    ds_read_b128 v[120:123], v188 offset:61696
    v_mfma_f32_16x16x32_bf16 v[52:55], v[124:127], a[104:107], v[52:55]
    buffer_load_dwordx4 v1, s[4:7], s33 offen offset:3072 sc1 lds
    v_mfma_f32_16x16x32_bf16 v[60:63], v[124:127], a[108:111], v[60:63]
    s_waitcnt vmcnt(14) lgkmcnt(5)
    ds_read_b128 v[124:127], v188 offset:63488
    v_mfma_f32_16x16x32_bf16 v[16:19], v[128:131], a[112:115], v[16:19]
    s_add_u32 m0, s59, 118784
    v_mfma_f32_16x16x32_bf16 v[24:27], v[128:131], a[116:119], v[24:27]
    s_add_u32 s33, s53, 147456
    ds_read_b128 v[128:131], v188 offset:63744
    v_mfma_f32_16x16x32_bf16 v[20:23], v[132:135], a[112:115], v[20:23]
    v_mfma_f32_16x16x32_bf16 v[28:31], v[132:135], a[116:119], v[28:31]
    s_waitcnt lgkmcnt(5)
    ds_read_b128 v[132:135], v191 offset:4096
    v_mfma_f32_16x16x32_bf16 v[32:35], v[136:139], a[112:115], v[32:35]
    buffer_load_dwordx4 v1, s[4:7], s33 offen offset:0 sc1 lds
    v_mfma_f32_16x16x32_bf16 v[40:43], v[136:139], a[116:119], v[40:43]
    ds_read_b128 v[136:139], v191 offset:4352
    v_mfma_f32_16x16x32_bf16 v[36:39], v[140:143], a[112:115], v[36:39]
    v_mfma_f32_16x16x32_bf16 v[44:47], v[140:143], a[116:119], v[44:47]
    s_waitcnt lgkmcnt(5)
    ds_read_b128 v[140:143], v191 offset:10240
    v_mfma_f32_16x16x4_4b_bf16 v[16:31], v[112:113], v[168:169], v[16:31]
    s_nop 2
    ds_read_b128 v[112:115], v191 offset:10496
    buffer_load_dwordx4 v1, s[4:7], s33 offen offset:1024 sc1 lds
    v_mfma_f32_16x16x32_bf16 v[48:51], v[116:119], a[112:115], v[48:51]
    v_mfma_f32_16x16x32_bf16 v[56:59], v[116:119], a[116:119], v[56:59]
    s_waitcnt lgkmcnt(5)
    ds_read_b128 v[116:119], v3 offset:25600
    v_mfma_f32_16x16x32_bf16 v[52:55], v[120:123], a[112:115], v[52:55]
    v_mfma_f32_16x16x32_bf16 v[60:63], v[120:123], a[116:119], v[60:63]
    s_waitcnt vmcnt(14)
    ds_read_b128 v[120:123], v191 offset:16384
    v_mfma_f32_16x16x32_bf16 v[16:19], v[124:127], a[120:123], v[16:19]
    buffer_load_dwordx4 v1, s[4:7], s33 offen offset:2048 sc1 lds
    v_mfma_f32_16x16x32_bf16 v[24:27], v[124:127], a[124:127], v[24:27]
    s_waitcnt lgkmcnt(5)
    ds_read_b128 v[124:127], v191 offset:16640
    v_mfma_f32_16x16x32_bf16 v[20:23], v[128:131], a[120:123], v[20:23]
    s_barrier
    v_mfma_f32_16x16x32_bf16 v[28:31], v[128:131], a[124:127], v[28:31]
    s_waitcnt vmcnt(13)
    ds_read_b128 v[128:131], v191 offset:22528
    v_mfma_f32_16x16x32_bf16 v[16:19], v[132:135], a[128:131], v[16:19]
    s_add_u32 m0, s59, 0
    v_mfma_f32_16x16x32_bf16 v[24:27], v[132:135], a[132:135], v[24:27]
    s_waitcnt lgkmcnt(5)
    ds_read_b128 v[132:135], v191 offset:22784
    v_mfma_f32_16x16x32_bf16 v[20:23], v[136:139], a[128:131], v[20:23]
    s_add_u32 s33, s53, 172032
    buffer_load_dwordx4 v1, s[4:7], s33 offen offset:0 sc1 lds
    v_mfma_f32_16x16x32_bf16 v[28:31], v[136:139], a[132:135], v[28:31]
    s_waitcnt vmcnt(12)
    ds_read_b128 v[136:139], v191 offset:0
    v_mfma_f32_16x16x32_bf16 v[16:19], v[140:143], a[136:139], v[16:19]
    v_mfma_f32_16x16x32_bf16 v[24:27], v[140:143], a[140:143], v[24:27]
    s_waitcnt lgkmcnt(5)
    ds_read_b128 v[140:143], v191 offset:256
    v_mfma_f32_16x16x32_bf16 v[20:23], v[112:115], a[136:139], v[20:23]
    buffer_load_dwordx4 v1, s[4:7], s33 offen offset:1024 sc1 lds
    v_mfma_f32_16x16x32_bf16 v[28:31], v[112:115], a[140:143], v[28:31]
    ds_read_b128 v[112:115], v191 offset:6144
    v_mfma_f32_16x16x4_4b_bf16 v[32:47], v[116:117], v[168:169], v[32:47]
    s_nop 2
    s_waitcnt vmcnt(11) lgkmcnt(5)
    ds_read_b128 v[116:119], v191 offset:6400
    v_mfma_f32_16x16x32_bf16 v[16:19], v[120:123], a[144:147], v[16:19]
    v_mfma_f32_16x16x32_bf16 v[24:27], v[120:123], a[148:151], v[24:27]
    ds_read_b128 v[120:123], v191 offset:12288
    v_mfma_f32_16x16x32_bf16 v[20:23], v[124:127], a[144:147], v[20:23]
    buffer_load_dwordx4 v1, s[4:7], s33 offen offset:2048 sc1 lds
    v_mfma_f32_16x16x32_bf16 v[28:31], v[124:127], a[148:151], v[28:31]
    s_waitcnt vmcnt(10) lgkmcnt(5)
    ds_read_b128 v[124:127], v191 offset:12544
    v_mfma_f32_16x16x32_bf16 v[16:19], v[128:131], a[152:155], v[16:19]
    v_mfma_f32_16x16x32_bf16 v[24:27], v[128:131], a[156:159], v[24:27]
    ds_read_b128 v[128:131], v3 offset:26624
    v_mfma_f32_16x16x32_bf16 v[20:23], v[132:135], a[152:155], v[20:23]
    buffer_load_dwordx4 v1, s[4:7], s33 offen offset:3072 sc1 lds
    v_mfma_f32_16x16x32_bf16 v[28:31], v[132:135], a[156:159], v[28:31]
    s_waitcnt lgkmcnt(5)
    ds_read_b128 v[132:135], v191 offset:18432
    v_mfma_f32_16x16x32_bf16 v[32:35], v[136:139], a[120:123], v[32:35]
    v_mul_f32 v156, v16, v5
    v_mul_f32 v157, v17, v5
    v_mfma_f32_16x16x32_bf16 v[40:43], v[136:139], a[124:127], v[40:43]
    s_add_u32 m0, s59, 4096
    ds_read_b128 v[136:139], v191 offset:18688
    v_exp_f32 v156, v156
    v_mfma_f32_16x16x32_bf16 v[36:39], v[140:143], a[120:123], v[36:39]
    s_add_u32 s33, s53, 176128
    v_exp_f32 v157, v157
    v_mfma_f32_16x16x32_bf16 v[44:47], v[140:143], a[124:127], v[44:47]
    s_waitcnt lgkmcnt(5)
    ds_read_b128 v[140:143], v191 offset:24576
    v_mul_f32 v160, v24, v189
    v_mul_f32 v161, v25, v189
    v_mfma_f32_16x16x32_bf16 v[32:35], v[112:115], a[128:131], v[32:35]
    buffer_load_dwordx4 v1, s[4:7], s33 offen offset:0 sc1 lds
    v_mfma_f32_16x16x32_bf16 v[40:43], v[112:115], a[132:135], v[40:43]
    ds_read_b128 v[112:115], v191 offset:24832
    v_exp_f32 v160, v160
    v_mfma_f32_16x16x32_bf16 v[36:39], v[116:119], a[128:131], v[36:39]
    v_exp_f32 v161, v161
    v_mfma_f32_16x16x32_bf16 v[44:47], v[116:119], a[132:135], v[44:47]
    s_waitcnt lgkmcnt(5)
    ds_read_b128 v[116:119], v191 offset:2048
    v_mul_f32 v158, v18, v5
    v_mul_f32 v159, v19, v5
    v_mfma_f32_16x16x32_bf16 v[32:35], v[120:123], a[136:139], v[32:35]
    buffer_load_dwordx4 v1, s[4:7], s33 offen offset:1024 sc1 lds
    v_mfma_f32_16x16x32_bf16 v[40:43], v[120:123], a[140:143], v[40:43]
    ds_read_b128 v[120:123], v191 offset:2304
    v_exp_f32 v158, v158
    v_mfma_f32_16x16x32_bf16 v[36:39], v[124:127], a[136:139], v[36:39]
    v_exp_f32 v159, v159
    v_mfma_f32_16x16x32_bf16 v[44:47], v[124:127], a[140:143], v[44:47]
    s_waitcnt lgkmcnt(5)
    ds_read_b128 v[124:127], v3 offset:27648
    v_mul_f32 v162, v26, v189
    v_mul_f32 v163, v27, v189
    v_mfma_f32_16x16x4_4b_bf16 v[48:63], v[128:129], v[168:169], v[48:63]
    s_nop 2
    ds_read_b128 v[128:131], v191 offset:8192
    v_mul_f32 v16, v16, v20
    v_exp_f32 v162, v162
    v_exp_f32 v163, v163
    v_mfma_f32_16x16x32_bf16 v[32:35], v[132:135], a[144:147], v[32:35]
    buffer_load_dwordx4 v1, s[4:7], s33 offen offset:2048 sc1 lds
    v_mfma_f32_16x16x32_bf16 v[40:43], v[132:135], a[148:151], v[40:43]
    s_waitcnt lgkmcnt(5)
    ds_read_b128 v[132:135], v191 offset:8448
    v_mul_f32 v17, v17, v21
    v_mul_f32 v24, v24, v28
    v_mfma_f32_16x16x32_bf16 v[36:39], v[136:139], a[144:147], v[36:39]
    s_add_u32 m0, s59, 28672
    v_mul_f32 v25, v25, v29
    v_mul_f32 v18, v18, v22
    v_mfma_f32_16x16x32_bf16 v[44:47], v[136:139], a[148:151], v[44:47]
    s_add_u32 s33, s53, 200704
    ds_read_b128 v[136:139], v191 offset:14336
    v_mul_f32 v19, v19, v23
    v_mul_f32 v26, v26, v30
    v_mfma_f32_16x16x32_bf16 v[32:35], v[140:143], a[152:155], v[32:35]
    buffer_load_dwordx4 v1, s[4:7], s33 offen offset:0 sc1 lds
    v_mfma_f32_16x16x32_bf16 v[40:43], v[140:143], a[156:159], v[40:43]
    s_waitcnt lgkmcnt(5)
    ds_read_b128 v[140:143], v191 offset:14592
    v_mul_f32 v27, v27, v31
    v_fma_f32 v156, v156, v6, v6
    v_mfma_f32_16x16x32_bf16 v[36:39], v[112:115], a[152:155], v[36:39]
    v_rcp_f32 v156, v156
    v_mfma_f32_16x16x32_bf16 v[44:47], v[112:115], a[156:159], v[44:47]
    ds_read_b128 v[112:115], v191 offset:20480
    v_fma_f32 v157, v157, v6, v6
    v_fma_f32 v160, v160, v190, v190
    v_mfma_f32_16x16x32_bf16 v[48:51], v[116:119], a[120:123], v[48:51]
    v_rcp_f32 v157, v157
    v_mfma_f32_16x16x32_bf16 v[56:59], v[116:119], a[124:127], v[56:59]
    s_waitcnt lgkmcnt(5)
    ds_read_b128 v[116:119], v191 offset:20736
    v_rcp_f32 v160, v160
    v_mfma_f32_16x16x32_bf16 v[52:55], v[120:123], a[120:123], v[52:55]
    buffer_load_dwordx4 v1, s[4:7], s33 offen offset:1024 sc1 lds
    v_mfma_f32_16x16x32_bf16 v[60:63], v[120:123], a[124:127], v[60:63]
    ds_read_b128 v[120:123], v191 offset:26624
    v_fma_f32 v161, v161, v190, v190
    v_fma_f32 v158, v158, v6, v6
    v_mfma_f32_16x16x4_4b_bf16 v[64:79], v[124:125], v[168:169], 0
    s_waitcnt lgkmcnt(5)
    ds_read_b128 v[124:127], v191 offset:26880
    v_fma_f32 v159, v159, v6, v6
    v_rcp_f32 v161, v161
    v_rcp_f32 v158, v158
    v_mfma_f32_16x16x32_bf16 v[48:51], v[128:131], a[128:131], v[48:51]
    v_rcp_f32 v159, v159
    v_mfma_f32_16x16x32_bf16 v[56:59], v[128:131], a[132:135], v[56:59]
    ds_read_b128 v[128:131], v191 offset:28672
    v_fma_f32 v162, v162, v190, v190
    v_fma_f32 v163, v163, v190, v190
    v_mfma_f32_16x16x32_bf16 v[52:55], v[132:135], a[128:131], v[52:55]
    buffer_load_dwordx4 v1, s[4:7], s33 offen offset:2048 sc1 lds
    v_mfma_f32_16x16x32_bf16 v[60:63], v[132:135], a[132:135], v[60:63]
    s_waitcnt lgkmcnt(5)
    ds_read_b128 v[132:135], v191 offset:28928
    v_rcp_f32 v162, v162
    v_mfma_f32_16x16x32_bf16 v[48:51], v[136:139], a[136:139], v[48:51]
    v_rcp_f32 v163, v163
    v_mfma_f32_16x16x32_bf16 v[56:59], v[136:139], a[140:143], v[56:59]
    ds_read_b128 v[136:139], v191 offset:30720
    v_mul_f32 v16, v16, v156
    v_mul_f32 v17, v17, v157
    v_mfma_f32_16x16x32_bf16 v[52:55], v[140:143], a[136:139], v[52:55]
    buffer_load_dwordx4 v1, s[4:7], s33 offen offset:3072 sc1 lds
    v_mfma_f32_16x16x32_bf16 v[60:63], v[140:143], a[140:143], v[60:63]
    s_waitcnt lgkmcnt(5)
    ds_read_b128 v[140:143], v191 offset:30976
    v_mul_f32 v24, v24, v160
    v_mul_f32 v25, v25, v161
    v_mfma_f32_16x16x32_bf16 v[48:51], v[112:115], a[144:147], v[48:51]
    v_cvt_pk_bf16_f32 v164, v16, v17
    v_cvt_pk_bf16_f32 v166, v24, v25
    v_mfma_f32_16x16x32_bf16 v[56:59], v[112:115], a[148:151], v[56:59]
    s_add_u32 m0, s59, 32768
    ds_read_b128 v[112:115], v191 offset:32768
    v_permlane32_swap_b32 v164, v166
    v_mfma_f32_16x16x32_bf16 v[52:55], v[116:119], a[144:147], v[52:55]
    s_add_u32 s33, s53, 204800
    v_mul_f32 v18, v18, v158
    v_mul_f32 v19, v19, v159
    v_mfma_f32_16x16x32_bf16 v[60:63], v[116:119], a[148:151], v[60:63]
    s_waitcnt lgkmcnt(5)
    ds_read_b128 v[116:119], v191 offset:33024
    v_mul_f32 v26, v26, v162
    v_mul_f32 v27, v27, v163
    v_mfma_f32_16x16x32_bf16 v[48:51], v[120:123], a[152:155], v[48:51]
    buffer_load_dwordx4 v1, s[4:7], s33 offen offset:0 sc1 lds
    v_mfma_f32_16x16x32_bf16 v[56:59], v[120:123], a[156:159], v[56:59]
    ds_read_b128 v[120:123], v191 offset:34816
    v_cvt_pk_bf16_f32 v165, v18, v19
    v_cvt_pk_bf16_f32 v167, v26, v27
    v_mfma_f32_16x16x32_bf16 v[52:55], v[124:127], a[152:155], v[52:55]
    v_mul_f32 v144, v32, v5
    v_mul_f32 v145, v33, v5
    v_mfma_f32_16x16x32_bf16 v[60:63], v[124:127], a[156:159], v[60:63]
    s_waitcnt lgkmcnt(5)
    ds_read_b128 v[124:127], v191 offset:35072
    v_permlane32_swap_b32 v165, v167
    v_mfma_f32_16x16x32_bf16 v[64:67], v[128:131], a[0:3], v[64:67]
    buffer_load_dwordx4 v1, s[4:7], s33 offen offset:1024 sc1 lds
    v_mfma_f32_16x16x32_bf16 v[72:75], v[128:131], a[4:7], v[72:75]
    ds_read_b128 v[128:131], v191 offset:36864
    buffer_store_dwordx4 v[164:167], v4, s[4:7], s60 offen offset:0 sc1
    v_mfma_f32_16x16x32_bf16 v[68:71], v[132:135], a[0:3], v[68:71]
    v_exp_f32 v144, v144
    v_mfma_f32_16x16x32_bf16 v[76:79], v[132:135], a[4:7], v[76:79]
    s_waitcnt lgkmcnt(5)
    ds_read_b128 v[132:135], v191 offset:37120
    v_exp_f32 v145, v145
    v_mfma_f32_16x16x32_bf16 v[64:67], v[136:139], a[8:11], v[64:67]
    v_mul_f32 v148, v40, v189
    v_mul_f32 v149, v41, v189
    v_mfma_f32_16x16x32_bf16 v[72:75], v[136:139], a[12:15], v[72:75]
    ds_read_b128 v[136:139], v191 offset:38912
    v_exp_f32 v148, v148
    v_mfma_f32_16x16x32_bf16 v[68:71], v[140:143], a[8:11], v[68:71]
    v_exp_f32 v149, v149
    v_mfma_f32_16x16x32_bf16 v[76:79], v[140:143], a[12:15], v[76:79]
    s_waitcnt lgkmcnt(5)
    ds_read_b128 v[140:143], v191 offset:39168
    v_mul_f32 v146, v34, v5
    v_mul_f32 v147, v35, v5
    v_mfma_f32_16x16x32_bf16 v[64:67], v[112:115], a[16:19], v[64:67]
    buffer_load_dwordx4 v1, s[4:7], s33 offen offset:2048 sc1 lds
    v_mfma_f32_16x16x32_bf16 v[72:75], v[112:115], a[20:23], v[72:75]
    ds_read_b128 v[112:115], v191 offset:40960
    v_exp_f32 v146, v146
    v_mfma_f32_16x16x32_bf16 v[68:71], v[116:119], a[16:19], v[68:71]
    s_add_u32 s37, s71, 40960
    v_exp_f32 v147, v147
    v_mfma_f32_16x16x32_bf16 v[76:79], v[116:119], a[20:23], v[76:79]
    s_waitcnt lgkmcnt(5)
    ds_read_b128 v[116:119], v191 offset:41216
    v_mul_f32 v150, v42, v189
    v_mul_f32 v151, v43, v189
    v_mfma_f32_16x16x32_bf16 v[64:67], v[120:123], a[24:27], v[64:67]
    buffer_load_dwordx4 v[80:83], v1, s[4:7], s37 offen offset:0 sc1
    v_mfma_f32_16x16x32_bf16 v[72:75], v[120:123], a[28:31], v[72:75]
    ds_read_b128 v[120:123], v191 offset:43008
    v_exp_f32 v150, v150
    v_mfma_f32_16x16x32_bf16 v[68:71], v[124:127], a[24:27], v[68:71]
    v_exp_f32 v151, v151
    v_mfma_f32_16x16x32_bf16 v[76:79], v[124:127], a[28:31], v[76:79]
    s_waitcnt lgkmcnt(5)
    ds_read_b128 v[124:127], v191 offset:43264
    v_mul_f32 v32, v32, v36
    v_mul_f32 v33, v33, v37
    v_mfma_f32_16x16x32_bf16 v[64:67], v[128:131], a[32:35], v[64:67]
    v_mul_f32 v40, v40, v44
    v_mul_f32 v41, v41, v45
    v_mfma_f32_16x16x32_bf16 v[72:75], v[128:131], a[36:39], v[72:75]
    ds_read_b128 v[128:131], v191 offset:45056
    v_mul_f32 v34, v34, v38
    v_mul_f32 v35, v35, v39
    v_mfma_f32_16x16x32_bf16 v[68:71], v[132:135], a[32:35], v[68:71]
    buffer_load_dwordx4 v[84:87], v1, s[4:7], s37 offen offset:1024 sc1
    v_mfma_f32_16x16x32_bf16 v[76:79], v[132:135], a[36:39], v[76:79]
    s_waitcnt lgkmcnt(5)
    ds_read_b128 v[132:135], v191 offset:45312
    v_mul_f32 v42, v42, v46
    v_mul_f32 v43, v43, v47
    v_mfma_f32_16x16x32_bf16 v[64:67], v[136:139], a[40:43], v[64:67]
    v_fma_f32 v144, v144, v6, v6
    v_fma_f32 v145, v145, v6, v6
    v_mfma_f32_16x16x32_bf16 v[72:75], v[136:139], a[44:47], v[72:75]
    ds_read_b128 v[136:139], v191 offset:47104
    v_rcp_f32 v144, v144
    v_mfma_f32_16x16x32_bf16 v[68:71], v[140:143], a[40:43], v[68:71]
    buffer_load_dwordx4 v[88:91], v1, s[4:7], s37 offen offset:2048 sc1
    v_mfma_f32_16x16x32_bf16 v[76:79], v[140:143], a[44:47], v[76:79]
    s_waitcnt vmcnt(18) lgkmcnt(5)
    ds_read_b128 v[140:143], v191 offset:47360
    v_rcp_f32 v145, v145
    v_mfma_f32_16x16x32_bf16 v[64:67], v[112:115], a[48:51], v[64:67]
    s_barrier
    v_fma_f32 v148, v148, v190, v190
    v_fma_f32 v149, v149, v190, v190
    v_mfma_f32_16x16x32_bf16 v[72:75], v[112:115], a[52:55], v[72:75]
    s_add_u32 m0, s59, 57344
    ds_read_b128 v[112:115], v191 offset:49152
    v_rcp_f32 v148, v148
    v_mfma_f32_16x16x32_bf16 v[68:71], v[116:119], a[48:51], v[68:71]
    s_add_u32 s33, s53, 229376
    v_rcp_f32 v149, v149
    v_mfma_f32_16x16x32_bf16 v[76:79], v[116:119], a[52:55], v[76:79]
    s_waitcnt lgkmcnt(5)
    ds_read_b128 v[116:119], v191 offset:49408
    v_fma_f32 v146, v146, v6, v6
    v_fma_f32 v147, v147, v6, v6
    v_mfma_f32_16x16x32_bf16 v[64:67], v[120:123], a[56:59], v[64:67]
    buffer_load_dwordx4 v1, s[4:7], s33 offen offset:0 sc1 lds
    v_mfma_f32_16x16x32_bf16 v[72:75], v[120:123], a[60:63], v[72:75]
    ds_read_b128 v[120:123], v191 offset:51200
    v_rcp_f32 v146, v146
    v_mfma_f32_16x16x32_bf16 v[68:71], v[124:127], a[56:59], v[68:71]
    v_rcp_f32 v147, v147
    v_mfma_f32_16x16x32_bf16 v[76:79], v[124:127], a[60:63], v[76:79]
    s_waitcnt lgkmcnt(5)
    ds_read_b128 v[124:127], v191 offset:51456
    v_fma_f32 v150, v150, v190, v190
    v_fma_f32 v151, v151, v190, v190
    v_mfma_f32_16x16x32_bf16 v[64:67], v[128:131], a[64:67], v[64:67]
    buffer_load_dwordx4 v1, s[4:7], s33 offen offset:1024 sc1 lds
    v_mfma_f32_16x16x32_bf16 v[72:75], v[128:131], a[68:71], v[72:75]
    ds_read_b128 v[128:131], v191 offset:53248
    v_rcp_f32 v150, v150
    v_mfma_f32_16x16x32_bf16 v[68:71], v[132:135], a[64:67], v[68:71]
    v_rcp_f32 v151, v151
    v_mfma_f32_16x16x32_bf16 v[76:79], v[132:135], a[68:71], v[76:79]
    s_waitcnt lgkmcnt(5)
    ds_read_b128 v[132:135], v191 offset:53504
    v_mul_f32 v32, v32, v144
    v_mul_f32 v33, v33, v145
    v_mfma_f32_16x16x32_bf16 v[64:67], v[136:139], a[72:75], v[64:67]
    v_mul_f32 v40, v40, v148
    v_mul_f32 v41, v41, v149
    v_mfma_f32_16x16x32_bf16 v[72:75], v[136:139], a[76:79], v[72:75]
    ds_read_b128 v[136:139], v191 offset:55296
    v_cvt_pk_bf16_f32 v152, v32, v33
    v_cvt_pk_bf16_f32 v154, v40, v41
    v_mfma_f32_16x16x32_bf16 v[68:71], v[140:143], a[72:75], v[68:71]
    buffer_load_dwordx4 v1, s[4:7], s33 offen offset:2048 sc1 lds
    v_mfma_f32_16x16x32_bf16 v[76:79], v[140:143], a[76:79], v[76:79]
    s_waitcnt lgkmcnt(5)
    ds_read_b128 v[140:143], v191 offset:55552
    v_permlane32_swap_b32 v152, v154
    v_mfma_f32_16x16x32_bf16 v[64:67], v[112:115], a[80:83], v[64:67]
    v_mul_f32 v34, v34, v146
    v_mul_f32 v35, v35, v147
    v_mfma_f32_16x16x32_bf16 v[72:75], v[112:115], a[84:87], v[72:75]
    ds_read_b128 v[112:115], v191 offset:57344
    v_mul_f32 v42, v42, v150
    v_mul_f32 v43, v43, v151
    v_mfma_f32_16x16x32_bf16 v[68:71], v[116:119], a[80:83], v[68:71]
    buffer_load_dwordx4 v1, s[4:7], s33 offen offset:3072 sc1 lds
    v_mfma_f32_16x16x32_bf16 v[76:79], v[116:119], a[84:87], v[76:79]
    s_waitcnt lgkmcnt(5)
    ds_read_b128 v[116:119], v191 offset:57600
    v_cvt_pk_bf16_f32 v153, v34, v35
    v_cvt_pk_bf16_f32 v155, v42, v43
    v_mfma_f32_16x16x32_bf16 v[64:67], v[120:123], a[88:91], v[64:67]
    v_mul_f32 v156, v48, v5
    v_mul_f32 v157, v49, v5
    v_mfma_f32_16x16x32_bf16 v[72:75], v[120:123], a[92:95], v[72:75]
    s_add_u32 m0, s59, 61440
    ds_read_b128 v[120:123], v191 offset:59392
    v_permlane32_swap_b32 v153, v155
    v_mfma_f32_16x16x32_bf16 v[68:71], v[124:127], a[88:91], v[68:71]
    s_add_u32 s33, s53, 233472
    buffer_store_dwordx4 v[152:155], v4, s[4:7], s60 offen offset:512 sc1
    v_mfma_f32_16x16x32_bf16 v[76:79], v[124:127], a[92:95], v[76:79]
    s_waitcnt lgkmcnt(5)
    ds_read_b128 v[124:127], v191 offset:59648
    v_exp_f32 v156, v156
    v_mfma_f32_16x16x32_bf16 v[64:67], v[128:131], a[96:99], v[64:67]
    v_exp_f32 v157, v157
    v_mfma_f32_16x16x32_bf16 v[72:75], v[128:131], a[100:103], v[72:75]
    ds_read_b128 v[128:131], v191 offset:61440
    v_mul_f32 v160, v56, v189
    v_mul_f32 v161, v57, v189
    v_mfma_f32_16x16x32_bf16 v[68:71], v[132:135], a[96:99], v[68:71]
    buffer_load_dwordx4 v1, s[4:7], s33 offen offset:0 sc1 lds
    v_mfma_f32_16x16x32_bf16 v[76:79], v[132:135], a[100:103], v[76:79]
    s_waitcnt lgkmcnt(5)
    ds_read_b128 v[132:135], v191 offset:61696
    v_exp_f32 v160, v160
    v_mfma_f32_16x16x32_bf16 v[64:67], v[136:139], a[104:107], v[64:67]
    v_exp_f32 v161, v161
    v_mfma_f32_16x16x32_bf16 v[72:75], v[136:139], a[108:111], v[72:75]
    ds_read_b128 v[136:139], v191 offset:63488
    v_mul_f32 v158, v50, v5
    v_mul_f32 v159, v51, v5
    v_mfma_f32_16x16x32_bf16 v[68:71], v[140:143], a[104:107], v[68:71]
    buffer_load_dwordx4 v1, s[4:7], s33 offen offset:1024 sc1 lds
    v_mfma_f32_16x16x32_bf16 v[76:79], v[140:143], a[108:111], v[76:79]
    s_waitcnt lgkmcnt(5)
    ds_read_b128 v[140:143], v191 offset:63744
    v_exp_f32 v158, v158
    v_mfma_f32_16x16x32_bf16 v[64:67], v[112:115], a[112:115], v[64:67]
    v_exp_f32 v159, v159
    v_mfma_f32_16x16x32_bf16 v[72:75], v[112:115], a[116:119], v[72:75]
    ds_read_b128 v[112:115], v3 offset:28672
    v_mul_f32 v162, v58, v189
    v_mul_f32 v163, v59, v189
    v_mfma_f32_16x16x32_bf16 v[68:71], v[116:119], a[112:115], v[68:71]
    v_exp_f32 v162, v162
    v_mfma_f32_16x16x32_bf16 v[76:79], v[116:119], a[116:119], v[76:79]
    s_waitcnt lgkmcnt(5)
    ds_read_b128 v[116:119], v0 offset:0
    v_exp_f32 v163, v163
    v_mfma_f32_16x16x32_bf16 v[64:67], v[120:123], a[120:123], v[64:67]
    buffer_load_dwordx4 v1, s[4:7], s33 offen offset:2048 sc1 lds
    v_mfma_f32_16x16x32_bf16 v[72:75], v[120:123], a[124:127], v[72:75]
    ds_read_b128 v[120:123], v0 offset:256
    v_mul_f32 v48, v48, v52
    v_mul_f32 v49, v49, v53
    v_mfma_f32_16x16x32_bf16 v[68:71], v[124:127], a[120:123], v[68:71]
    v_mul_f32 v56, v56, v60
    v_mul_f32 v57, v57, v61
    v_mfma_f32_16x16x32_bf16 v[76:79], v[124:127], a[124:127], v[76:79]
    s_waitcnt lgkmcnt(5)
    ds_read_b128 v[124:127], v0 offset:2048
    v_mul_f32 v50, v50, v54
    v_mul_f32 v51, v51, v55
    v_mfma_f32_16x16x32_bf16 v[64:67], v[128:131], a[128:131], v[64:67]
    buffer_load_dwordx4 v[92:95], v1, s[4:7], s37 offen offset:3072 sc1
    v_mfma_f32_16x16x32_bf16 v[72:75], v[128:131], a[132:135], v[72:75]
    ds_read_b128 v[128:131], v0 offset:2304
    v_mul_f32 v58, v58, v62
    v_mul_f32 v59, v59, v63
    v_mfma_f32_16x16x32_bf16 v[68:71], v[132:135], a[128:131], v[68:71]
    v_fma_f32 v156, v156, v6, v6
    v_fma_f32 v157, v157, v6, v6
    v_mfma_f32_16x16x32_bf16 v[76:79], v[132:135], a[132:135], v[76:79]
    s_waitcnt lgkmcnt(5)
    ds_read_b128 v[132:135], v0 offset:4096
    v_rcp_f32 v156, v156
    v_mfma_f32_16x16x32_bf16 v[64:67], v[136:139], a[136:139], v[64:67]
    s_add_u32 s37, s71, 45056
    v_rcp_f32 v157, v157
    v_mfma_f32_16x16x32_bf16 v[72:75], v[136:139], a[140:143], v[72:75]
    ds_read_b128 v[136:139], v0 offset:4352
    v_fma_f32 v160, v160, v190, v190
    v_fma_f32 v161, v161, v190, v190
    v_mfma_f32_16x16x32_bf16 v[68:71], v[140:143], a[136:139], v[68:71]
    buffer_load_dwordx4 v[96:99], v1, s[4:7], s37 offen offset:0 sc1
    v_mfma_f32_16x16x32_bf16 v[76:79], v[140:143], a[140:143], v[76:79]
    s_waitcnt lgkmcnt(5)
    ds_read_b128 v[140:143], v0 offset:6144
    v_rcp_f32 v160, v160
    v_mfma_f32_16x16x4_4b_bf16 v[16:31], v[112:113], v[168:169], 0
    ds_read_b128 v[112:115], v0 offset:6400
    v_fma_f32 v158, v158, v6, v6
    v_rcp_f32 v161, v161
    v_rcp_f32 v158, v158
    v_mfma_f32_16x16x32_bf16 v[64:67], v[116:119], a[144:147], v[64:67]
    v_fma_f32 v159, v159, v6, v6
    v_fma_f32 v162, v162, v190, v190
    v_mfma_f32_16x16x32_bf16 v[72:75], v[116:119], a[148:151], v[72:75]
    s_waitcnt lgkmcnt(5)
    ds_read_b128 v[116:119], v0 offset:8192
    v_rcp_f32 v159, v159
    v_mfma_f32_16x16x32_bf16 v[68:71], v[120:123], a[144:147], v[68:71]
    buffer_load_dwordx4 v[100:103], v1, s[4:7], s37 offen offset:1024 sc1
    v_mfma_f32_16x16x32_bf16 v[76:79], v[120:123], a[148:151], v[76:79]
    ds_read_b128 v[120:123], v0 offset:8448
    v_rcp_f32 v162, v162
    v_mfma_f32_16x16x32_bf16 v[64:67], v[124:127], a[152:155], v[64:67]
    v_fma_f32 v163, v163, v190, v190
    v_mul_f32 v48, v48, v156
    v_mfma_f32_16x16x32_bf16 v[72:75], v[124:127], a[156:159], v[72:75]
    s_waitcnt lgkmcnt(5)
    ds_read_b128 v[124:127], v0 offset:10240
    v_rcp_f32 v163, v163
    v_mfma_f32_16x16x32_bf16 v[68:71], v[128:131], a[152:155], v[68:71]
    buffer_load_dwordx4 v[104:107], v1, s[4:7], s37 offen offset:2048 sc1
    v_mfma_f32_16x16x32_bf16 v[76:79], v[128:131], a[156:159], v[76:79]
    s_waitcnt vmcnt(23)
    ds_read_b128 v[128:131], v0 offset:10496
    v_mul_f32 v49, v49, v157
    v_mul_f32 v56, v56, v160
    v_mfma_f32_16x16x32_bf16 v[16:19], v[132:135], a[0:3], v[16:19]
    s_barrier
    v_mul_f32 v57, v57, v161
    v_cvt_pk_bf16_f32 v164, v48, v49
    v_mfma_f32_16x16x32_bf16 v[24:27], v[132:135], a[4:7], v[24:27]
    s_waitcnt lgkmcnt(5)
    ds_read_b128 v[132:135], v188 offset:0
    v_cvt_pk_bf16_f32 v166, v56, v57
    v_mul_f32 v50, v50, v158
    v_mfma_f32_16x16x32_bf16 v[20:23], v[136:139], a[0:3], v[20:23]
    s_add_u32 m0, s59, 86016
    v_permlane32_swap_b32 v164, v166
    v_mfma_f32_16x16x32_bf16 v[28:31], v[136:139], a[4:7], v[28:31]
    s_add_u32 s33, s53, 258048
    ds_read_b128 v[136:139], v188 offset:256
    v_mul_f32 v51, v51, v159
    v_mul_f32 v58, v58, v162
    v_mfma_f32_16x16x32_bf16 v[16:19], v[140:143], a[8:11], v[16:19]
    buffer_load_dwordx4 v1, s[4:7], s33 offen offset:0 sc1 lds
    v_mfma_f32_16x16x32_bf16 v[24:27], v[140:143], a[12:15], v[24:27]
    s_waitcnt lgkmcnt(5)
    ds_read_b128 v[140:143], v188 offset:2048
    v_mul_f32 v59, v59, v163
    v_cvt_pk_bf16_f32 v165, v50, v51
    v_mfma_f32_16x16x32_bf16 v[20:23], v[112:115], a[8:11], v[20:23]
    v_cvt_pk_bf16_f32 v167, v58, v59
    v_mul_f32 v144, v64, v5
    v_mfma_f32_16x16x32_bf16 v[28:31], v[112:115], a[12:15], v[28:31]
    ds_read_b128 v[112:115], v188 offset:2304
    v_permlane32_swap_b32 v165, v167
    v_mfma_f32_16x16x32_bf16 v[16:19], v[116:119], a[16:19], v[16:19]
    buffer_load_dwordx4 v1, s[4:7], s33 offen offset:1024 sc1 lds
    v_mfma_f32_16x16x32_bf16 v[24:27], v[116:119], a[20:23], v[24:27]
    s_waitcnt lgkmcnt(5)
    ds_read_b128 v[116:119], v188 offset:4096
    buffer_store_dwordx4 v[164:167], v4, s[4:7], s60 offen offset:1024 sc1
    v_mfma_f32_16x16x32_bf16 v[20:23], v[120:123], a[16:19], v[20:23]
    v_exp_f32 v144, v144
    v_mfma_f32_16x16x32_bf16 v[28:31], v[120:123], a[20:23], v[28:31]
    ds_read_b128 v[120:123], v188 offset:4352
    v_mul_f32 v145, v65, v5
    v_mul_f32 v148, v72, v189
    v_mfma_f32_16x16x32_bf16 v[16:19], v[124:127], a[24:27], v[16:19]
    v_exp_f32 v145, v145
    v_mfma_f32_16x16x32_bf16 v[24:27], v[124:127], a[28:31], v[24:27]
    s_waitcnt lgkmcnt(5)
    ds_read_b128 v[124:127], v188 offset:6144
    v_exp_f32 v148, v148
    v_mfma_f32_16x16x32_bf16 v[20:23], v[128:131], a[24:27], v[20:23]
    v_mul_f32 v149, v73, v189
    v_mul_f32 v146, v66, v5
    v_mfma_f32_16x16x32_bf16 v[28:31], v[128:131], a[28:31], v[28:31]
    ds_read_b128 v[128:131], v188 offset:6400
    v_exp_f32 v149, v149
    v_mfma_f32_16x16x32_bf16 v[16:19], v[132:135], a[32:35], v[16:19]
    buffer_load_dwordx4 v1, s[4:7], s33 offen offset:2048 sc1 lds
    v_mfma_f32_16x16x32_bf16 v[24:27], v[132:135], a[36:39], v[24:27]
    s_waitcnt lgkmcnt(5)
    ds_read_b128 v[132:135], v188 offset:8192
    v_exp_f32 v146, v146
    v_mfma_f32_16x16x32_bf16 v[20:23], v[136:139], a[32:35], v[20:23]
    v_mul_f32 v147, v67, v5
    v_mul_f32 v150, v74, v189
    v_mfma_f32_16x16x32_bf16 v[28:31], v[136:139], a[36:39], v[28:31]
    ds_read_b128 v[136:139], v188 offset:8448
    v_exp_f32 v147, v147
    v_mfma_f32_16x16x32_bf16 v[16:19], v[140:143], a[40:43], v[16:19]
    buffer_load_dwordx4 v1, s[4:7], s33 offen offset:3072 sc1 lds
    v_mfma_f32_16x16x32_bf16 v[24:27], v[140:143], a[44:47], v[24:27]
    s_waitcnt lgkmcnt(5)
    ds_read_b128 v[140:143], v188 offset:10240
    v_exp_f32 v150, v150
    v_mfma_f32_16x16x32_bf16 v[20:23], v[112:115], a[40:43], v[20:23]
    v_mul_f32 v151, v75, v189
    v_mul_f32 v64, v64, v68
    v_mfma_f32_16x16x32_bf16 v[28:31], v[112:115], a[44:47], v[28:31]
    s_add_u32 m0, s59, 90112
    ds_read_b128 v[112:115], v188 offset:10496
    v_exp_f32 v151, v151
    v_mfma_f32_16x16x32_bf16 v[16:19], v[116:119], a[48:51], v[16:19]
    s_add_u32 s33, s53, 262144
    v_mul_f32 v65, v65, v69
    v_mul_f32 v72, v72, v76
    v_mfma_f32_16x16x32_bf16 v[24:27], v[116:119], a[52:55], v[24:27]
    s_waitcnt lgkmcnt(5)
    ds_read_b128 v[116:119], v188 offset:12288
    v_mul_f32 v73, v73, v77
    v_mul_f32 v66, v66, v70
    v_mfma_f32_16x16x32_bf16 v[20:23], v[120:123], a[48:51], v[20:23]
    buffer_load_dwordx4 v1, s[4:7], s33 offen offset:0 sc1 lds
    v_mfma_f32_16x16x32_bf16 v[28:31], v[120:123], a[52:55], v[28:31]
    ds_read_b128 v[120:123], v188 offset:12544
    v_mul_f32 v67, v67, v71
    v_mul_f32 v74, v74, v78
    v_mfma_f32_16x16x32_bf16 v[16:19], v[124:127], a[56:59], v[16:19]
    v_mul_f32 v75, v75, v79
    v_fma_f32 v144, v144, v6, v6
    v_mfma_f32_16x16x32_bf16 v[24:27], v[124:127], a[60:63], v[24:27]
    s_waitcnt lgkmcnt(5)
    ds_read_b128 v[124:127], v188 offset:14336
    v_rcp_f32 v144, v144
    v_mfma_f32_16x16x32_bf16 v[20:23], v[128:131], a[56:59], v[20:23]
    buffer_load_dwordx4 v1, s[4:7], s33 offen offset:1024 sc1 lds
    v_mfma_f32_16x16x32_bf16 v[28:31], v[128:131], a[60:63], v[28:31]
    ds_read_b128 v[128:131], v188 offset:14592
    v_fma_f32 v145, v145, v6, v6
    v_fma_f32 v148, v148, v190, v190
    v_mfma_f32_16x16x32_bf16 v[16:19], v[132:135], a[64:67], v[16:19]
    v_rcp_f32 v145, v145
    v_mfma_f32_16x16x32_bf16 v[24:27], v[132:135], a[68:71], v[24:27]
    s_waitcnt lgkmcnt(5)
    ds_read_b128 v[132:135], v188 offset:16384
    v_rcp_f32 v148, v148
    v_mfma_f32_16x16x32_bf16 v[20:23], v[136:139], a[64:67], v[20:23]
k2_main_kernel_pad_P9:
    s_cbranch_execz k2_main_kernel_tr_r13
    v_fma_f32 v149, v149, v190, v190
    v_fma_f32 v146, v146, v6, v6
    v_mfma_f32_16x16x32_bf16 v[28:31], v[136:139], a[68:71], v[28:31]
    ds_read_b128 v[136:139], v188 offset:16640
    v_rcp_f32 v149, v149
    v_mfma_f32_16x16x32_bf16 v[16:19], v[140:143], a[72:75], v[16:19]
    buffer_load_dwordx4 v1, s[4:7], s33 offen offset:2048 sc1 lds
    v_mfma_f32_16x16x32_bf16 v[24:27], v[140:143], a[76:79], v[24:27]
    s_waitcnt lgkmcnt(5)
    ds_read_b128 v[140:143], v188 offset:18432
    v_rcp_f32 v146, v146
    v_mfma_f32_16x16x32_bf16 v[20:23], v[112:115], a[72:75], v[20:23]
    v_fma_f32 v147, v147, v6, v6
    v_fma_f32 v150, v150, v190, v190
    v_mfma_f32_16x16x32_bf16 v[28:31], v[112:115], a[76:79], v[28:31]
    ds_read_b128 v[112:115], v188 offset:18688
    v_rcp_f32 v147, v147
    v_mfma_f32_16x16x32_bf16 v[16:19], v[116:119], a[80:83], v[16:19]
    buffer_load_dwordx4 v[108:111], v1, s[4:7], s37 offen offset:3072 sc1
    v_mfma_f32_16x16x32_bf16 v[24:27], v[116:119], a[84:87], v[24:27]
    s_waitcnt lgkmcnt(5)
    ds_read_b128 v[116:119], v188 offset:20480
    v_rcp_f32 v150, v150
    v_mfma_f32_16x16x32_bf16 v[20:23], v[120:123], a[80:83], v[20:23]
    v_fma_f32 v151, v151, v190, v190
    v_mul_f32 v64, v64, v144
    v_mfma_f32_16x16x32_bf16 v[28:31], v[120:123], a[84:87], v[28:31]
    s_add_u32 s37, s71, 49152
    ds_read_b128 v[120:123], v188 offset:20736
    v_mul_f32 v65, v65, v145
    v_mfma_f32_16x16x32_bf16 v[16:19], v[124:127], a[88:91], v[16:19]
    v_rcp_f32 v151, v151
    v_mfma_f32_16x16x32_bf16 v[24:27], v[124:127], a[92:95], v[24:27]
    s_waitcnt lgkmcnt(5)
    ds_read_b128 v[124:127], v188 offset:22528
    v_mul_f32 v72, v72, v148
    v_mfma_f32_16x16x32_bf16 v[20:23], v[128:131], a[88:91], v[20:23]
    buffer_load_dwordx4 v[48:51], v1, s[4:7], s37 offen offset:0 sc1
    v_mfma_f32_16x16x32_bf16 v[28:31], v[128:131], a[92:95], v[28:31]
    ds_read_b128 v[128:131], v188 offset:22784
    v_mul_f32 v73, v73, v149
    v_mfma_f32_16x16x32_bf16 v[16:19], v[132:135], a[96:99], v[16:19]
    v_cvt_pk_bf16_f32 v152, v64, v65
    v_cvt_pk_bf16_f32 v154, v72, v73
    v_mfma_f32_16x16x32_bf16 v[24:27], v[132:135], a[100:103], v[24:27]
    s_waitcnt lgkmcnt(5)
    ds_read_b128 v[132:135], v188 offset:24576
    v_mul_f32 v66, v66, v146
    v_mfma_f32_16x16x32_bf16 v[20:23], v[136:139], a[96:99], v[20:23]
    v_permlane32_swap_b32 v152, v154
    v_mfma_f32_16x16x32_bf16 v[28:31], v[136:139], a[100:103], v[28:31]
    ds_read_b128 v[136:139], v188 offset:24832
    v_mul_f32 v67, v67, v147
    v_mfma_f32_16x16x32_bf16 v[16:19], v[140:143], a[104:107], v[16:19]
    buffer_load_dwordx4 v[52:55], v1, s[4:7], s37 offen offset:1024 sc1
    v_mfma_f32_16x16x32_bf16 v[24:27], v[140:143], a[108:111], v[24:27]
    s_waitcnt lgkmcnt(5)
    ds_read_b128 v[140:143], v188 offset:26624
    v_mul_f32 v74, v74, v150
    v_mfma_f32_16x16x32_bf16 v[20:23], v[112:115], a[104:107], v[20:23]
    v_mul_f32 v75, v75, v151
    v_cvt_pk_bf16_f32 v153, v66, v67
    v_mfma_f32_16x16x32_bf16 v[28:31], v[112:115], a[108:111], v[28:31]
    ds_read_b128 v[112:115], v188 offset:26880
    v_cvt_pk_bf16_f32 v155, v74, v75
    v_mfma_f32_16x16x32_bf16 v[16:19], v[116:119], a[112:115], v[16:19]
    v_mfma_f32_16x16x32_bf16 v[24:27], v[116:119], a[116:119], v[24:27]
    s_waitcnt vmcnt(26) lgkmcnt(5)
    ds_read_b128 v[116:119], v3 offset:29696
    v_mfma_f32_16x16x32_bf16 v[20:23], v[120:123], a[112:115], v[20:23]
    s_barrier
    buffer_load_dwordx4 v[56:59], v1, s[4:7], s37 offen offset:2048 sc1
    v_mfma_f32_16x16x32_bf16 v[28:31], v[120:123], a[116:119], v[28:31]
    ds_read_b128 v[120:123], v188 offset:28672
    v_permlane32_swap_b32 v153, v155
    v_mfma_f32_16x16x32_bf16 v[16:19], v[124:127], a[120:123], v[16:19]
    s_add_u32 m0, s64, 114688
    buffer_store_dwordx4 v[152:155], v4, s[4:7], s60 offen offset:1536 sc1
    v_mfma_f32_16x16x32_bf16 v[24:27], v[124:127], a[124:127], v[24:27]
    s_waitcnt lgkmcnt(5)
    ds_read_b128 v[124:127], v188 offset:28928
    v_mfma_f32_16x16x32_bf16 v[20:23], v[128:131], a[120:123], v[20:23]
    s_add_u32 s33, s71, 61440
    v_mfma_f32_16x16x32_bf16 v[28:31], v[128:131], a[124:127], v[28:31]
    ds_read_b128 v[128:131], v188 offset:30720
    v_mfma_f32_16x16x32_bf16 v[16:19], v[132:135], a[128:131], v[16:19]
    v_mfma_f32_16x16x32_bf16 v[24:27], v[132:135], a[132:135], v[24:27]
    s_waitcnt lgkmcnt(5)
    ds_read_b128 v[132:135], v188 offset:30976
    v_mfma_f32_16x16x32_bf16 v[20:23], v[136:139], a[128:131], v[20:23]
    buffer_load_dwordx4 v1, s[4:7], s33 offen offset:0 sc1 lds
    v_mfma_f32_16x16x32_bf16 v[28:31], v[136:139], a[132:135], v[28:31]
    ds_read_b128 v[136:139], v188 offset:32768
    v_mfma_f32_16x16x32_bf16 v[16:19], v[140:143], a[136:139], v[16:19]
    v_mfma_f32_16x16x32_bf16 v[24:27], v[140:143], a[140:143], v[24:27]
    s_waitcnt lgkmcnt(5)
    ds_read_b128 v[140:143], v188 offset:33024
    v_mfma_f32_16x16x32_bf16 v[20:23], v[112:115], a[136:139], v[20:23]
    v_mfma_f32_16x16x32_bf16 v[28:31], v[112:115], a[140:143], v[28:31]
    ds_read_b128 v[112:115], v188 offset:34816
    v_mfma_f32_16x16x4_4b_bf16 v[32:47], v[116:117], v[168:169], 0
    s_waitcnt lgkmcnt(5)
    ds_read_b128 v[116:119], v188 offset:35072
    buffer_load_dwordx4 v1, s[4:7], s33 offen offset:1024 sc1 lds
    v_mfma_f32_16x16x32_bf16 v[16:19], v[120:123], a[144:147], v[16:19]
    v_mfma_f32_16x16x32_bf16 v[24:27], v[120:123], a[148:151], v[24:27]
    ds_read_b128 v[120:123], v188 offset:36864
    v_mfma_f32_16x16x32_bf16 v[20:23], v[124:127], a[144:147], v[20:23]
    v_mfma_f32_16x16x32_bf16 v[28:31], v[124:127], a[148:151], v[28:31]
    s_waitcnt lgkmcnt(5)
    ds_read_b128 v[124:127], v188 offset:37120
    v_mfma_f32_16x16x32_bf16 v[16:19], v[128:131], a[152:155], v[16:19]
    buffer_load_dwordx4 v1, s[4:7], s33 offen offset:2048 sc1 lds
    v_mfma_f32_16x16x32_bf16 v[24:27], v[128:131], a[156:159], v[24:27]
    ds_read_b128 v[128:131], v188 offset:38912
    v_mfma_f32_16x16x32_bf16 v[20:23], v[132:135], a[152:155], v[20:23]
    v_mfma_f32_16x16x32_bf16 v[28:31], v[132:135], a[156:159], v[28:31]
    s_waitcnt lgkmcnt(5)
    ds_read_b128 v[132:135], v188 offset:39168
    v_mfma_f32_16x16x32_bf16 v[32:35], v[136:139], a[0:3], v[32:35]
    v_mul_f32 v156, v16, v5
    v_mul_f32 v157, v17, v5
    v_mfma_f32_16x16x32_bf16 v[40:43], v[136:139], a[4:7], v[40:43]
    ds_read_b128 v[136:139], v188 offset:40960
    v_exp_f32 v156, v156
    v_mfma_f32_16x16x32_bf16 v[36:39], v[140:143], a[0:3], v[36:39]
    buffer_load_dwordx4 v1, s[4:7], s33 offen offset:3072 sc1 lds
    v_mfma_f32_16x16x32_bf16 v[44:47], v[140:143], a[4:7], v[44:47]
    s_waitcnt lgkmcnt(5)
    ds_read_b128 v[140:143], v188 offset:41216
    v_exp_f32 v157, v157
    v_mfma_f32_16x16x32_bf16 v[32:35], v[112:115], a[8:11], v[32:35]
    s_add_u32 m0, s64, 118784
    v_mul_f32 v160, v24, v189
    v_mul_f32 v161, v25, v189
    v_mfma_f32_16x16x32_bf16 v[40:43], v[112:115], a[12:15], v[40:43]
    s_add_u32 s33, s71, 65536
    ds_read_b128 v[112:115], v188 offset:43008
    v_exp_f32 v160, v160
    v_mfma_f32_16x16x32_bf16 v[36:39], v[116:119], a[8:11], v[36:39]
    buffer_load_dwordx4 v1, s[4:7], s33 offen offset:0 sc1 lds
    v_mfma_f32_16x16x32_bf16 v[44:47], v[116:119], a[12:15], v[44:47]
    s_waitcnt lgkmcnt(5)
    ds_read_b128 v[116:119], v188 offset:43264
    v_exp_f32 v161, v161
    v_mfma_f32_16x16x32_bf16 v[32:35], v[120:123], a[16:19], v[32:35]
    v_mul_f32 v158, v18, v5
    v_mul_f32 v159, v19, v5
    v_mfma_f32_16x16x32_bf16 v[40:43], v[120:123], a[20:23], v[40:43]
    ds_read_b128 v[120:123], v188 offset:45056
    v_exp_f32 v158, v158
    v_mfma_f32_16x16x32_bf16 v[36:39], v[124:127], a[16:19], v[36:39]
    v_exp_f32 v159, v159
    v_mfma_f32_16x16x32_bf16 v[44:47], v[124:127], a[20:23], v[44:47]
    s_waitcnt lgkmcnt(5)
    ds_read_b128 v[124:127], v188 offset:45312
    v_mul_f32 v162, v26, v189
    v_mul_f32 v163, v27, v189
    v_mfma_f32_16x16x32_bf16 v[32:35], v[128:131], a[24:27], v[32:35]
    buffer_load_dwordx4 v1, s[4:7], s33 offen offset:1024 sc1 lds
    v_mfma_f32_16x16x32_bf16 v[40:43], v[128:131], a[28:31], v[40:43]
    ds_read_b128 v[128:131], v188 offset:47104
    v_exp_f32 v162, v162
    v_mfma_f32_16x16x32_bf16 v[36:39], v[132:135], a[24:27], v[36:39]
    v_exp_f32 v163, v163
    v_mfma_f32_16x16x32_bf16 v[44:47], v[132:135], a[28:31], v[44:47]
    s_waitcnt lgkmcnt(5)
    ds_read_b128 v[132:135], v188 offset:47360
    v_mul_f32 v16, v16, v20
    v_mul_f32 v17, v17, v21
    v_mfma_f32_16x16x32_bf16 v[32:35], v[136:139], a[32:35], v[32:35]
    buffer_load_dwordx4 v1, s[4:7], s33 offen offset:2048 sc1 lds
    v_mfma_f32_16x16x32_bf16 v[40:43], v[136:139], a[36:39], v[40:43]
    ds_read_b128 v[136:139], v188 offset:49152
    v_mul_f32 v24, v24, v28
    v_mul_f32 v25, v25, v29
    v_mfma_f32_16x16x32_bf16 v[36:39], v[140:143], a[32:35], v[36:39]
    v_mul_f32 v18, v18, v22
    v_mul_f32 v19, v19, v23
    v_mfma_f32_16x16x32_bf16 v[44:47], v[140:143], a[36:39], v[44:47]
    s_waitcnt lgkmcnt(5)
    ds_read_b128 v[140:143], v188 offset:49408
    v_mul_f32 v26, v26, v30
    v_mul_f32 v27, v27, v31
    v_mfma_f32_16x16x32_bf16 v[32:35], v[112:115], a[40:43], v[32:35]
    v_fma_f32 v156, v156, v6, v6
    v_fma_f32 v157, v157, v6, v6
    v_mfma_f32_16x16x32_bf16 v[40:43], v[112:115], a[44:47], v[40:43]
    ds_read_b128 v[112:115], v188 offset:51200
    v_rcp_f32 v156, v156
    v_mfma_f32_16x16x32_bf16 v[36:39], v[116:119], a[40:43], v[36:39]
    s_waitcnt vmcnt(7)
    buffer_store_dword v7, off, s[4:7], s69 sc1
    v_mfma_f32_16x16x32_bf16 v[44:47], v[116:119], a[44:47], v[44:47]
    s_waitcnt lgkmcnt(5)
    ds_read_b128 v[116:119], v188 offset:51456
    v_rcp_f32 v157, v157
    v_mfma_f32_16x16x32_bf16 v[32:35], v[120:123], a[48:51], v[32:35]
    buffer_load_dwordx4 v1, s[4:7], s33 offen offset:3072 sc1 lds
    v_mfma_f32_16x16x32_bf16 v[40:43], v[120:123], a[52:55], v[40:43]
    ds_read_b128 v[120:123], v188 offset:53248
    v_add_u32 v7, 1, v7
    v_fma_f32 v160, v160, v190, v190
    v_mfma_f32_16x16x32_bf16 v[36:39], v[124:127], a[48:51], v[36:39]
    s_add_u32 m0, s64, 122880
    v_rcp_f32 v160, v160
    v_mfma_f32_16x16x32_bf16 v[44:47], v[124:127], a[52:55], v[44:47]
    s_waitcnt lgkmcnt(5)
    ds_read_b128 v[124:127], v188 offset:53504
    v_fma_f32 v161, v161, v190, v190
    v_fma_f32 v158, v158, v6, v6
    v_mfma_f32_16x16x32_bf16 v[32:35], v[128:131], a[56:59], v[32:35]
    s_add_u32 s33, s71, 69632
    buffer_load_dwordx4 v1, s[4:7], s33 offen offset:0 sc1 lds
    v_mfma_f32_16x16x32_bf16 v[40:43], v[128:131], a[60:63], v[40:43]
    ds_read_b128 v[128:131], v188 offset:55296
    v_rcp_f32 v161, v161
    v_mfma_f32_16x16x32_bf16 v[36:39], v[132:135], a[56:59], v[36:39]
    v_rcp_f32 v158, v158
    v_mfma_f32_16x16x32_bf16 v[44:47], v[132:135], a[60:63], v[44:47]
    s_waitcnt lgkmcnt(5)
    ds_read_b128 v[132:135], v188 offset:55552
    v_fma_f32 v159, v159, v6, v6
    v_mfma_f32_16x16x32_bf16 v[32:35], v[136:139], a[64:67], v[32:35]
    s_barrier
    v_rcp_f32 v159, v159
    v_mfma_f32_16x16x32_bf16 v[40:43], v[136:139], a[68:71], v[40:43]
    ds_read_b128 v[136:139], v188 offset:57344
    v_fma_f32 v162, v162, v190, v190
    v_mfma_f32_16x16x32_bf16 v[36:39], v[140:143], a[64:67], v[36:39]
    buffer_load_dwordx4 v1, s[4:7], s33 offen offset:1024 sc1 lds
    v_mfma_f32_16x16x32_bf16 v[44:47], v[140:143], a[68:71], v[44:47]
    s_waitcnt lgkmcnt(5)
    ds_read_b128 v[140:143], v188 offset:57600
    v_rcp_f32 v162, v162
    v_mfma_f32_16x16x32_bf16 v[32:35], v[112:115], a[72:75], v[32:35]
    v_fma_f32 v163, v163, v190, v190
    v_mul_f32 v16, v16, v156
    v_mfma_f32_16x16x32_bf16 v[40:43], v[112:115], a[76:79], v[40:43]
    ds_read_b128 v[112:115], v188 offset:59392
    v_mul_f32 v17, v17, v157
    v_mfma_f32_16x16x32_bf16 v[36:39], v[116:119], a[72:75], v[36:39]
    v_rcp_f32 v163, v163
    v_mfma_f32_16x16x32_bf16 v[44:47], v[116:119], a[76:79], v[44:47]
    s_waitcnt lgkmcnt(5)
    ds_read_b128 v[116:119], v188 offset:59648
    v_mul_f32 v24, v24, v160
    v_mfma_f32_16x16x32_bf16 v[32:35], v[120:123], a[80:83], v[32:35]
    buffer_load_dwordx4 v[60:63], v1, s[4:7], s37 offen offset:3072 sc1
    v_mfma_f32_16x16x32_bf16 v[40:43], v[120:123], a[84:87], v[40:43]
    ds_read_b128 v[120:123], v188 offset:61440
    v_mul_f32 v25, v25, v161
    v_mfma_f32_16x16x32_bf16 v[36:39], v[124:127], a[80:83], v[36:39]
    s_add_u32 s37, s71, 53248
    v_cvt_pk_bf16_f32 v164, v16, v17
    v_cvt_pk_bf16_f32 v166, v24, v25
    v_mfma_f32_16x16x32_bf16 v[44:47], v[124:127], a[84:87], v[44:47]
    s_waitcnt lgkmcnt(5)
    ds_read_b128 v[124:127], v188 offset:61696
    v_mul_f32 v18, v18, v158
    v_mfma_f32_16x16x32_bf16 v[32:35], v[128:131], a[88:91], v[32:35]
    v_permlane32_swap_b32 v164, v166
    v_mfma_f32_16x16x32_bf16 v[40:43], v[128:131], a[92:95], v[40:43]
    ds_read_b128 v[128:131], v188 offset:63488
    v_mul_f32 v19, v19, v159
    v_mfma_f32_16x16x32_bf16 v[36:39], v[132:135], a[88:91], v[36:39]
    buffer_load_dwordx4 v[64:67], v1, s[4:7], s37 offen offset:0 sc1
    v_mfma_f32_16x16x32_bf16 v[44:47], v[132:135], a[92:95], v[44:47]
    s_waitcnt lgkmcnt(5)
    ds_read_b128 v[132:135], v188 offset:63744
    v_mul_f32 v26, v26, v162
    v_mfma_f32_16x16x32_bf16 v[32:35], v[136:139], a[96:99], v[32:35]
    v_mul_f32 v27, v27, v163
    v_cvt_pk_bf16_f32 v165, v18, v19
    v_mfma_f32_16x16x32_bf16 v[40:43], v[136:139], a[100:103], v[40:43]
    ds_read_b128 v[136:139], v191 offset:0
    v_cvt_pk_bf16_f32 v167, v26, v27
    v_mfma_f32_16x16x32_bf16 v[36:39], v[140:143], a[96:99], v[36:39]
    v_mfma_f32_16x16x32_bf16 v[44:47], v[140:143], a[100:103], v[44:47]
    s_waitcnt lgkmcnt(5)
    ds_read_b128 v[140:143], v191 offset:256
    v_mfma_f32_16x16x32_bf16 v[32:35], v[112:115], a[104:107], v[32:35]
    buffer_load_dwordx4 v[68:71], v1, s[4:7], s37 offen offset:1024 sc1
    v_mfma_f32_16x16x32_bf16 v[40:43], v[112:115], a[108:111], v[40:43]
    ds_read_b128 v[112:115], v191 offset:2048
    v_permlane32_swap_b32 v165, v167
    v_mfma_f32_16x16x32_bf16 v[36:39], v[116:119], a[104:107], v[36:39]
    buffer_store_dwordx4 v[164:167], v4, s[4:7], s61 offen offset:0 sc1
    v_mfma_f32_16x16x32_bf16 v[44:47], v[116:119], a[108:111], v[44:47]
    s_waitcnt lgkmcnt(5)
    ds_read_b128 v[116:119], v191 offset:2304
    v_mfma_f32_16x16x32_bf16 v[32:35], v[120:123], a[112:115], v[32:35]
    v_mfma_f32_16x16x32_bf16 v[40:43], v[120:123], a[116:119], v[40:43]
    ds_read_b128 v[120:123], v3 offset:30720
    v_mfma_f32_16x16x32_bf16 v[36:39], v[124:127], a[112:115], v[36:39]
    v_mfma_f32_16x16x32_bf16 v[44:47], v[124:127], a[116:119], v[44:47]
    s_waitcnt lgkmcnt(5)
    ds_read_b128 v[124:127], v191 offset:4096
    v_mfma_f32_16x16x32_bf16 v[32:35], v[128:131], a[120:123], v[32:35]
    buffer_load_dwordx4 v[72:75], v1, s[4:7], s37 offen offset:2048 sc1
    v_mfma_f32_16x16x32_bf16 v[40:43], v[128:131], a[124:127], v[40:43]
    ds_read_b128 v[128:131], v191 offset:4352
    v_mfma_f32_16x16x32_bf16 v[36:39], v[132:135], a[120:123], v[36:39]
    v_mfma_f32_16x16x32_bf16 v[44:47], v[132:135], a[124:127], v[44:47]
    s_waitcnt lgkmcnt(5)
    ds_read_b128 v[132:135], v191 offset:6144
    v_mfma_f32_16x16x32_bf16 v[32:35], v[136:139], a[128:131], v[32:35]
    v_mfma_f32_16x16x32_bf16 v[40:43], v[136:139], a[132:135], v[40:43]
    ds_read_b128 v[136:139], v191 offset:6400
    v_mfma_f32_16x16x32_bf16 v[36:39], v[140:143], a[128:131], v[36:39]
    buffer_load_dwordx4 v[76:79], v1, s[4:7], s37 offen offset:3072 sc1
    v_mfma_f32_16x16x32_bf16 v[44:47], v[140:143], a[132:135], v[44:47]
    s_waitcnt lgkmcnt(5)
    ds_read_b128 v[140:143], v191 offset:8192
    v_mfma_f32_16x16x32_bf16 v[32:35], v[112:115], a[136:139], v[32:35]
    v_mfma_f32_16x16x32_bf16 v[40:43], v[112:115], a[140:143], v[40:43]
    ds_read_b128 v[112:115], v191 offset:8448
    v_mfma_f32_16x16x32_bf16 v[36:39], v[116:119], a[136:139], v[36:39]
    v_mfma_f32_16x16x32_bf16 v[44:47], v[116:119], a[140:143], v[44:47]
    s_waitcnt lgkmcnt(5)
    ds_read_b128 v[116:119], v191 offset:10240
    v_mfma_f32_16x16x4_4b_bf16 v[16:31], v[120:121], v[168:169], 0
    ds_read_b128 v[120:123], v191 offset:10496
    v_mfma_f32_16x16x32_bf16 v[32:35], v[124:127], a[144:147], v[32:35]
    v_mfma_f32_16x16x32_bf16 v[40:43], v[124:127], a[148:151], v[40:43]
    s_waitcnt lgkmcnt(5)
    ds_read_b128 v[124:127], v191 offset:12288
    v_mfma_f32_16x16x32_bf16 v[36:39], v[128:131], a[144:147], v[36:39]
    v_mfma_f32_16x16x32_bf16 v[44:47], v[128:131], a[148:151], v[44:47]
    ds_read_b128 v[128:131], v191 offset:12544
    v_mfma_f32_16x16x32_bf16 v[32:35], v[132:135], a[152:155], v[32:35]
    v_mfma_f32_16x16x32_bf16 v[40:43], v[132:135], a[156:159], v[40:43]
    s_waitcnt lgkmcnt(5)
    ds_read_b128 v[132:135], v191 offset:14336
    v_mfma_f32_16x16x32_bf16 v[36:39], v[136:139], a[152:155], v[36:39]
    v_mfma_f32_16x16x32_bf16 v[44:47], v[136:139], a[156:159], v[44:47]
    ds_read_b128 v[136:139], v191 offset:14592
    v_mfma_f32_16x16x32_bf16 v[16:19], v[140:143], a[0:3], v[16:19]
    v_mfma_f32_16x16x32_bf16 v[24:27], v[140:143], a[4:7], v[24:27]
    s_waitcnt lgkmcnt(5)
    ds_read_b128 v[140:143], v191 offset:16384
    v_mul_f32 v144, v32, v5
    v_mul_f32 v145, v33, v5
    v_mfma_f32_16x16x32_bf16 v[20:23], v[112:115], a[0:3], v[20:23]
    v_mul_f32 v148, v40, v189
    v_exp_f32 v144, v144
    v_mfma_f32_16x16x32_bf16 v[28:31], v[112:115], a[4:7], v[28:31]
    ds_read_b128 v[112:115], v191 offset:16640
    v_exp_f32 v145, v145
    v_mfma_f32_16x16x32_bf16 v[16:19], v[116:119], a[8:11], v[16:19]
    s_add_u32 s37, s71, 57344
    buffer_load_dwordx4 a[0:3], v1, s[4:7], s37 offen offset:0 sc1
    v_mul_f32 v149, v41, v189
    v_mfma_f32_16x16x32_bf16 v[24:27], v[116:119], a[12:15], v[24:27]
    s_waitcnt lgkmcnt(5)
    ds_read_b128 v[116:119], v191 offset:18432
    v_exp_f32 v148, v148
    v_mfma_f32_16x16x32_bf16 v[20:23], v[120:123], a[8:11], v[20:23]
    v_mul_f32 v146, v34, v5
    v_exp_f32 v149, v149
    v_mfma_f32_16x16x32_bf16 v[28:31], v[120:123], a[12:15], v[28:31]
    s_waitcnt vmcnt(7)
    ds_read_b128 v[120:123], v191 offset:18688
    v_exp_f32 v146, v146
    v_mfma_f32_16x16x32_bf16 v[16:19], v[124:127], a[16:19], v[16:19]
    s_barrier
    buffer_load_dwordx4 a[4:7], v1, s[4:7], s37 offen offset:1024 sc1
    v_mul_f32 v147, v35, v5
    v_mfma_f32_16x16x32_bf16 v[24:27], v[124:127], a[20:23], v[24:27]
    s_waitcnt lgkmcnt(5)
    ds_read_b128 v[124:127], v191 offset:20480
    v_exp_f32 v147, v147
    v_mfma_f32_16x16x32_bf16 v[20:23], v[128:131], a[16:19], v[20:23]
    v_mul_f32 v150, v42, v189
    v_exp_f32 v150, v150
    v_mfma_f32_16x16x32_bf16 v[28:31], v[128:131], a[20:23], v[28:31]
    ds_read_b128 v[128:131], v191 offset:20736
    v_mul_f32 v151, v43, v189
    v_mul_f32 v32, v32, v36
    v_mfma_f32_16x16x32_bf16 v[16:19], v[132:135], a[24:27], v[16:19]
    buffer_load_dwordx4 a[8:11], v1, s[4:7], s37 offen offset:2048 sc1
    v_mul_f32 v33, v33, v37
    v_mfma_f32_16x16x32_bf16 v[24:27], v[132:135], a[28:31], v[24:27]
    s_waitcnt lgkmcnt(5)
    ds_read_b128 v[132:135], v191 offset:22528
    v_exp_f32 v151, v151
    v_mfma_f32_16x16x32_bf16 v[20:23], v[136:139], a[24:27], v[20:23]
    v_mul_f32 v40, v40, v44
    v_mul_f32 v41, v41, v45
    v_mul_f32 v34, v34, v38
    v_mfma_f32_16x16x32_bf16 v[28:31], v[136:139], a[28:31], v[28:31]
    ds_read_b128 v[136:139], v191 offset:22784
    v_mul_f32 v35, v35, v39
    v_mul_f32 v42, v42, v46
    v_mfma_f32_16x16x32_bf16 v[16:19], v[140:143], a[32:35], v[16:19]
    buffer_load_dwordx4 a[12:15], v1, s[4:7], s37 offen offset:3072 sc1
    v_mul_f32 v43, v43, v47
    v_mfma_f32_16x16x32_bf16 v[24:27], v[140:143], a[36:39], v[24:27]
    s_waitcnt lgkmcnt(5)
    ds_read_b128 v[140:143], v191 offset:24576
    v_fma_f32 v144, v144, v6, v6
    v_fma_f32 v145, v145, v6, v6
    v_mfma_f32_16x16x32_bf16 v[20:23], v[112:115], a[32:35], v[20:23]
    buffer_load_dword v13, v12, s[4:7], s70 offen sc1
    v_fma_f32 v148, v148, v190, v190
    v_mfma_f32_16x16x32_bf16 v[28:31], v[112:115], a[36:39], v[28:31]
    ds_read_b128 v[112:115], v191 offset:24832
    v_rcp_f32 v144, v144
    v_mfma_f32_16x16x32_bf16 v[16:19], v[116:119], a[40:43], v[16:19]
    v_fma_f32 v149, v149, v190, v190
    v_rcp_f32 v145, v145
    v_mfma_f32_16x16x32_bf16 v[24:27], v[116:119], a[44:47], v[24:27]
    s_waitcnt lgkmcnt(5)
    ds_read_b128 v[116:119], v191 offset:26624
    v_rcp_f32 v148, v148
    v_mfma_f32_16x16x32_bf16 v[20:23], v[120:123], a[40:43], v[20:23]
    v_fma_f32 v146, v146, v6, v6
    v_rcp_f32 v149, v149
    v_mfma_f32_16x16x32_bf16 v[28:31], v[120:123], a[44:47], v[28:31]
    ds_read_b128 v[120:123], v191 offset:26880
    v_rcp_f32 v146, v146
    v_mfma_f32_16x16x32_bf16 v[16:19], v[124:127], a[48:51], v[16:19]
    v_fma_f32 v147, v147, v6, v6
    v_rcp_f32 v147, v147
    v_mfma_f32_16x16x32_bf16 v[24:27], v[124:127], a[52:55], v[24:27]
    s_waitcnt lgkmcnt(5)
    ds_read_b128 v[124:127], v191 offset:28672
    v_fma_f32 v150, v150, v190, v190
    v_fma_f32 v151, v151, v190, v190
    v_mfma_f32_16x16x32_bf16 v[20:23], v[128:131], a[48:51], v[20:23]
    v_mul_f32 v32, v32, v144
    v_rcp_f32 v150, v150
    v_mfma_f32_16x16x32_bf16 v[28:31], v[128:131], a[52:55], v[28:31]
    ds_read_b128 v[128:131], v191 offset:28928
    v_rcp_f32 v151, v151
    v_mfma_f32_16x16x32_bf16 v[16:19], v[132:135], a[56:59], v[16:19]
    v_mul_f32 v33, v33, v145
    v_mul_f32 v40, v40, v148
    v_mul_f32 v41, v41, v149
    v_mfma_f32_16x16x32_bf16 v[24:27], v[132:135], a[60:63], v[24:27]
    s_waitcnt lgkmcnt(5)
    ds_read_b128 v[132:135], v191 offset:30720
    v_cvt_pk_bf16_f32 v152, v32, v33
    v_cvt_pk_bf16_f32 v154, v40, v41
    v_mfma_f32_16x16x32_bf16 v[20:23], v[136:139], a[56:59], v[20:23]
    v_mul_f32 v34, v34, v146
    v_mul_f32 v35, v35, v147
    v_mfma_f32_16x16x32_bf16 v[28:31], v[136:139], a[60:63], v[28:31]
    ds_read_b128 v[136:139], v191 offset:30976
    v_permlane32_swap_b32 v152, v154
    v_mfma_f32_16x16x32_bf16 v[16:19], v[140:143], a[64:67], v[16:19]
    v_mul_f32 v42, v42, v150
    v_mul_f32 v43, v43, v151
    v_mfma_f32_16x16x32_bf16 v[24:27], v[140:143], a[68:71], v[24:27]
    s_waitcnt lgkmcnt(5)
    ds_read_b128 v[140:143], v191 offset:32768
    v_cvt_pk_bf16_f32 v153, v34, v35
    v_mfma_f32_16x16x32_bf16 v[20:23], v[112:115], a[64:67], v[20:23]
    v_cvt_pk_bf16_f32 v155, v42, v43
    v_mfma_f32_16x16x32_bf16 v[28:31], v[112:115], a[68:71], v[28:31]
    ds_read_b128 v[112:115], v191 offset:33024
    v_mfma_f32_16x16x32_bf16 v[16:19], v[116:119], a[72:75], v[16:19]
    v_permlane32_swap_b32 v153, v155
    v_mfma_f32_16x16x32_bf16 v[24:27], v[116:119], a[76:79], v[24:27]
    s_waitcnt lgkmcnt(5)
    ds_read_b128 v[116:119], v191 offset:34816
    v_mfma_f32_16x16x32_bf16 v[20:23], v[120:123], a[72:75], v[20:23]
    buffer_store_dwordx4 v[152:155], v4, s[4:7], s61 offen offset:512 sc1
    v_mfma_f32_16x16x32_bf16 v[28:31], v[120:123], a[76:79], v[28:31]
    ds_read_b128 v[120:123], v191 offset:35072
    v_mfma_f32_16x16x32_bf16 v[16:19], v[124:127], a[80:83], v[16:19]
    v_mfma_f32_16x16x32_bf16 v[24:27], v[124:127], a[84:87], v[24:27]
    s_waitcnt lgkmcnt(5)
    ds_read_b128 v[124:127], v191 offset:36864
    v_mfma_f32_16x16x32_bf16 v[20:23], v[128:131], a[80:83], v[20:23]
    v_mfma_f32_16x16x32_bf16 v[28:31], v[128:131], a[84:87], v[28:31]
    ds_read_b128 v[128:131], v191 offset:37120
    v_mfma_f32_16x16x32_bf16 v[16:19], v[132:135], a[88:91], v[16:19]
    v_mfma_f32_16x16x32_bf16 v[24:27], v[132:135], a[92:95], v[24:27]
    s_waitcnt lgkmcnt(5)
    ds_read_b128 v[132:135], v191 offset:38912
    v_mfma_f32_16x16x32_bf16 v[20:23], v[136:139], a[88:91], v[20:23]
    v_mfma_f32_16x16x32_bf16 v[28:31], v[136:139], a[92:95], v[28:31]
    ds_read_b128 v[136:139], v191 offset:39168
    v_mfma_f32_16x16x32_bf16 v[16:19], v[140:143], a[96:99], v[16:19]
    v_mfma_f32_16x16x32_bf16 v[24:27], v[140:143], a[100:103], v[24:27]
    s_waitcnt lgkmcnt(5)
    ds_read_b128 v[140:143], v191 offset:40960
    v_mfma_f32_16x16x32_bf16 v[20:23], v[112:115], a[96:99], v[20:23]
    v_mfma_f32_16x16x32_bf16 v[28:31], v[112:115], a[100:103], v[28:31]
    ds_read_b128 v[112:115], v191 offset:41216
    v_mfma_f32_16x16x32_bf16 v[16:19], v[116:119], a[104:107], v[16:19]
    v_mfma_f32_16x16x32_bf16 v[24:27], v[116:119], a[108:111], v[24:27]
    s_waitcnt lgkmcnt(5)
    ds_read_b128 v[116:119], v191 offset:43008
    v_mfma_f32_16x16x32_bf16 v[20:23], v[120:123], a[104:107], v[20:23]
    v_mfma_f32_16x16x32_bf16 v[28:31], v[120:123], a[108:111], v[28:31]
    ds_read_b128 v[120:123], v191 offset:43264
    v_mfma_f32_16x16x32_bf16 v[16:19], v[124:127], a[112:115], v[16:19]
    v_mfma_f32_16x16x32_bf16 v[24:27], v[124:127], a[116:119], v[24:27]
    s_waitcnt lgkmcnt(5)
    ds_read_b128 v[124:127], v191 offset:45056
    v_mfma_f32_16x16x32_bf16 v[20:23], v[128:131], a[112:115], v[20:23]
    v_mfma_f32_16x16x32_bf16 v[28:31], v[128:131], a[116:119], v[28:31]
    ds_read_b128 v[128:131], v191 offset:45312
    v_mfma_f32_16x16x32_bf16 v[16:19], v[132:135], a[120:123], v[16:19]
    v_mfma_f32_16x16x32_bf16 v[24:27], v[132:135], a[124:127], v[24:27]
    s_waitcnt lgkmcnt(5)
    ds_read_b128 v[132:135], v191 offset:47104
    v_mfma_f32_16x16x32_bf16 v[20:23], v[136:139], a[120:123], v[20:23]
    v_mfma_f32_16x16x32_bf16 v[28:31], v[136:139], a[124:127], v[28:31]
    ds_read_b128 v[136:139], v191 offset:47360
    v_mfma_f32_16x16x32_bf16 v[16:19], v[140:143], a[128:131], v[16:19]
    v_mfma_f32_16x16x32_bf16 v[24:27], v[140:143], a[132:135], v[24:27]
    s_waitcnt lgkmcnt(5)
    v_mfma_f32_16x16x32_bf16 v[20:23], v[112:115], a[128:131], v[20:23]
    s_waitcnt vmcnt(1)
    v_cmp_gt_u32 vcc, 1, v13
    v_mfma_f32_16x16x32_bf16 v[28:31], v[112:115], a[132:135], v[28:31]
    s_cbranch_vccnz k2_main_kernel_q1
k2_main_kernel_q1x:
    v_mfma_f32_16x16x32_bf16 v[16:19], v[116:119], a[136:139], v[16:19]
    v_mfma_f32_16x16x32_bf16 v[24:27], v[116:119], a[140:143], v[24:27]
    s_waitcnt lgkmcnt(3)
    v_mfma_f32_16x16x32_bf16 v[20:23], v[120:123], a[136:139], v[20:23]
    s_add_u32 s34, s73, 0
    buffer_load_dwordx4 a[16:19], v1, s[4:7], s34 offen offset:0 sc1
    v_mfma_f32_16x16x32_bf16 v[28:31], v[120:123], a[140:143], v[28:31]
    v_mfma_f32_16x16x32_bf16 v[16:19], v[124:127], a[144:147], v[16:19]
    v_mfma_f32_16x16x32_bf16 v[24:27], v[124:127], a[148:151], v[24:27]
    s_waitcnt lgkmcnt(1)
    v_mfma_f32_16x16x32_bf16 v[20:23], v[128:131], a[144:147], v[20:23]
    buffer_load_dwordx4 a[20:23], v1, s[4:7], s34 offen offset:1024 sc1
    v_mfma_f32_16x16x32_bf16 v[28:31], v[128:131], a[148:151], v[28:31]
    v_mfma_f32_16x16x32_bf16 v[16:19], v[132:135], a[152:155], v[16:19]
    v_mfma_f32_16x16x32_bf16 v[24:27], v[132:135], a[156:159], v[24:27]
    s_waitcnt lgkmcnt(0)
    v_mfma_f32_16x16x32_bf16 v[20:23], v[136:139], a[152:155], v[20:23]
    v_mfma_f32_16x16x32_bf16 v[28:31], v[136:139], a[156:159], v[28:31]
    buffer_load_dwordx4 a[24:27], v1, s[4:7], s34 offen offset:2048 sc1
    s_nop 5
    v_mul_f32 v156, v16, v5
    buffer_load_dwordx4 a[28:31], v1, s[4:7], s34 offen offset:3072 sc1
    v_mul_f32 v157, v17, v5
    v_mul_f32 v160, v24, v189
    v_mul_f32 v161, v25, v189
    v_mul_f32 v158, v18, v5
    v_mul_f32 v159, v19, v5
    v_mul_f32 v162, v26, v189
    v_mul_f32 v163, v27, v189
    v_exp_f32 v156, v156
    v_mul_f32 v16, v16, v20
    v_exp_f32 v157, v157
    v_mul_f32 v17, v17, v21
    v_exp_f32 v160, v160
    v_mul_f32 v24, v24, v28
    v_exp_f32 v161, v161
    v_mul_f32 v25, v25, v29
    v_exp_f32 v158, v158
    v_mul_f32 v18, v18, v22
    v_exp_f32 v159, v159
    v_mul_f32 v19, v19, v23
    v_exp_f32 v162, v162
    v_mul_f32 v26, v26, v30
    v_exp_f32 v163, v163
    v_mul_f32 v27, v27, v31
    v_fma_f32 v156, v156, v6, v6
    s_add_u32 s34, s73, 4096
    buffer_load_dwordx4 a[32:35], v1, s[4:7], s34 offen offset:0 sc1
    v_rcp_f32 v156, v156
    v_fma_f32 v157, v157, v6, v6
    v_rcp_f32 v157, v157
    v_fma_f32 v160, v160, v190, v190
    v_rcp_f32 v160, v160
    v_fma_f32 v161, v161, v190, v190
    v_rcp_f32 v161, v161
    v_fma_f32 v158, v158, v6, v6
    v_rcp_f32 v158, v158
    v_fma_f32 v159, v159, v6, v6
    v_rcp_f32 v159, v159
    v_fma_f32 v162, v162, v190, v190
    v_rcp_f32 v162, v162
    v_fma_f32 v163, v163, v190, v190
    v_rcp_f32 v163, v163
    v_mul_f32 v16, v16, v156
    v_mul_f32 v17, v17, v157
    v_mul_f32 v24, v24, v160
    v_mul_f32 v25, v25, v161
    v_cvt_pk_bf16_f32 v164, v16, v17
    v_cvt_pk_bf16_f32 v166, v24, v25
    v_mul_f32 v18, v18, v158
    v_mul_f32 v19, v19, v159
    v_mul_f32 v26, v26, v162
    v_mul_f32 v27, v27, v163
    v_cvt_pk_bf16_f32 v165, v18, v19
    v_cvt_pk_bf16_f32 v167, v26, v27
    v_permlane32_swap_b32 v164, v166
    s_nop 0
    v_permlane32_swap_b32 v165, v167
    buffer_store_dwordx4 v[164:167], v4, s[4:7], s62 offen offset:0 sc1
    s_waitcnt vmcnt(6)
    buffer_store_dword v7, off, s[4:7], s69 sc1
    v_add_u32 v7, 1, v7
    s_waitcnt vmcnt(6)
    v_mfma_f32_16x16x32_bf16 v[112:115], a[160:163], a[16:19], 0
    v_mfma_f32_16x16x32_bf16 v[116:119], a[164:167], a[16:19], 0
    buffer_load_dwordx4 a[36:39], v1, s[4:7], s34 offen offset:1024 sc1
    v_mfma_f32_16x16x32_bf16 v[120:123], a[168:171], a[16:19], 0
    v_mfma_f32_16x16x32_bf16 v[124:127], a[172:175], a[16:19], 0
    buffer_load_dwordx4 a[40:43], v1, s[4:7], s34 offen offset:2048 sc1
    v_mfma_f32_16x16x32_bf16 v[128:131], a[176:179], a[16:19], 0
    s_waitcnt vmcnt(7)
    v_mfma_f32_16x16x32_bf16 v[112:115], a[180:183], a[20:23], v[112:115]
    v_mfma_f32_16x16x32_bf16 v[116:119], a[184:187], a[20:23], v[116:119]
    buffer_load_dwordx4 a[44:47], v1, s[4:7], s34 offen offset:3072 sc1
    v_mfma_f32_16x16x32_bf16 v[120:123], a[188:191], a[20:23], v[120:123]
    v_mfma_f32_16x16x32_bf16 v[124:127], a[192:195], a[20:23], v[124:127]
k2_main_kernel_pad_P10:
    s_cbranch_execz k2_main_kernel_tr_c3
    v_mfma_f32_16x16x32_bf16 v[128:131], a[196:199], a[20:23], v[128:131]
    s_waitcnt vmcnt(7)
    v_mfma_f32_16x16x32_bf16 v[112:115], a[200:203], a[24:27], v[112:115]
    v_mfma_f32_16x16x32_bf16 v[116:119], a[204:207], a[24:27], v[116:119]
    s_add_u32 s34, s74, 0
    buffer_load_dwordx4 a[48:51], v1, s[4:7], s34 offen offset:0 sc1
    v_mfma_f32_16x16x32_bf16 v[120:123], a[208:211], a[24:27], v[120:123]
    v_mfma_f32_16x16x32_bf16 v[124:127], a[212:215], a[24:27], v[124:127]
    buffer_load_dwordx4 a[52:55], v1, s[4:7], s34 offen offset:1024 sc1
    v_mfma_f32_16x16x32_bf16 v[128:131], a[216:219], a[24:27], v[128:131]
    s_waitcnt vmcnt(8)
    v_mfma_f32_16x16x32_bf16 v[112:115], a[220:223], a[28:31], v[112:115]
    v_mfma_f32_16x16x32_bf16 v[116:119], a[224:227], a[28:31], v[116:119]
    buffer_load_dwordx4 a[56:59], v1, s[4:7], s34 offen offset:2048 sc1
    v_mfma_f32_16x16x32_bf16 v[120:123], a[228:231], a[28:31], v[120:123]
    v_mfma_f32_16x16x32_bf16 v[124:127], a[232:235], a[28:31], v[124:127]
    v_mfma_f32_16x16x32_bf16 v[128:131], a[236:239], a[28:31], v[128:131]
    s_waitcnt vmcnt(8)
    v_mfma_f32_16x16x32_bf16 v[112:115], a[240:243], a[32:35], v[112:115]
    v_mfma_f32_16x16x32_bf16 v[116:119], a[244:247], a[32:35], v[116:119]
    buffer_load_dwordx4 a[60:63], v1, s[4:7], s34 offen offset:3072 sc1
    v_mfma_f32_16x16x32_bf16 v[120:123], a[248:251], a[32:35], v[120:123]
    v_mfma_f32_16x16x32_bf16 v[124:127], a[252:255], a[32:35], v[124:127]
    s_add_u32 s34, s74, 4096
    buffer_load_dwordx4 a[64:67], v1, s[4:7], s34 offen offset:0 sc1
    v_mfma_f32_16x16x32_bf16 v[128:131], v[192:195], a[32:35], v[128:131]
    s_waitcnt vmcnt(7)
    v_mfma_f32_16x16x32_bf16 v[112:115], v[196:199], a[36:39], v[112:115]
    v_mfma_f32_16x16x32_bf16 v[116:119], v[200:203], a[36:39], v[116:119]
    buffer_load_dwordx4 a[68:71], v1, s[4:7], s34 offen offset:1024 sc1
    v_mfma_f32_16x16x32_bf16 v[120:123], v[204:207], a[36:39], v[120:123]
    v_mfma_f32_16x16x32_bf16 v[124:127], v[208:211], a[36:39], v[124:127]
    v_mfma_f32_16x16x32_bf16 v[128:131], v[212:215], a[36:39], v[128:131]
    buffer_store_dword v7, off, s[4:7], s69 sc1
    s_waitcnt vmcnt(8)
    v_mfma_f32_16x16x32_bf16 v[112:115], v[216:219], a[40:43], v[112:115]
    v_mfma_f32_16x16x32_bf16 v[116:119], v[220:223], a[40:43], v[116:119]
    buffer_load_dwordx4 a[72:75], v1, s[4:7], s34 offen offset:2048 sc1
    v_mfma_f32_16x16x32_bf16 v[120:123], v[224:227], a[40:43], v[120:123]
    v_mfma_f32_16x16x32_bf16 v[124:127], v[228:231], a[40:43], v[124:127]
    buffer_load_dwordx4 a[76:79], v1, s[4:7], s34 offen offset:3072 sc1
    v_mfma_f32_16x16x32_bf16 v[128:131], v[232:235], a[40:43], v[128:131]
    s_waitcnt vmcnt(9)
    v_mfma_f32_16x16x32_bf16 v[112:115], v[236:239], a[44:47], v[112:115]
    v_mfma_f32_16x16x32_bf16 v[116:119], v[240:243], a[44:47], v[116:119]
    s_add_u32 s34, s75, 0
    buffer_load_dwordx4 a[80:83], v1, s[4:7], s34 offen offset:0 sc1
    v_mfma_f32_16x16x32_bf16 v[120:123], v[244:247], a[44:47], v[120:123]
    v_mfma_f32_16x16x32_bf16 v[124:127], v[248:251], a[44:47], v[124:127]
    v_mfma_f32_16x16x32_bf16 v[128:131], v[252:255], a[44:47], v[128:131]
    s_waitcnt vmcnt(9)
    v_mfma_f32_16x16x32_bf16 v[132:135], a[160:163], a[48:51], 0
    v_mfma_f32_16x16x32_bf16 v[136:139], a[164:167], a[48:51], 0
    buffer_load_dwordx4 a[84:87], v1, s[4:7], s34 offen offset:1024 sc1
    v_mfma_f32_16x16x32_bf16 v[140:143], a[168:171], a[48:51], 0
    v_mfma_f32_16x16x32_bf16 v[144:147], a[172:175], a[48:51], 0
    buffer_load_dwordx4 a[88:91], v1, s[4:7], s34 offen offset:2048 sc1
    v_mfma_f32_16x16x32_bf16 v[148:151], a[176:179], a[48:51], 0
    s_waitcnt vmcnt(10)
    v_mfma_f32_16x16x32_bf16 v[132:135], a[180:183], a[52:55], v[132:135]
    v_mfma_f32_16x16x32_bf16 v[136:139], a[184:187], a[52:55], v[136:139]
    buffer_load_dwordx4 a[92:95], v1, s[4:7], s34 offen offset:3072 sc1
    v_mfma_f32_16x16x32_bf16 v[140:143], a[188:191], a[52:55], v[140:143]
    v_mfma_f32_16x16x32_bf16 v[144:147], a[192:195], a[52:55], v[144:147]
    v_mfma_f32_16x16x32_bf16 v[148:151], a[196:199], a[52:55], v[148:151]
    s_waitcnt vmcnt(10)
    v_mfma_f32_16x16x32_bf16 v[132:135], a[200:203], a[56:59], v[132:135]
    v_mfma_f32_16x16x32_bf16 v[136:139], a[204:207], a[56:59], v[136:139]
    s_add_u32 s34, s75, 4096
    buffer_load_dwordx4 a[96:99], v1, s[4:7], s34 offen offset:0 sc1
    v_mfma_f32_16x16x32_bf16 v[140:143], a[208:211], a[56:59], v[140:143]
    v_mfma_f32_16x16x32_bf16 v[144:147], a[212:215], a[56:59], v[144:147]
    buffer_load_dwordx4 a[100:103], v1, s[4:7], s34 offen offset:1024 sc1
    v_mfma_f32_16x16x32_bf16 v[148:151], a[216:219], a[56:59], v[148:151]
    s_waitcnt vmcnt(11)
    v_mfma_f32_16x16x32_bf16 v[132:135], a[220:223], a[60:63], v[132:135]
    v_mfma_f32_16x16x32_bf16 v[136:139], a[224:227], a[60:63], v[136:139]
    buffer_load_dwordx4 a[104:107], v1, s[4:7], s34 offen offset:2048 sc1
    v_mfma_f32_16x16x32_bf16 v[140:143], a[228:231], a[60:63], v[140:143]
    v_mfma_f32_16x16x32_bf16 v[144:147], a[232:235], a[60:63], v[144:147]
    v_mfma_f32_16x16x32_bf16 v[148:151], a[236:239], a[60:63], v[148:151]
    buffer_load_dword v13, v12, s[4:7], s70 offen sc1
    s_waitcnt vmcnt(12)
    v_mfma_f32_16x16x32_bf16 v[132:135], a[240:243], a[64:67], v[132:135]
    v_mfma_f32_16x16x32_bf16 v[136:139], a[244:247], a[64:67], v[136:139]
    buffer_load_dwordx4 a[108:111], v1, s[4:7], s34 offen offset:3072 sc1
    v_mfma_f32_16x16x32_bf16 v[140:143], a[248:251], a[64:67], v[140:143]
    v_mfma_f32_16x16x32_bf16 v[144:147], a[252:255], a[64:67], v[144:147]
    s_add_u32 s34, s76, 0
    buffer_load_dwordx4 a[112:115], v1, s[4:7], s34 offen offset:0 sc1
    v_mfma_f32_16x16x32_bf16 v[148:151], v[192:195], a[64:67], v[148:151]
    s_waitcnt vmcnt(13)
    v_mfma_f32_16x16x32_bf16 v[132:135], v[196:199], a[68:71], v[132:135]
    v_mfma_f32_16x16x32_bf16 v[136:139], v[200:203], a[68:71], v[136:139]
    buffer_load_dwordx4 a[116:119], v1, s[4:7], s34 offen offset:1024 sc1
    v_mfma_f32_16x16x32_bf16 v[140:143], v[204:207], a[68:71], v[140:143]
    v_mfma_f32_16x16x32_bf16 v[144:147], v[208:211], a[68:71], v[144:147]
    v_mfma_f32_16x16x32_bf16 v[148:151], v[212:215], a[68:71], v[148:151]
    s_waitcnt vmcnt(12)
    v_mfma_f32_16x16x32_bf16 v[132:135], v[216:219], a[72:75], v[132:135]
    v_mfma_f32_16x16x32_bf16 v[136:139], v[220:223], a[72:75], v[136:139]
    buffer_load_dwordx4 a[120:123], v1, s[4:7], s34 offen offset:2048 sc1
    v_mfma_f32_16x16x32_bf16 v[140:143], v[224:227], a[72:75], v[140:143]
    v_mfma_f32_16x16x32_bf16 v[144:147], v[228:231], a[72:75], v[144:147]
    buffer_load_dwordx4 a[124:127], v1, s[4:7], s34 offen offset:3072 sc1
    v_mfma_f32_16x16x32_bf16 v[148:151], v[232:235], a[72:75], v[148:151]
    s_waitcnt vmcnt(13)
    v_mfma_f32_16x16x32_bf16 v[132:135], v[236:239], a[76:79], v[132:135]
    v_mfma_f32_16x16x32_bf16 v[136:139], v[240:243], a[76:79], v[136:139]
    s_add_u32 s34, s76, 4096
    buffer_load_dwordx4 a[128:131], v1, s[4:7], s34 offen offset:0 sc1
    v_mfma_f32_16x16x32_bf16 v[140:143], v[244:247], a[76:79], v[140:143]
    v_mfma_f32_16x16x32_bf16 v[144:147], v[248:251], a[76:79], v[144:147]
    v_mfma_f32_16x16x32_bf16 v[148:151], v[252:255], a[76:79], v[148:151]
    s_waitcnt vmcnt(13)
    v_mfma_f32_16x16x32_bf16 v[152:155], a[160:163], a[80:83], 0
    v_mfma_f32_16x16x32_bf16 v[156:159], a[164:167], a[80:83], 0
    buffer_load_dwordx4 a[132:135], v1, s[4:7], s34 offen offset:1024 sc1
    v_mfma_f32_16x16x32_bf16 v[160:163], a[168:171], a[80:83], 0
    v_mfma_f32_16x16x32_bf16 v[164:167], a[172:175], a[80:83], 0
    buffer_load_dwordx4 a[136:139], v1, s[4:7], s34 offen offset:2048 sc1
    v_mfma_f32_16x16x32_bf16 v[168:171], a[176:179], a[80:83], 0
    s_waitcnt vmcnt(14)
    v_mfma_f32_16x16x32_bf16 v[152:155], a[180:183], a[84:87], v[152:155]
    v_mfma_f32_16x16x32_bf16 v[156:159], a[184:187], a[84:87], v[156:159]
    buffer_load_dwordx4 a[140:143], v1, s[4:7], s34 offen offset:3072 sc1
    v_mfma_f32_16x16x32_bf16 v[160:163], a[188:191], a[84:87], v[160:163]
    v_mfma_f32_16x16x32_bf16 v[164:167], a[192:195], a[84:87], v[164:167]
    v_mfma_f32_16x16x32_bf16 v[168:171], a[196:199], a[84:87], v[168:171]
    s_waitcnt vmcnt(14)
    v_mfma_f32_16x16x32_bf16 v[152:155], a[200:203], a[88:91], v[152:155]
    v_mfma_f32_16x16x32_bf16 v[156:159], a[204:207], a[88:91], v[156:159]
    v_mfma_f32_16x16x32_bf16 v[160:163], a[208:211], a[88:91], v[160:163]
    v_mfma_f32_16x16x32_bf16 v[164:167], a[212:215], a[88:91], v[164:167]
    v_mfma_f32_16x16x32_bf16 v[168:171], a[216:219], a[88:91], v[168:171]
    s_waitcnt vmcnt(13)
    v_mfma_f32_16x16x32_bf16 v[152:155], a[220:223], a[92:95], v[152:155]
    v_mfma_f32_16x16x32_bf16 v[156:159], a[224:227], a[92:95], v[156:159]
    v_mfma_f32_16x16x32_bf16 v[160:163], a[228:231], a[92:95], v[160:163]
    v_mfma_f32_16x16x32_bf16 v[164:167], a[232:235], a[92:95], v[164:167]
    v_mfma_f32_16x16x32_bf16 v[168:171], a[236:239], a[92:95], v[168:171]
    s_waitcnt vmcnt(12)
    v_mfma_f32_16x16x32_bf16 v[152:155], a[240:243], a[96:99], v[152:155]
    v_mfma_f32_16x16x32_bf16 v[156:159], a[244:247], a[96:99], v[156:159]
    v_mfma_f32_16x16x32_bf16 v[160:163], a[248:251], a[96:99], v[160:163]
    v_mfma_f32_16x16x32_bf16 v[164:167], a[252:255], a[96:99], v[164:167]
    v_mfma_f32_16x16x32_bf16 v[168:171], v[192:195], a[96:99], v[168:171]
    s_waitcnt vmcnt(11)
    v_mfma_f32_16x16x32_bf16 v[152:155], v[196:199], a[100:103], v[152:155]
    v_mfma_f32_16x16x32_bf16 v[156:159], v[200:203], a[100:103], v[156:159]
    v_mfma_f32_16x16x32_bf16 v[160:163], v[204:207], a[100:103], v[160:163]
    v_mfma_f32_16x16x32_bf16 v[164:167], v[208:211], a[100:103], v[164:167]
    v_mfma_f32_16x16x32_bf16 v[168:171], v[212:215], a[100:103], v[168:171]
    s_waitcnt vmcnt(9)
    v_cmp_gt_u32 vcc, 2, v13
    s_cbranch_vccnz k2_main_kernel_q2
k2_main_kernel_q2x:
    buffer_load_dword v13, v187, s[4:7], s72 offen sc1
    v_mfma_f32_16x16x32_bf16 v[152:155], v[216:219], a[104:107], v[152:155]
    v_mfma_f32_16x16x32_bf16 v[156:159], v[220:223], a[104:107], v[156:159]
    s_add_u32 s34, s73, 8192
    buffer_load_dwordx4 a[16:19], v1, s[4:7], s34 offen offset:0 sc1
    v_mfma_f32_16x16x32_bf16 v[160:163], v[224:227], a[104:107], v[160:163]
    v_mfma_f32_16x16x32_bf16 v[164:167], v[228:231], a[104:107], v[164:167]
    buffer_load_dwordx4 a[20:23], v1, s[4:7], s34 offen offset:1024 sc1
    v_mfma_f32_16x16x32_bf16 v[168:171], v[232:235], a[104:107], v[168:171]
    s_waitcnt vmcnt(11)
    v_mfma_f32_16x16x32_bf16 v[152:155], v[236:239], a[108:111], v[152:155]
    v_mfma_f32_16x16x32_bf16 v[156:159], v[240:243], a[108:111], v[156:159]
    buffer_load_dwordx4 a[24:27], v1, s[4:7], s34 offen offset:2048 sc1
    v_mfma_f32_16x16x32_bf16 v[160:163], v[244:247], a[108:111], v[160:163]
    v_mfma_f32_16x16x32_bf16 v[164:167], v[248:251], a[108:111], v[164:167]
    v_mfma_f32_16x16x32_bf16 v[168:171], v[252:255], a[108:111], v[168:171]
    s_waitcnt vmcnt(11)
    v_mfma_f32_16x16x32_bf16 v[16:19], a[160:163], a[112:115], 0
    v_mfma_f32_16x16x32_bf16 v[20:23], a[164:167], a[112:115], 0
    buffer_load_dwordx4 a[28:31], v1, s[4:7], s34 offen offset:3072 sc1
    v_mfma_f32_16x16x32_bf16 v[24:27], a[168:171], a[112:115], 0
    v_mfma_f32_16x16x32_bf16 v[28:31], a[172:175], a[112:115], 0
    s_add_u32 s34, s74, 8192
    buffer_load_dwordx4 a[32:35], v1, s[4:7], s34 offen offset:0 sc1
    v_mfma_f32_16x16x32_bf16 v[32:35], a[176:179], a[112:115], 0
    s_waitcnt vmcnt(12)
    v_mfma_f32_16x16x32_bf16 v[16:19], a[180:183], a[116:119], v[16:19]
    v_mfma_f32_16x16x32_bf16 v[20:23], a[184:187], a[116:119], v[20:23]
    buffer_load_dwordx4 a[36:39], v1, s[4:7], s34 offen offset:1024 sc1
    v_mfma_f32_16x16x32_bf16 v[24:27], a[188:191], a[116:119], v[24:27]
    v_mfma_f32_16x16x32_bf16 v[28:31], a[192:195], a[116:119], v[28:31]
    v_mfma_f32_16x16x32_bf16 v[32:35], a[196:199], a[116:119], v[32:35]
    s_waitcnt vmcnt(12)
    v_mfma_f32_16x16x32_bf16 v[16:19], a[200:203], a[120:123], v[16:19]
    v_mfma_f32_16x16x32_bf16 v[20:23], a[204:207], a[120:123], v[20:23]
    buffer_load_dwordx4 a[40:43], v1, s[4:7], s34 offen offset:2048 sc1
    v_mfma_f32_16x16x32_bf16 v[24:27], a[208:211], a[120:123], v[24:27]
    v_mfma_f32_16x16x32_bf16 v[28:31], a[212:215], a[120:123], v[28:31]
    buffer_load_dwordx4 a[44:47], v1, s[4:7], s34 offen offset:3072 sc1
    v_mfma_f32_16x16x32_bf16 v[32:35], a[216:219], a[120:123], v[32:35]
    s_waitcnt vmcnt(13)
    v_mfma_f32_16x16x32_bf16 v[16:19], a[220:223], a[124:127], v[16:19]
    v_mfma_f32_16x16x32_bf16 v[20:23], a[224:227], a[124:127], v[20:23]
    s_add_u32 s34, s75, 8192
    buffer_load_dwordx4 a[48:51], v1, s[4:7], s34 offen offset:0 sc1
    v_mfma_f32_16x16x32_bf16 v[24:27], a[228:231], a[124:127], v[24:27]
    v_mfma_f32_16x16x32_bf16 v[28:31], a[232:235], a[124:127], v[28:31]
    v_mfma_f32_16x16x32_bf16 v[32:35], a[236:239], a[124:127], v[32:35]
    s_waitcnt vmcnt(13)
    v_mfma_f32_16x16x32_bf16 v[16:19], a[240:243], a[128:131], v[16:19]
    v_mfma_f32_16x16x32_bf16 v[20:23], a[244:247], a[128:131], v[20:23]
    buffer_load_dwordx4 a[52:55], v1, s[4:7], s34 offen offset:1024 sc1
    v_mfma_f32_16x16x32_bf16 v[24:27], a[248:251], a[128:131], v[24:27]
    v_mfma_f32_16x16x32_bf16 v[28:31], a[252:255], a[128:131], v[28:31]
    buffer_load_dwordx4 a[56:59], v1, s[4:7], s34 offen offset:2048 sc1
    v_mfma_f32_16x16x32_bf16 v[32:35], v[192:195], a[128:131], v[32:35]
    s_waitcnt vmcnt(14)
    v_mfma_f32_16x16x32_bf16 v[16:19], v[196:199], a[132:135], v[16:19]
    v_mfma_f32_16x16x32_bf16 v[20:23], v[200:203], a[132:135], v[20:23]
    buffer_load_dwordx4 a[60:63], v1, s[4:7], s34 offen offset:3072 sc1
    v_mfma_f32_16x16x32_bf16 v[24:27], v[204:207], a[132:135], v[24:27]
    v_mfma_f32_16x16x32_bf16 v[28:31], v[208:211], a[132:135], v[28:31]
    v_mfma_f32_16x16x32_bf16 v[32:35], v[212:215], a[132:135], v[32:35]
    s_waitcnt vmcnt(14)
    v_mfma_f32_16x16x32_bf16 v[16:19], v[216:219], a[136:139], v[16:19]
    v_mfma_f32_16x16x32_bf16 v[20:23], v[220:223], a[136:139], v[20:23]
    s_add_u32 s34, s76, 8192
    buffer_load_dwordx4 a[64:67], v1, s[4:7], s34 offen offset:0 sc1
    v_mfma_f32_16x16x32_bf16 v[24:27], v[224:227], a[136:139], v[24:27]
    v_mfma_f32_16x16x32_bf16 v[28:31], v[228:231], a[136:139], v[28:31]
    buffer_load_dwordx4 a[68:71], v1, s[4:7], s34 offen offset:1024 sc1
    v_mfma_f32_16x16x32_bf16 v[32:35], v[232:235], a[136:139], v[32:35]
    s_waitcnt vmcnt(15)
    v_mfma_f32_16x16x32_bf16 v[16:19], v[236:239], a[140:143], v[16:19]
    v_mfma_f32_16x16x32_bf16 v[20:23], v[240:243], a[140:143], v[20:23]
    buffer_load_dwordx4 a[72:75], v1, s[4:7], s34 offen offset:2048 sc1
    v_mfma_f32_16x16x32_bf16 v[24:27], v[244:247], a[140:143], v[24:27]
    v_mfma_f32_16x16x32_bf16 v[28:31], v[248:251], a[140:143], v[28:31]
    v_mfma_f32_16x16x32_bf16 v[32:35], v[252:255], a[140:143], v[32:35]
    s_waitcnt vmcnt(14)
    v_mfma_f32_16x16x32_bf16 v[112:115], v[80:83], a[16:19], v[112:115]
    ds_read_b128 a[160:163], v2 offset:49152
    v_mfma_f32_16x16x32_bf16 v[116:119], v[84:87], a[16:19], v[116:119]
    ds_read_b128 a[164:167], v2 offset:50176
    buffer_load_dwordx4 a[76:79], v1, s[4:7], s34 offen offset:3072 sc1
    v_mfma_f32_16x16x32_bf16 v[120:123], v[88:91], a[16:19], v[120:123]
    ds_read_b128 a[168:171], v2 offset:51200
    v_mfma_f32_16x16x32_bf16 v[124:127], v[92:95], a[16:19], v[124:127]
    ds_read_b128 a[172:175], v2 offset:52224
    v_mfma_f32_16x16x32_bf16 v[128:131], v[96:99], a[16:19], v[128:131]
    ds_read_b128 a[176:179], v2 offset:53248
    s_waitcnt vmcnt(14)
    v_mfma_f32_16x16x32_bf16 v[112:115], v[100:103], a[20:23], v[112:115]
    ds_read_b128 a[180:183], v2 offset:54272
    v_mfma_f32_16x16x32_bf16 v[116:119], v[104:107], a[20:23], v[116:119]
    ds_read_b128 a[184:187], v2 offset:55296
    v_mfma_f32_16x16x32_bf16 v[120:123], v[108:111], a[20:23], v[120:123]
    ds_read_b128 a[188:191], v2 offset:56320
    v_mfma_f32_16x16x32_bf16 v[124:127], v[48:51], a[20:23], v[124:127]
    ds_read_b128 a[192:195], v2 offset:57344
    v_mfma_f32_16x16x32_bf16 v[128:131], v[52:55], a[20:23], v[128:131]
    ds_read_b128 a[196:199], v2 offset:58368
    v_cmp_gt_u32 vcc, 3, v13
    s_cbranch_vccnz k2_main_kernel_q3
k2_main_kernel_q3x:
    s_waitcnt vmcnt(13)
    v_mfma_f32_16x16x32_bf16 v[112:115], v[56:59], a[24:27], v[112:115]
    ds_read_b128 a[200:203], v2 offset:59392
    v_mfma_f32_16x16x32_bf16 v[116:119], v[60:63], a[24:27], v[116:119]
    ds_read_b128 a[204:207], v2 offset:60416
    s_add_u32 s34, s63, 0
    buffer_load_dwordx4 a[80:83], v1, s[4:7], s34 offen offset:0 sc1
    v_mfma_f32_16x16x32_bf16 v[120:123], v[64:67], a[24:27], v[120:123]
    ds_read_b128 a[208:211], v2 offset:61440
    v_mfma_f32_16x16x32_bf16 v[124:127], v[68:71], a[24:27], v[124:127]
    ds_read_b128 a[212:215], v2 offset:62464
    buffer_load_dwordx4 a[84:87], v1, s[4:7], s34 offen offset:1024 sc1
    v_mfma_f32_16x16x32_bf16 v[128:131], v[72:75], a[24:27], v[128:131]
    ds_read_b128 a[216:219], v2 offset:63488
    s_waitcnt vmcnt(14)
    v_mfma_f32_16x16x32_bf16 v[112:115], v[76:79], a[28:31], v[112:115]
    ds_read_b128 a[220:223], v2 offset:64512
    v_mfma_f32_16x16x32_bf16 v[116:119], a[0:3], a[28:31], v[116:119]
    ds_read_b128 a[224:227], v3 offset:0
    s_add_u32 s34, s63, 14336
    buffer_load_dwordx4 a[88:91], v1, s[4:7], s34 offen offset:0 sc1
    v_mfma_f32_16x16x32_bf16 v[120:123], a[4:7], a[28:31], v[120:123]
    ds_read_b128 a[228:231], v3 offset:1024
    v_mfma_f32_16x16x32_bf16 v[124:127], a[8:11], a[28:31], v[124:127]
    ds_read_b128 a[232:235], v3 offset:2048
    v_mfma_f32_16x16x32_bf16 v[128:131], a[12:15], a[28:31], v[128:131]
    ds_read_b128 a[236:239], v3 offset:3072
    s_waitcnt vmcnt(14)
    v_mfma_f32_16x16x32_bf16 v[132:135], v[80:83], a[32:35], v[132:135]
    ds_read_b128 a[240:243], v3 offset:4096
    v_mfma_f32_16x16x32_bf16 v[136:139], v[84:87], a[32:35], v[136:139]
    ds_read_b128 a[244:247], v3 offset:5120
    buffer_load_dwordx4 a[92:95], v1, s[4:7], s34 offen offset:1024 sc1
    v_mfma_f32_16x16x32_bf16 v[140:143], v[88:91], a[32:35], v[140:143]
    v_add_u32 v14, s77, v1
    v_mfma_f32_16x16x32_bf16 v[144:147], v[92:95], a[32:35], v[144:147]
    ds_write_b128 v14, v[112:115] offset:0
    s_add_u32 s34, s63, 28672
    buffer_load_dwordx4 a[96:99], v1, s[4:7], s34 offen offset:0 sc1
    v_mfma_f32_16x16x32_bf16 v[148:151], v[96:99], a[32:35], v[148:151]
    ds_read_b128 a[248:251], v3 offset:6144
    s_waitcnt vmcnt(15)
    v_mfma_f32_16x16x32_bf16 v[132:135], v[100:103], a[36:39], v[132:135]
    ds_read_b128 a[252:255], v3 offset:7168
    v_mfma_f32_16x16x32_bf16 v[136:139], v[104:107], a[36:39], v[136:139]
    ds_read_b128 a[112:115], v3 offset:8192
    buffer_load_dwordx4 a[100:103], v1, s[4:7], s34 offen offset:1024 sc1
    v_mfma_f32_16x16x32_bf16 v[140:143], v[108:111], a[36:39], v[140:143]
    ds_write_b128 v14, v[116:119] offset:1024
    v_mfma_f32_16x16x32_bf16 v[144:147], v[48:51], a[36:39], v[144:147]
    ds_read_b128 a[116:119], v3 offset:9216
    v_mfma_f32_16x16x32_bf16 v[148:151], v[52:55], a[36:39], v[148:151]
    ds_read_b128 a[120:123], v3 offset:10240
    s_waitcnt vmcnt(15)
    v_mfma_f32_16x16x32_bf16 v[132:135], v[56:59], a[40:43], v[132:135]
    ds_read_b128 a[124:127], v3 offset:11264
    v_mfma_f32_16x16x32_bf16 v[136:139], v[60:63], a[40:43], v[136:139]
    ds_write_b128 v14, v[120:123] offset:2048
    s_add_u32 s34, s63, 43008
    buffer_load_dwordx4 a[104:107], v1, s[4:7], s34 offen offset:0 sc1
    v_mfma_f32_16x16x32_bf16 v[140:143], v[64:67], a[40:43], v[140:143]
    ds_read_b128 a[128:131], v3 offset:12288
    v_mfma_f32_16x16x32_bf16 v[144:147], v[68:71], a[40:43], v[144:147]
    ds_read_b128 a[132:135], v3 offset:13312
    buffer_load_dwordx4 a[108:111], v1, s[4:7], s34 offen offset:1024 sc1
    v_mfma_f32_16x16x32_bf16 v[148:151], v[72:75], a[40:43], v[148:151]
    ds_read_b128 a[136:139], v3 offset:14336
    s_waitcnt vmcnt(16)
    v_mfma_f32_16x16x32_bf16 v[132:135], v[76:79], a[44:47], v[132:135]
    ds_write_b128 v14, v[124:127] offset:3072
    v_mfma_f32_16x16x32_bf16 v[136:139], a[0:3], a[44:47], v[136:139]
    ds_read_b128 a[140:143], v3 offset:15360
    v_mfma_f32_16x16x32_bf16 v[140:143], a[4:7], a[44:47], v[140:143]
    ds_read_b128 a[144:147], v3 offset:16384
    v_mfma_f32_16x16x32_bf16 v[144:147], a[8:11], a[44:47], v[144:147]
    ds_read_b128 a[148:151], v3 offset:17408
    v_mfma_f32_16x16x32_bf16 v[148:151], a[12:15], a[44:47], v[148:151]
    ds_write_b128 v14, v[128:131] offset:4096
    s_waitcnt vmcnt(15)
    v_mfma_f32_16x16x32_bf16 v[152:155], v[80:83], a[48:51], v[152:155]
    ds_read_b128 a[152:155], v3 offset:18432
    v_mfma_f32_16x16x32_bf16 v[156:159], v[84:87], a[48:51], v[156:159]
    ds_read_b128 a[156:159], v3 offset:19456
    v_mfma_f32_16x16x32_bf16 v[160:163], v[88:91], a[48:51], v[160:163]
    v_add_u32 v14, s78, v1
    v_mfma_f32_16x16x32_bf16 v[164:167], v[92:95], a[48:51], v[164:167]
    ds_write_b128 v14, v[132:135] offset:20480
    v_mfma_f32_16x16x32_bf16 v[168:171], v[96:99], a[48:51], v[168:171]
    v_lshlrev_b32 v112, 16, v176
    v_and_b32 v113, 0xffff0000, v176
    s_waitcnt vmcnt(14)
    v_mfma_f32_16x16x32_bf16 v[152:155], v[100:103], a[52:55], v[152:155]
    v_lshlrev_b32 v114, 16, v177
    v_and_b32 v115, 0xffff0000, v177
    v_mfma_f32_16x16x32_bf16 v[156:159], v[104:107], a[52:55], v[156:159]
    v_lshlrev_b32 v116, 16, v178
    v_and_b32 v117, 0xffff0000, v178
    v_mfma_f32_16x16x32_bf16 v[160:163], v[108:111], a[52:55], v[160:163]
    ds_write_b128 v14, v[136:139] offset:21504
    v_mfma_f32_16x16x32_bf16 v[164:167], v[48:51], a[52:55], v[164:167]
    v_lshlrev_b32 v118, 16, v179
    v_and_b32 v119, 0xffff0000, v179
    v_mfma_f32_16x16x32_bf16 v[168:171], v[52:55], a[52:55], v[168:171]
    v_lshlrev_b32 v120, 16, v180
    v_and_b32 v121, 0xffff0000, v180
    s_waitcnt vmcnt(13)
    v_mfma_f32_16x16x32_bf16 v[152:155], v[56:59], a[56:59], v[152:155]
    v_lshlrev_b32 v122, 16, v181
    v_and_b32 v123, 0xffff0000, v181
    v_mfma_f32_16x16x32_bf16 v[156:159], v[60:63], a[56:59], v[156:159]
    ds_write_b128 v14, v[140:143] offset:22528
    v_mfma_f32_16x16x32_bf16 v[160:163], v[64:67], a[56:59], v[160:163]
    v_lshlrev_b32 v124, 16, v182
    v_and_b32 v125, 0xffff0000, v182
    v_mfma_f32_16x16x32_bf16 v[164:167], v[68:71], a[56:59], v[164:167]
    v_lshlrev_b32 v126, 16, v183
    v_and_b32 v127, 0xffff0000, v183
    v_mfma_f32_16x16x32_bf16 v[168:171], v[72:75], a[56:59], v[168:171]
    v_lshlrev_b32 v128, 16, v184
    v_and_b32 v129, 0xffff0000, v184
    s_waitcnt vmcnt(12)
    v_mfma_f32_16x16x32_bf16 v[152:155], v[76:79], a[60:63], v[152:155]
    ds_write_b128 v14, v[144:147] offset:23552
    v_mfma_f32_16x16x32_bf16 v[156:159], a[0:3], a[60:63], v[156:159]
    v_lshlrev_b32 v130, 16, v185
    v_and_b32 v131, 0xffff0000, v185
    v_mfma_f32_16x16x32_bf16 v[160:163], a[4:7], a[60:63], v[160:163]
    v_mfma_f32_16x16x32_bf16 v[164:167], a[8:11], a[60:63], v[164:167]
    v_mfma_f32_16x16x32_bf16 v[168:171], a[12:15], a[60:63], v[168:171]
    ds_write_b128 v14, v[148:151] offset:24576
    s_waitcnt vmcnt(11)
    v_mfma_f32_16x16x32_bf16 v[16:19], v[80:83], a[64:67], v[16:19]
    v_mfma_f32_16x16x32_bf16 v[20:23], v[84:87], a[64:67], v[20:23]
    v_add_u32 v15, s80, v1
    v_mfma_f32_16x16x32_bf16 v[24:27], v[88:91], a[64:67], v[24:27]
    v_add_u32 v14, s79, v1
    v_mfma_f32_16x16x32_bf16 v[28:31], v[92:95], a[64:67], v[28:31]
    ds_write_b128 v14, v[152:155] offset:40960
    v_mfma_f32_16x16x32_bf16 v[32:35], v[96:99], a[64:67], v[32:35]
    s_waitcnt lgkmcnt(1)
    s_waitcnt vmcnt(10)
    v_mfma_f32_16x16x32_bf16 v[16:19], v[100:103], a[68:71], v[16:19]
    s_barrier
    v_mfma_f32_16x16x32_bf16 v[20:23], v[104:107], a[68:71], v[20:23]
    ds_write_b128 v14, v[156:159] offset:41984
    v_mfma_f32_16x16x32_bf16 v[24:27], v[108:111], a[68:71], v[24:27]
    ds_read_b128 v[192:195], v15 offset:0
    v_mfma_f32_16x16x32_bf16 v[28:31], v[48:51], a[68:71], v[28:31]
    ds_read_b128 v[196:199], v15 offset:1024
    v_mfma_f32_16x16x32_bf16 v[32:35], v[52:55], a[68:71], v[32:35]
    ds_write_b128 v14, v[160:163] offset:43008
    s_waitcnt vmcnt(9)
    v_mfma_f32_16x16x32_bf16 v[16:19], v[56:59], a[72:75], v[16:19]
    ds_read_b128 v[200:203], v15 offset:2048
    v_mfma_f32_16x16x32_bf16 v[20:23], v[60:63], a[72:75], v[20:23]
    ds_read_b128 v[204:207], v15 offset:3072
    v_mfma_f32_16x16x32_bf16 v[24:27], v[64:67], a[72:75], v[24:27]
    ds_write_b128 v14, v[164:167] offset:44032
    v_mfma_f32_16x16x32_bf16 v[28:31], v[68:71], a[72:75], v[28:31]
    ds_read_b128 v[208:211], v15 offset:4096
    v_mfma_f32_16x16x32_bf16 v[32:35], v[72:75], a[72:75], v[32:35]
    ds_read_b128 v[212:215], v15 offset:20480
    s_waitcnt vmcnt(8)
    v_mfma_f32_16x16x32_bf16 v[16:19], v[76:79], a[76:79], v[16:19]
    ds_write_b128 v14, v[168:171] offset:45056
    v_mfma_f32_16x16x32_bf16 v[20:23], a[0:3], a[76:79], v[20:23]
    ds_read_b128 v[216:219], v15 offset:21504
    v_mfma_f32_16x16x32_bf16 v[24:27], a[4:7], a[76:79], v[24:27]
    ds_read_b128 v[220:223], v15 offset:22528
    v_mfma_f32_16x16x32_bf16 v[28:31], a[8:11], a[76:79], v[28:31]
    ds_read_b128 v[224:227], v15 offset:23552
    v_mfma_f32_16x16x32_bf16 v[32:35], a[12:15], a[76:79], v[32:35]
    ds_read_b128 v[228:231], v15 offset:24576
    s_waitcnt vmcnt(7)
    v_mfma_f32_16x16x32_bf16 v[16:19], a[160:163], a[80:83], v[16:19]
    v_mfma_f32_16x16x32_bf16 v[20:23], a[164:167], a[80:83], v[20:23]
    s_waitcnt lgkmcnt(0)
    v_mfma_f32_16x16x32_bf16 v[24:27], a[168:171], a[80:83], v[24:27]
    s_barrier
    v_add_f32 v112, v112, v192
    v_add_f32 v113, v113, v193
    v_mfma_f32_16x16x32_bf16 v[28:31], a[172:175], a[80:83], v[28:31]
    ds_read_b128 v[232:235], v15 offset:40960
    v_add_f32 v114, v114, v194
    v_mfma_f32_16x16x32_bf16 v[32:35], a[176:179], a[80:83], v[32:35]
    ds_read_b128 v[236:239], v15 offset:41984
    v_add_f32 v115, v115, v195
    s_waitcnt vmcnt(6)
    v_mfma_f32_16x16x32_bf16 v[16:19], a[180:183], a[84:87], v[16:19]
    ds_read_b128 v[240:243], v15 offset:43008
    v_add_f32 v116, v116, v196
    v_mfma_f32_16x16x32_bf16 v[20:23], a[184:187], a[84:87], v[20:23]
    ds_read_b128 v[244:247], v15 offset:44032
    v_add_f32 v117, v117, v197
    v_mfma_f32_16x16x32_bf16 v[24:27], a[188:191], a[84:87], v[24:27]
    ds_read_b128 v[248:251], v15 offset:45056
    v_add_f32 v118, v118, v198
    v_mfma_f32_16x16x32_bf16 v[28:31], a[192:195], a[84:87], v[28:31]
    ds_read_b128 a[160:163], v3 offset:20480
    v_add_f32 v119, v119, v199
    v_mfma_f32_16x16x32_bf16 v[32:35], a[196:199], a[84:87], v[32:35]
    ds_read_b128 a[164:167], v3 offset:21504
    v_add_f32 v120, v120, v200
    s_waitcnt vmcnt(5)
    v_mfma_f32_16x16x32_bf16 v[16:19], a[200:203], a[88:91], v[16:19]
    ds_read_b128 a[168:171], v3 offset:22528
    v_add_f32 v121, v121, v201
    v_mfma_f32_16x16x32_bf16 v[20:23], a[204:207], a[88:91], v[20:23]
    ds_read_b128 a[172:175], v3 offset:23552
    v_add_f32 v122, v122, v202
    v_mfma_f32_16x16x32_bf16 v[24:27], a[208:211], a[88:91], v[24:27]
    v_add_f32 v123, v123, v203
    v_add_f32 v124, v124, v204
    v_mfma_f32_16x16x32_bf16 v[28:31], a[212:215], a[88:91], v[28:31]
    v_add_f32 v125, v125, v205
    v_add_f32 v126, v126, v206
    v_mfma_f32_16x16x32_bf16 v[32:35], a[216:219], a[88:91], v[32:35]
    v_add_f32 v127, v127, v207
    v_add_f32 v128, v128, v208
    s_waitcnt vmcnt(4)
    v_mfma_f32_16x16x32_bf16 v[16:19], a[220:223], a[92:95], v[16:19]
    v_add_f32 v129, v129, v209
    v_add_f32 v130, v130, v210
    v_mfma_f32_16x16x32_bf16 v[20:23], a[224:227], a[92:95], v[20:23]
    v_add_f32 v131, v131, v211
    v_add_f32 v112, v112, v212
    v_mfma_f32_16x16x32_bf16 v[24:27], a[228:231], a[92:95], v[24:27]
    v_add_f32 v113, v113, v213
    v_add_f32 v114, v114, v214
    v_mfma_f32_16x16x32_bf16 v[28:31], a[232:235], a[92:95], v[28:31]
    v_add_f32 v115, v115, v215
    v_add_f32 v116, v116, v216
    v_mfma_f32_16x16x32_bf16 v[32:35], a[236:239], a[92:95], v[32:35]
    v_add_f32 v117, v117, v217
    v_add_f32 v118, v118, v218
    s_waitcnt vmcnt(3)
    v_mfma_f32_16x16x32_bf16 v[16:19], a[240:243], a[96:99], v[16:19]
    v_add_f32 v119, v119, v219
    v_add_f32 v120, v120, v220
    v_mfma_f32_16x16x32_bf16 v[20:23], a[244:247], a[96:99], v[20:23]
    v_add_f32 v121, v121, v221
    v_add_f32 v122, v122, v222
    v_mfma_f32_16x16x32_bf16 v[24:27], a[248:251], a[96:99], v[24:27]
    v_add_f32 v123, v123, v223
    v_add_f32 v124, v124, v224
    v_mfma_f32_16x16x32_bf16 v[28:31], a[252:255], a[96:99], v[28:31]
    v_add_f32 v125, v125, v225
    v_add_f32 v126, v126, v226
    v_mfma_f32_16x16x32_bf16 v[32:35], a[112:115], a[96:99], v[32:35]
    v_add_f32 v127, v127, v227
    v_add_f32 v128, v128, v228
    s_waitcnt vmcnt(2)
    v_mfma_f32_16x16x32_bf16 v[16:19], a[116:119], a[100:103], v[16:19]
    v_add_f32 v129, v129, v229
    v_add_f32 v130, v130, v230
    v_mfma_f32_16x16x32_bf16 v[20:23], a[120:123], a[100:103], v[20:23]
    s_waitcnt lgkmcnt(0)
    v_add_f32 v131, v131, v231
    v_add_f32 v112, v112, v232
    v_mfma_f32_16x16x32_bf16 v[24:27], a[124:127], a[100:103], v[24:27]
    v_add_f32 v113, v113, v233
    v_add_f32 v114, v114, v234
    v_mfma_f32_16x16x32_bf16 v[28:31], a[128:131], a[100:103], v[28:31]
    v_add_f32 v115, v115, v235
    v_add_f32 v116, v116, v236
    v_mfma_f32_16x16x32_bf16 v[32:35], a[132:135], a[100:103], v[32:35]
    v_add_f32 v117, v117, v237
    v_add_f32 v118, v118, v238
    s_waitcnt vmcnt(1)
    v_mfma_f32_16x16x32_bf16 v[16:19], a[136:139], a[104:107], v[16:19]
    v_add_f32 v119, v119, v239
    v_add_f32 v120, v120, v240
    v_mfma_f32_16x16x32_bf16 v[20:23], a[140:143], a[104:107], v[20:23]
    v_add_f32 v121, v121, v241
    v_add_f32 v122, v122, v242
    v_mfma_f32_16x16x32_bf16 v[24:27], a[144:147], a[104:107], v[24:27]
    v_add_f32 v123, v123, v243
    v_add_f32 v124, v124, v244
    v_mfma_f32_16x16x32_bf16 v[28:31], a[148:151], a[104:107], v[28:31]
    v_add_f32 v125, v125, v245
    v_add_f32 v126, v126, v246
    v_mfma_f32_16x16x32_bf16 v[32:35], a[152:155], a[104:107], v[32:35]
    v_add_f32 v127, v127, v247
    v_add_f32 v128, v128, v248
    s_waitcnt vmcnt(0)
    v_mfma_f32_16x16x32_bf16 v[16:19], a[156:159], a[108:111], v[16:19]
    v_add_f32 v129, v129, v249
    v_add_f32 v130, v130, v250
    v_mfma_f32_16x16x32_bf16 v[20:23], a[160:163], a[108:111], v[20:23]
    v_add_f32 v131, v131, v251
    v_mfma_f32_16x16x32_bf16 v[24:27], a[164:167], a[108:111], v[24:27]
    v_mfma_f32_16x16x32_bf16 v[28:31], a[168:171], a[108:111], v[28:31]
    v_mfma_f32_16x16x32_bf16 v[32:35], a[172:175], a[108:111], v[32:35]
    s_nop 3
    v_pk_add_f32 v[112:113], v[112:113], v[16:17]
    v_pk_add_f32 v[114:115], v[114:115], v[18:19]
    v_cvt_pk_bf16_f32 v176, v112, v113
    v_cvt_pk_bf16_f32 v177, v114, v115
    v_pk_add_f32 v[116:117], v[116:117], v[20:21]
    v_pk_add_f32 v[118:119], v[118:119], v[22:23]
    ds_write_b64 v11, v[176:177] offset:0
    v_cvt_pk_bf16_f32 v178, v116, v117
    v_cvt_pk_bf16_f32 v179, v118, v119
    v_pk_add_f32 v[120:121], v[120:121], v[24:25]
    v_pk_add_f32 v[122:123], v[122:123], v[26:27]
    ds_write_b64 v11, v[178:179] offset:32
    v_cvt_pk_bf16_f32 v180, v120, v121
    v_cvt_pk_bf16_f32 v181, v122, v123
    v_pk_add_f32 v[124:125], v[124:125], v[28:29]
    v_pk_add_f32 v[126:127], v[126:127], v[30:31]
    ds_write_b64 v11, v[180:181] offset:64
    v_cvt_pk_bf16_f32 v182, v124, v125
    v_cvt_pk_bf16_f32 v183, v126, v127
    v_pk_add_f32 v[128:129], v[128:129], v[32:33]
    v_pk_add_f32 v[130:131], v[130:131], v[34:35]
    ds_write_b64 v11, v[182:183] offset:96
    v_cvt_pk_bf16_f32 v184, v128, v129
    v_cvt_pk_bf16_f32 v185, v130, v131
    ds_write_b64 v11, v[184:185] offset:128
    v_add_u32 v13, s32, v1
    s_waitcnt lgkmcnt(0)
    ds_read_b128 v[48:51], v13 offset:0
    ds_read_b128 v[52:55], v13 offset:1024
    ds_read_b128 v[56:59], v13 offset:2048
    s_waitcnt lgkmcnt(2)
    buffer_store_dwordx4 v[48:51], v8, s[44:47], s25 offen nt
    s_waitcnt lgkmcnt(1)
    buffer_store_dwordx4 v[52:55], v9, s[44:47], s25 offen nt
    s_waitcnt lgkmcnt(0)
    s_mov_b32 exec_hi, 0
    buffer_store_dwordx4 v[56:59], v10, s[44:47], s25 offen nt
k2_main_kernel_end:
    s_endpgm
k2_main_kernel_dp:
    s_mov_b32 s81, 0
k2_main_kernel_dpl:
    buffer_load_dword v13, off, s[44:47], 0 sc1
    s_add_u32 s81, s81, 1
    s_cmp_gt_u32 s81, 40000
    s_waitcnt vmcnt(0)
    v_cmp_eq_u32 vcc, 0, v13
    s_cbranch_scc1 k2_main_kernel_dpx
    s_cbranch_vccnz k2_main_kernel_dpl
    s_branch k2_main_kernel_dpx
k2_main_kernel_kp:
    s_mov_b32 s81, 0
k2_main_kernel_kpl:
    buffer_load_dword v220, v254, s[4:7], s68 offen sc1
    s_add_u32 s81, s81, 1
    s_cmp_gt_u32 s81, 40000
    s_waitcnt vmcnt(0)
    v_cmp_eq_u32 vcc, 0, v220
    s_cbranch_scc1 k2_main_kernel_kpx
    s_cbranch_vccnz k2_main_kernel_kpl
    s_branch k2_main_kernel_kpx
k2_main_kernel_pr:
    s_mov_b32 s81, 0
k2_main_kernel_prl:
    buffer_load_dword v13, v239, s[4:7], s100 offen sc1
    s_add_u32 s81, s81, 1
    s_cmp_gt_u32 s81, 40000
    s_waitcnt vmcnt(0)
    v_cmp_gt_u32 vcc, 1, v13
    s_cbranch_scc1 k2_main_kernel_prx
    s_cbranch_vccnz k2_main_kernel_prl
    s_branch k2_main_kernel_prx
k2_main_kernel_vs1:
    buffer_store_dwordx4 v[16:19], v1, s[4:7], s48 offen sc1
    s_mov_b32 exec_hi, 0
    buffer_store_dwordx2 v[20:21], v12, s[4:7], s49 offen sc1
    s_branch k2_main_kernel_vs1x
k2_main_kernel_vs2:
    buffer_store_dwordx4 v[24:27], v1, s[4:7], s16 offen sc1
    s_mov_b32 exec_hi, 0
    buffer_store_dwordx2 v[28:29], v12, s[4:7], s17 offen sc1
    s_branch k2_main_kernel_vs2x
k2_main_kernel_slow:
    s_mov_b32 s41, 1
    s_mov_b32 s33, 5570560
    v_subrev_u32 v3, 122880, v3
    v_subrev_u32 v4, 122880, v4
    v_mov_b32 v10, 0xff800000
    v_mov_b32 v12, 0xff800000
    s_waitcnt vmcnt(0)
k2_main_kernel_slow1:
    buffer_load_dwordx4 a[0:3], v1, s[4:7], s33 offen
    buffer_load_dwordx4 a[4:7], v1, s[4:7], s33 offen offset:1024
    buffer_load_dwordx2 a[8:9], v3, s[4:7], s33 offen
    s_add_u32 s33, s33, 5120
    s_waitcnt vmcnt(0)
    v_mfma_f32_32x32x16_bf16 v[16:31], a[0:3], v[144:147], 0
    v_mfma_f32_32x32x16_bf16 v[32:47], a[4:7], v[144:147], 0
    v_mfma_f32_32x32x16_bf16 v[48:63], a[0:3], v[152:155], 0
    v_mfma_f32_32x32x16_bf16 v[64:79], a[4:7], v[152:155], 0
    s_nop 8
    v_mfma_f32_32x32x4_2b_bf16 v[16:47], a[8:9], v[148:149], v[16:47]
    v_mfma_f32_32x32x4_2b_bf16 v[48:79], a[8:9], v[156:157], v[48:79]
    s_nop 9
    s_nop 9
    v_max3_f32 v10, v16, v17, v10
    v_max3_f32 v10, v18, v19, v10
    v_max3_f32 v10, v20, v21, v10
    v_max3_f32 v10, v22, v23, v10
    v_max3_f32 v10, v24, v25, v10
    v_max3_f32 v10, v26, v27, v10
    v_max3_f32 v10, v28, v29, v10
    v_max3_f32 v10, v30, v31, v10
    v_max3_f32 v10, v32, v33, v10
    v_max3_f32 v10, v34, v35, v10
    v_max3_f32 v10, v36, v37, v10
    v_max3_f32 v10, v38, v39, v10
    v_max3_f32 v10, v40, v41, v10
    v_max3_f32 v10, v42, v43, v10
    v_max3_f32 v10, v44, v45, v10
    v_max3_f32 v10, v46, v47, v10
    v_max3_f32 v12, v48, v49, v12
    v_max3_f32 v12, v50, v51, v12
    v_max3_f32 v12, v52, v53, v12
    v_max3_f32 v12, v54, v55, v12
    v_max3_f32 v12, v56, v57, v12
    v_max3_f32 v12, v58, v59, v12
    v_max3_f32 v12, v60, v61, v12
    v_max3_f32 v12, v62, v63, v12
    v_max3_f32 v12, v64, v65, v12
    v_max3_f32 v12, v66, v67, v12
    v_max3_f32 v12, v68, v69, v12
    v_max3_f32 v12, v70, v71, v12
    v_max3_f32 v12, v72, v73, v12
    v_max3_f32 v12, v74, v75, v12
    v_max3_f32 v12, v76, v77, v12
    v_max3_f32 v12, v78, v79, v12
    s_cmp_lt_u32 s33, 5734400
    s_cbranch_scc1 k2_main_kernel_slow1
    v_mov_b32 v11, v10
    s_nop 1
    v_permlane32_swap_b32 v10, v11
    v_max_f32 v10, v10, v11
    v_mul_f32 v80, -1.0, v10
    v_mul_f32 v81, -1.0, v10
    v_mul_f32 v82, -1.0, v10
    v_mul_f32 v83, -1.0, v10
    v_mul_f32 v84, -1.0, v10
    v_mul_f32 v85, -1.0, v10
    v_mul_f32 v86, -1.0, v10
    v_mul_f32 v87, -1.0, v10
    v_mul_f32 v88, -1.0, v10
    v_mul_f32 v89, -1.0, v10
    v_mul_f32 v90, -1.0, v10
    v_mul_f32 v91, -1.0, v10
    v_mul_f32 v92, -1.0, v10
    v_mul_f32 v93, -1.0, v10
    v_mul_f32 v94, -1.0, v10
    v_mul_f32 v95, -1.0, v10
    v_mov_b32 v13, v12
    s_nop 1
    v_permlane32_swap_b32 v12, v13
    v_max_f32 v12, v12, v13
    v_mul_f32 v96, -1.0, v12
    v_mul_f32 v97, -1.0, v12
    v_mul_f32 v98, -1.0, v12
    v_mul_f32 v99, -1.0, v12
    v_mul_f32 v100, -1.0, v12
    v_mul_f32 v101, -1.0, v12
    v_mul_f32 v102, -1.0, v12
    v_mul_f32 v103, -1.0, v12
    v_mul_f32 v104, -1.0, v12
    v_mul_f32 v105, -1.0, v12
    v_mul_f32 v106, -1.0, v12
    v_mul_f32 v107, -1.0, v12
    v_mul_f32 v108, -1.0, v12
    v_mul_f32 v109, -1.0, v12
    v_mul_f32 v110, -1.0, v12
    v_mul_f32 v111, -1.0, v12
    v_mov_b32 v112, 0
    v_mov_b32 v113, 0
    v_mov_b32 v114, 0
    v_mov_b32 v115, 0
    v_mov_b32 v116, 0
    v_mov_b32 v117, 0
    v_mov_b32 v118, 0
    v_mov_b32 v119, 0
    v_mov_b32 v120, 0
    v_mov_b32 v121, 0
    v_mov_b32 v122, 0
    v_mov_b32 v123, 0
    v_mov_b32 v124, 0
    v_mov_b32 v125, 0
    v_mov_b32 v126, 0
    v_mov_b32 v127, 0
    v_mov_b32 v128, 0
    v_mov_b32 v129, 0
    v_mov_b32 v130, 0
    v_mov_b32 v131, 0
    v_mov_b32 v132, 0
    v_mov_b32 v133, 0
    v_mov_b32 v134, 0
    v_mov_b32 v135, 0
    v_mov_b32 v136, 0
    v_mov_b32 v137, 0
    v_mov_b32 v138, 0
    v_mov_b32 v139, 0
    v_mov_b32 v140, 0
    v_mov_b32 v141, 0
    v_mov_b32 v142, 0
    v_mov_b32 v143, 0
    s_mov_b32 s33, 5570560
k2_main_kernel_slow2:
    buffer_load_dwordx4 a[0:3], v1, s[4:7], s33 offen
    buffer_load_dwordx4 a[4:7], v1, s[4:7], s33 offen offset:1024
    buffer_load_dwordx2 a[8:9], v3, s[4:7], s33 offen
    s_mov_b64 exec, s[42:43]
    buffer_load_dwordx4 v[160:163], v4, s[4:7], s33 offen offset:0
    buffer_load_dwordx4 v[164:167], v4, s[4:7], s33 offen offset:640
    buffer_load_dwordx4 v[168:171], v4, s[4:7], s33 offen offset:1280
    buffer_load_dwordx4 v[172:175], v4, s[4:7], s33 offen offset:1920
    s_mov_b64 exec, -1
    s_add_u32 s33, s33, 5120
    s_waitcnt vmcnt(0)
    v_mfma_f32_32x32x16_bf16 v[16:31], a[0:3], v[144:147], v[80:95]
    v_mfma_f32_32x32x16_bf16 v[32:47], a[4:7], v[144:147], v[80:95]
    v_mfma_f32_32x32x16_bf16 v[48:63], a[0:3], v[152:155], v[96:111]
    v_mfma_f32_32x32x16_bf16 v[64:79], a[4:7], v[152:155], v[96:111]
    s_nop 8
    v_mfma_f32_32x32x4_2b_bf16 v[16:47], a[8:9], v[148:149], v[16:47]
    v_mfma_f32_32x32x4_2b_bf16 v[48:79], a[8:9], v[156:157], v[48:79]
    s_nop 9
    s_nop 9
    v_exp_f32 v16, v16
    v_exp_f32 v17, v17
    v_exp_f32 v18, v18
    v_exp_f32 v19, v19
    v_exp_f32 v20, v20
    v_exp_f32 v21, v21
    v_exp_f32 v22, v22
    v_exp_f32 v23, v23
    v_exp_f32 v24, v24
    v_exp_f32 v25, v25
    v_exp_f32 v26, v26
    v_exp_f32 v27, v27
    v_exp_f32 v28, v28
    v_exp_f32 v29, v29
    v_exp_f32 v30, v30
    v_exp_f32 v31, v31
    v_exp_f32 v32, v32
    v_exp_f32 v33, v33
    v_exp_f32 v34, v34
    v_exp_f32 v35, v35
    v_exp_f32 v36, v36
    v_exp_f32 v37, v37
    v_exp_f32 v38, v38
    v_exp_f32 v39, v39
    v_exp_f32 v40, v40
    v_exp_f32 v41, v41
    v_exp_f32 v42, v42
    v_exp_f32 v43, v43
    v_exp_f32 v44, v44
    v_exp_f32 v45, v45
    v_exp_f32 v46, v46
    v_exp_f32 v47, v47
    v_exp_f32 v48, v48
    v_exp_f32 v49, v49
    v_exp_f32 v50, v50
    v_exp_f32 v51, v51
    v_exp_f32 v52, v52
    v_exp_f32 v53, v53
    v_exp_f32 v54, v54
    v_exp_f32 v55, v55
    v_exp_f32 v56, v56
    v_exp_f32 v57, v57
    v_exp_f32 v58, v58
    v_exp_f32 v59, v59
    v_exp_f32 v60, v60
    v_exp_f32 v61, v61
    v_exp_f32 v62, v62
    v_exp_f32 v63, v63
    v_exp_f32 v64, v64
    v_exp_f32 v65, v65
    v_exp_f32 v66, v66
    v_exp_f32 v67, v67
    v_exp_f32 v68, v68
    v_exp_f32 v69, v69
    v_exp_f32 v70, v70
    v_exp_f32 v71, v71
    v_exp_f32 v72, v72
    v_exp_f32 v73, v73
    v_exp_f32 v74, v74
    v_exp_f32 v75, v75
    v_exp_f32 v76, v76
    v_exp_f32 v77, v77
    v_exp_f32 v78, v78
    v_exp_f32 v79, v79
    s_nop 1
    v_smfmac_f32_32x32x32_bf16 v[112:127], v[160:163], v[16:23], v5
    v_smfmac_f32_32x32x32_bf16 v[128:143], v[160:163], v[48:55], v5
    v_smfmac_f32_32x32x32_bf16 v[112:127], v[164:167], v[24:31], v5
    v_smfmac_f32_32x32x32_bf16 v[128:143], v[164:167], v[56:63], v5
    v_smfmac_f32_32x32x32_bf16 v[112:127], v[168:171], v[32:39], v5
    v_smfmac_f32_32x32x32_bf16 v[128:143], v[168:171], v[64:71], v5
    v_smfmac_f32_32x32x32_bf16 v[112:127], v[172:175], v[40:47], v5
    v_smfmac_f32_32x32x32_bf16 v[128:143], v[172:175], v[72:79], v5
    s_nop 11
    s_cmp_lt_u32 s33, 5734400
    s_cbranch_scc1 k2_main_kernel_slow2
    s_branch k2_main_kernel_fin
k2_main_kernel_vs3:
    buffer_store_dword v7, off, s[4:7], s65 sc1
    s_branch k2_main_kernel_vs3x
k2_main_kernel_pad_Tpo:
    s_branch k2_main_kernel_tr_r13
k2_main_kernel_po:
    s_mov_b32 s81, 0
k2_main_kernel_pol:
    buffer_load_dword v13, v187, s[4:7], s66 offen sc1
    s_add_u32 s81, s81, 1
    s_cmp_gt_u32 s81, 40000
    s_waitcnt vmcnt(0)
    v_cmp_gt_u32 vcc, 1, v13
    s_cbranch_scc1 k2_main_kernel_pox
    s_cbranch_vccnz k2_main_kernel_pol
    s_branch k2_main_kernel_pox
k2_main_kernel_p1:
    s_mov_b32 s81, 0
k2_main_kernel_p1l:
    buffer_load_dword v13, v12, s[4:7], s68 offen sc1
    s_add_u32 s81, s81, 1
    s_cmp_gt_u32 s81, 40000
    s_waitcnt vmcnt(0)
    v_cmp_gt_u32 vcc, 1, v13
    s_cbranch_scc1 k2_main_kernel_p1x
    s_cbranch_vccnz k2_main_kernel_p1l
    s_branch k2_main_kernel_p1x
k2_main_kernel_ps:
    s_mov_b32 s81, 0
k2_main_kernel_psl:
    buffer_load_dword v13, v12, s[4:7], s68 offen sc1
    s_add_u32 s81, s81, 1
    s_cmp_gt_u32 s81, 40000
    s_waitcnt vmcnt(0)
    v_cmp_gt_u32 vcc, 2, v13
    s_cbranch_scc1 k2_main_kernel_psx
    s_cbranch_vccnz k2_main_kernel_psl
    s_branch k2_main_kernel_psx
k2_main_kernel_q1:
    s_mov_b32 s81, 0
k2_main_kernel_q1l:
    buffer_load_dword v13, v12, s[4:7], s70 offen sc1
    s_add_u32 s81, s81, 1
    s_cmp_gt_u32 s81, 40000
    s_waitcnt vmcnt(0)
    v_cmp_gt_u32 vcc, 1, v13
    s_cbranch_scc1 k2_main_kernel_q1x
    s_cbranch_vccnz k2_main_kernel_q1l
    s_branch k2_main_kernel_q1x
k2_main_kernel_q2:
    s_mov_b32 s81, 0
k2_main_kernel_q2l:
    buffer_load_dword v13, v12, s[4:7], s70 offen sc1
    s_add_u32 s81, s81, 1
    s_cmp_gt_u32 s81, 40000
    s_waitcnt vmcnt(0)
    v_cmp_gt_u32 vcc, 2, v13
    s_cbranch_scc1 k2_main_kernel_q2x
    s_cbranch_vccnz k2_main_kernel_q2l
    s_branch k2_main_kernel_q2x
k2_main_kernel_q3:
    s_mov_b32 s81, 0
k2_main_kernel_q3l:
    buffer_load_dword v13, v187, s[4:7], s72 offen sc1
    s_add_u32 s81, s81, 1
    s_cmp_gt_u32 s81, 40000
    s_waitcnt vmcnt(0)
    v_cmp_gt_u32 vcc, 3, v13
    s_cbranch_scc1 k2_main_kernel_q3x
    s_cbranch_vccnz k2_main_kernel_q3l
    s_branch k2_main_kernel_q3x
k2_main_kernel_last:
text_end:
.section .rodata,"a"
.p2align 6
.amdhsa_kernel sequential_preLN__grouped_kv_mqa__glu_gated_swiglu__prompt_kernel
  .amdhsa_next_free_vgpr 512
  .amdhsa_next_free_sgpr 102
  .amdhsa_accum_offset 256
  .amdhsa_group_segment_fixed_size 0
  .amdhsa_kernarg_size 96
  .amdhsa_user_sgpr_count 2
  .amdhsa_user_sgpr_kernarg_segment_ptr 1
  .amdhsa_system_sgpr_workgroup_id_x 1
.end_amdhsa_kernel
```
